```python
import torch

def _softmax(x, axis=-1):
    return torch.softmax(x, dim=axis)

def _gelu(x):
    return torch.nn.functional.gelu(x, approximate='tanh')

def _silu(x):
    return torch.nn.functional.silu(x)

def _sigmoid(x):
    return torch.sigmoid(x)

def _layernorm(x, axis=-1, eps=1e-05):
    m = x.mean(dim=axis, keepdim=True)
    v = x.var(dim=axis, keepdim=True, unbiased=False)
    return (x - m) / torch.sqrt(v + eps)

def _scatter_add(tgt, idx, src, axis=0):
    return tgt.clone().index_add_(axis, idx, src)

def _segment_sum(src, seg, n):
    out = torch.zeros((n,) + src.shape[1:], dtype=src.dtype)
    return out.index_add_(0, seg, src)

def _pad(x, pw):
    flat = tuple((v for pair in reversed(pw) for v in pair))
    return torch.nn.functional.pad(x, flat)
kernel_name = 'adaLN_cond__memory_aug_recurrent_mem_tr__geglu_ffn__prompt'

def setup_inputs():

    _w = lambda a: (lambda t: t.to(torch.bfloat16) if t.is_floating_point() else t)(torch.as_tensor(a))

    def _A_setup():
        B, S, Dm = (1, 2048, 512)
        H, Dh = (32, 128)
        M, seg = (8, 32)
        seg = min(seg, S)
        S = S // seg * seg
        return {'x': _w((lambda *s: torch.randn(*s, dtype=torch.bfloat16) * 0.05)(B, S, Dm)), 'mem0': _w((lambda *s: torch.randn(*s, dtype=torch.bfloat16) * 0.4)(B, M, Dm)), 'Wq': _w((lambda *s: torch.randn(*s, dtype=torch.bfloat16) * 3.2)(Dm, H, Dh) * Dm ** (-0.5)), 'Wk': _w((lambda *s: torch.randn(*s, dtype=torch.bfloat16) * 3.2)(Dm, H, Dh) * Dm ** (-0.5)), 'Wv': _w((lambda *s: torch.randn(*s, dtype=torch.bfloat16) * 0.4)(Dm, H, Dh) * Dm ** (-0.5)), 'Wo': _w((lambda *s: torch.randn(*s, dtype=torch.bfloat16) * 0.4)(H, Dh, Dm) * (H * Dh) ** (-0.5)), 'seg_len': seg}
    _A_in = _A_setup()

    def _B_setup():
        B, S, D, F = (1, 2048, 512, 1376)
        return {'x': _w((lambda *s: torch.randn(*s, dtype=torch.bfloat16) * 0.05)(B, S, D)), 'w_gate': _w((lambda *s: torch.randn(*s, dtype=torch.bfloat16) * 0.05)(D, F)), 'w_up': _w((lambda *s: torch.randn(*s, dtype=torch.bfloat16) * 0.05)(D, F)), 'w_down': _w((lambda *s: torch.randn(*s, dtype=torch.bfloat16) * 0.05)(F, D))}
    _B_in = _B_setup()
    return {'A_x': _A_in['x'], 'A_mem0': _A_in['mem0'], 'A_Wq': _A_in['Wq'], 'A_Wk': _A_in['Wk'], 'A_Wv': _A_in['Wv'], 'A_Wo': _A_in['Wo'], 'A_seg_len': _A_in['seg_len'], 'B_x': _B_in['x'], 'B_w_gate': _B_in['w_gate'], 'B_w_up': _B_in['w_up'], 'B_w_down': _B_in['w_down'], 'c': _w((lambda *s: torch.randn(*s, dtype=torch.bfloat16) * 0.1)(1, 512) * 8.0), 'w_mod': _w((lambda *s: torch.randn(*s, dtype=torch.bfloat16) * 0.1)(512, 6 * 512) * 512 ** (-0.5) * 8.0)}

def reference(A_x, A_mem0, A_Wq, A_Wk, A_Wv, A_Wo, A_seg_len, B_x, B_w_gate, B_w_up, B_w_down, c, w_mod):

    def _A_ref(x, mem0, Wq, Wk, Wv, Wo, seg_len):
        B, S, Dm = x.shape
        H, Dh = (Wq.shape[1], Wq.shape[2])
        M = mem0.shape[1]
        scale = Dh ** (-0.5)
        n_seg = S // seg_len
        L = M + seg_len
        idx = torch.arange(L)
        mask = (idx[:, None] < M) | (idx[:, None] >= idx[None, :])
        mem = mem0
        outs = []
        for s in range(n_seg):
            xs = x[:, s * seg_len:(s + 1) * seg_len, :].clone()
            h = torch.concatenate([mem, xs], axis=1)
            q = torch.einsum('btd,dhe->bhte', h, Wq)
            k = torch.einsum('btd,dhe->bhte', h, Wk)
            v = torch.einsum('btd,dhe->bhte', h, Wv)
            scores = torch.einsum('bhqe,bhke->bhqk', q, k) * scale
            scores = torch.where(mask[None, None], scores, -1000000000.0)
            p = _softmax(scores, axis=-1)
            o = torch.einsum('bhqk,bhke->bhqe', p, v)
            o = torch.einsum('bhte,hed->btd', o, Wo)
            mem = o[:, :M, :].clone()
            outs.append(o[:, M:, :])
        return torch.concatenate(outs, axis=1)

    def _B_ref(x, w_gate, w_up, w_down):
        return _gelu(x @ w_gate) * (x @ w_up) @ w_down
    x = A_x
    mod = (_silu(c) @ w_mod).reshape(c.shape[0], 6, 1, -1)
    sa, ca, ga, sb, cb, gb = (mod[:, 0].clone(), mod[:, 1].clone(), mod[:, 2].clone(), mod[:, 3].clone(), mod[:, 4].clone(), mod[:, 5].clone())
    h = _layernorm(x, axis=-1) * (1 + ca) + sa
    x = x + ga * _A_ref(h, A_mem0, A_Wq, A_Wk, A_Wv, A_Wo, A_seg_len)
    h = _layernorm(x, axis=-1) * (1 + cb) + sb
    x = x + gb * _B_ref(h, B_w_gate, B_w_up, B_w_down)
    return x
```

```asm
; @launch grid=(256,1,1) block=(256,1,1) lds=163840
.amdgcn_target "amdgcn-amd-amdhsa--gfx950"
.text
.globl adaLN_cond__memory_aug_recurrent_mem_tr__geglu_ffn__prompt_kernel
.p2align 8
.type adaLN_cond__memory_aug_recurrent_mem_tr__geglu_ffn__prompt_kernel,@function
adaLN_cond__memory_aug_recurrent_mem_tr__geglu_ffn__prompt_kernel:
KSTART:
    s_cmp_ge_u32 s2, 256
    s_cbranch_scc1 m_exit
    s_load_dwordx4 s[96:99], s[0:1], 112
    s_getreg_b32 s3, hwreg(HW_REG_XCC_ID)
    s_and_b32 s3, s3, 7
    v_and_b32 v60, 63, v0
    v_lshrrev_b32 v61, 6, v0
    s_nop 0
    v_readfirstlane_b32 s21, v61
    s_waitcnt lgkmcnt(0)
    s_mov_b32 s8, s98
    s_and_b32 s9, s99, 0xffff
    s_mov_b32 s10, 0x10000000
    s_mov_b32 s11, 0x20000
    s_mov_b32 s16, s96
    s_and_b32 s17, s97, 0xffff
    s_mov_b32 s18, 0x100
    s_mov_b32 s19, 0x20000
    s_cmp_lg_u32 s21, 0
    s_cbranch_scc1 CW_3
    s_mov_b32 s4, s3
    s_mov_b32 s5, 0
    s_mov_b64 exec, 1
CL_1:
    v_mov_b32 v61, 1
    s_lshl_b32 s6, s4, 4
    s_cmp_eq_u32 s4, 0
    s_cselect_b32 s6, 224, s6
    buffer_atomic_add v61, off, s[16:19], s6 offset:0 sc0
    s_waitcnt vmcnt(0)
    v_readfirstlane_b32 s6, v61
    s_nop 0
    s_cmp_lt_u32 s6, 32
    s_cbranch_scc1 CD_2
    s_add_u32 s4, s4, 1
    s_and_b32 s4, s4, 7
    s_add_u32 s5, s5, 1
    s_cmp_lt_u32 s5, 8
    s_cbranch_scc1 CL_1
    s_mov_b32 s4, 8
CD_2:
    s_lshl_b32 s4, s4, 5
    s_add_u32 s4, s4, s6
    v_mov_b32 v61, s4
    v_mov_b32 v62, 0
    ds_write_b32 v62, v61
    s_mov_b64 exec, -1
    s_waitcnt lgkmcnt(0)
CW_3:
    s_barrier
    v_mov_b32 v62, 0
    ds_read_b32 v61, v62
    s_waitcnt lgkmcnt(0)
    v_readfirstlane_b32 s5, v61
    s_barrier
    s_cmp_ge_u32 s5, 256
    s_cbranch_scc1 m_exit
    s_lshr_b32 s4, s5, 5
    s_and_b32 s99, s5, 31
    s_cmp_lt_u32 s5, 32
    s_cbranch_scc1 m_team
    s_sub_u32 s5, s5, 32
    s_mul_i32 s20, s5, 9363
    s_lshr_b32 s20, s20, 16
    s_mul_i32 s40, s20, 7
    s_sub_u32 s6, s5, s40
    s_cmp_lt_u32 s6, 1
    s_cbranch_scc1 m_qkv
    s_cmp_lt_u32 s6, 3
    s_cbranch_scc1 m_pf
    s_cmp_ge_u32 s6, 5
    s_cbranch_scc1 m_ln
    s_sub_u32 s36, s6, 3
    s_lshl_b32 s36, s36, 5
    s_add_u32 s36, s36, s20
    s_load_dwordx4 s[84:87], s[0:1], 88
    s_lshl_b32 s39, s36, 4
    s_waitcnt lgkmcnt(0)
    s_mov_b32 s44, s84
    s_and_b32 s45, s85, 0xffff
    s_mov_b32 s46, 0x400
    s_mov_b32 s47, 0x20000
    s_mov_b32 s48, s86
    s_and_b32 s49, s87, 0xffff
    s_mov_b32 s50, 0x300000
    s_mov_b32 s51, 0x20000
    v_mov_b32 v7, 0
    v_and_b32 v6, 127, v0
    v_lshlrev_b32 v6, 2, v6
    s_lshl_b32 s37, s36, 9
    buffer_store_dword v7, v6, s[8:11], s37 offen sc1
    v_lshrrev_b32 v2, 1, v0
    v_mul_u32_u24 v3, 8, v2
    buffer_load_dwordx2 v[8:9], v3, s[44:47], 0 offen
    s_mov_b32 s37, 24576
    v_mul_lo_u32 v3, s37, v2
    v_and_b32 v4, 1, v0
    v_lshlrev_b32 v4, 4, v4
    v_add_u32 v3, v3, v4
    s_lshl_b32 s37, s39, 1
    buffer_load_dwordx4 v[64:67], v3, s[48:51], s37 offen
    s_add_u32 s37, s37, 6144
    buffer_load_dwordx4 v[68:71], v3, s[48:51], s37 offen
    s_add_u32 s37, s37, 6144
    buffer_load_dwordx4 v[72:75], v3, s[48:51], s37 offen
    s_add_u32 s37, s37, 6144
    buffer_load_dwordx4 v[76:79], v3, s[48:51], s37 offen
    s_add_u32 s37, s37, 6144
    s_waitcnt vmcnt(4)
    v_and_b32 v17, 0xffff0000, v8
    v_lshlrev_b32 v16, 16, v8
    v_and_b32 v19, 0xffff0000, v9
    v_lshlrev_b32 v18, 16, v9
    s_mov_b32 s38, 0xbfb8aa3b
    v_mul_f32 v32, s38, v16
    v_mul_f32 v33, s38, v17
    v_mul_f32 v34, s38, v18
    v_mul_f32 v35, s38, v19
    v_exp_f32 v32, v32
    v_exp_f32 v33, v33
    v_exp_f32 v34, v34
    v_exp_f32 v35, v35
    v_add_f32 v32, 1.0, v32
    v_add_f32 v33, 1.0, v33
    v_add_f32 v34, 1.0, v34
    v_add_f32 v35, 1.0, v35
    v_rcp_f32 v32, v32
    v_rcp_f32 v33, v33
    v_rcp_f32 v34, v34
    v_rcp_f32 v35, v35
    s_nop 0
    v_mul_f32 v16, v16, v32
    v_mul_f32 v17, v17, v33
    v_mul_f32 v18, v18, v34
    v_mul_f32 v19, v19, v35
    v_cvt_pk_bf16_f32 v8, v16, v17
    v_cvt_pk_bf16_f32 v9, v18, v19
    v_and_b32 v17, 0xffff0000, v8
    v_lshlrev_b32 v16, 16, v8
    v_and_b32 v19, 0xffff0000, v9
    v_lshlrev_b32 v18, 16, v9
    s_waitcnt vmcnt(3)
    v_and_b32 v41, 0xffff0000, v64
    v_lshlrev_b32 v40, 16, v64
    v_and_b32 v43, 0xffff0000, v65
    v_lshlrev_b32 v42, 16, v65
    v_and_b32 v45, 0xffff0000, v66
    v_lshlrev_b32 v44, 16, v66
    v_and_b32 v47, 0xffff0000, v67
    v_lshlrev_b32 v46, 16, v67
    v_mul_f32 v32, v16, v40
    v_mul_f32 v33, v16, v41
    v_mul_f32 v34, v16, v42
    v_mul_f32 v35, v16, v43
    v_mul_f32 v36, v16, v44
    v_mul_f32 v37, v16, v45
    v_mul_f32 v38, v16, v46
    v_mul_f32 v39, v16, v47
    s_waitcnt vmcnt(2)
    v_and_b32 v41, 0xffff0000, v68
    v_lshlrev_b32 v40, 16, v68
    v_and_b32 v43, 0xffff0000, v69
    v_lshlrev_b32 v42, 16, v69
    v_and_b32 v45, 0xffff0000, v70
    v_lshlrev_b32 v44, 16, v70
    v_and_b32 v47, 0xffff0000, v71
    v_lshlrev_b32 v46, 16, v71
    v_fmac_f32 v32, v17, v40
    v_fmac_f32 v33, v17, v41
    v_fmac_f32 v34, v17, v42
    v_fmac_f32 v35, v17, v43
    v_fmac_f32 v36, v17, v44
    v_fmac_f32 v37, v17, v45
    v_fmac_f32 v38, v17, v46
    v_fmac_f32 v39, v17, v47
    s_waitcnt vmcnt(1)
    v_and_b32 v41, 0xffff0000, v72
    v_lshlrev_b32 v40, 16, v72
    v_and_b32 v43, 0xffff0000, v73
    v_lshlrev_b32 v42, 16, v73
    v_and_b32 v45, 0xffff0000, v74
    v_lshlrev_b32 v44, 16, v74
    v_and_b32 v47, 0xffff0000, v75
    v_lshlrev_b32 v46, 16, v75
    v_fmac_f32 v32, v18, v40
    v_fmac_f32 v33, v18, v41
    v_fmac_f32 v34, v18, v42
    v_fmac_f32 v35, v18, v43
    v_fmac_f32 v36, v18, v44
    v_fmac_f32 v37, v18, v45
    v_fmac_f32 v38, v18, v46
    v_fmac_f32 v39, v18, v47
    s_waitcnt vmcnt(0)
    v_and_b32 v41, 0xffff0000, v76
    v_lshlrev_b32 v40, 16, v76
    v_and_b32 v43, 0xffff0000, v77
    v_lshlrev_b32 v42, 16, v77
    v_and_b32 v45, 0xffff0000, v78
    v_lshlrev_b32 v44, 16, v78
    v_and_b32 v47, 0xffff0000, v79
    v_lshlrev_b32 v46, 16, v79
    v_fmac_f32 v32, v19, v40
    v_fmac_f32 v33, v19, v41
    v_fmac_f32 v34, v19, v42
    v_fmac_f32 v35, v19, v43
    v_fmac_f32 v36, v19, v44
    v_fmac_f32 v37, v19, v45
    v_fmac_f32 v38, v19, v46
    v_fmac_f32 v39, v19, v47
    v_lshlrev_b32 v2, 5, v0
    ds_write_b128 v2, v[32:35]
    ds_write_b128 v2, v[36:39] offset:16
    s_waitcnt lgkmcnt(0)
    s_barrier
    s_cmp_lg_u32 s21, 0
    s_cbranch_scc1 NM_4
    v_lshlrev_b32 v2, 2, v0
    ds_read_b32 v64, v2 offset:0
    ds_read_b32 v65, v2 offset:256
    ds_read_b32 v66, v2 offset:512
    ds_read_b32 v67, v2 offset:768
    ds_read_b32 v68, v2 offset:1024
    ds_read_b32 v69, v2 offset:1280
    ds_read_b32 v70, v2 offset:1536
    ds_read_b32 v71, v2 offset:1792
    ds_read_b32 v72, v2 offset:2048
    ds_read_b32 v73, v2 offset:2304
    ds_read_b32 v74, v2 offset:2560
    ds_read_b32 v75, v2 offset:2816
    ds_read_b32 v76, v2 offset:3072
    ds_read_b32 v77, v2 offset:3328
    ds_read_b32 v78, v2 offset:3584
    ds_read_b32 v79, v2 offset:3840
    ds_read_b32 v80, v2 offset:4096
    ds_read_b32 v81, v2 offset:4352
    ds_read_b32 v82, v2 offset:4608
    ds_read_b32 v83, v2 offset:4864
    ds_read_b32 v84, v2 offset:5120
    ds_read_b32 v85, v2 offset:5376
    ds_read_b32 v86, v2 offset:5632
    ds_read_b32 v87, v2 offset:5888
    ds_read_b32 v88, v2 offset:6144
    ds_read_b32 v89, v2 offset:6400
    ds_read_b32 v90, v2 offset:6656
    ds_read_b32 v91, v2 offset:6912
    ds_read_b32 v92, v2 offset:7168
    ds_read_b32 v93, v2 offset:7424
    ds_read_b32 v94, v2 offset:7680
    ds_read_b32 v95, v2 offset:7936
    s_waitcnt lgkmcnt(0)
    v_add_f32 v64, v64, v80
    v_add_f32 v65, v65, v81
    v_add_f32 v66, v66, v82
    v_add_f32 v67, v67, v83
    v_add_f32 v68, v68, v84
    v_add_f32 v69, v69, v85
    v_add_f32 v70, v70, v86
    v_add_f32 v71, v71, v87
    v_add_f32 v72, v72, v88
    v_add_f32 v73, v73, v89
    v_add_f32 v74, v74, v90
    v_add_f32 v75, v75, v91
    v_add_f32 v76, v76, v92
    v_add_f32 v77, v77, v93
    v_add_f32 v78, v78, v94
    v_add_f32 v79, v79, v95
    v_add_f32 v64, v64, v72
    v_add_f32 v65, v65, v73
    v_add_f32 v66, v66, v74
    v_add_f32 v67, v67, v75
    v_add_f32 v68, v68, v76
    v_add_f32 v69, v69, v77
    v_add_f32 v70, v70, v78
    v_add_f32 v71, v71, v79
    v_add_f32 v64, v64, v68
    v_add_f32 v65, v65, v69
    v_add_f32 v66, v66, v70
    v_add_f32 v67, v67, v71
    v_add_f32 v64, v64, v66
    v_add_f32 v65, v65, v67
    v_add_f32 v64, v64, v65
    v_mov_b32 v65, v64
    s_nop 1
    v_permlane32_swap_b32 v64, v65
    v_add_f32 v64, v64, v65
    v_mov_b32 v65, v64
    s_nop 1
    v_permlane16_swap_b32 v64, v65
    v_add_f32 v64, v64, v65
    v_cvt_pk_bf16_f32 v64, v64, v64
    v_lshlrev_b32 v64, 16, v64
    s_lshr_b32 s37, s39, 9
    s_cmp_eq_u32 s37, 1
    s_cselect_b32 s38, 1.0, 0
    s_cmp_eq_u32 s37, 4
    s_cselect_b32 s38, 1.0, s38
    v_add_f32 v64, s38, v64
    v_cvt_pk_bf16_f32 v64, v64, v64
    v_lshlrev_b32 v64, 16, v64
    v_and_b32 v2, 63, v2
    s_lshl_b32 s37, s39, 2
    s_add_u32 s37, s37, 65536
    buffer_store_dword v64, v2, s[8:11], s37 offen sc1
NM_4:
    s_waitcnt vmcnt(0)
    s_barrier
    s_cmp_lg_u32 s21, 0
    s_cbranch_scc1 SG_5
    v_mov_b32 v61, 1
    s_mov_b64 exec, 1
    buffer_atomic_add v61, off, s[16:19], 0 offset:36 sc0
    s_waitcnt vmcnt(0)
    v_readfirstlane_b32 s40, v61
    s_mov_b64 exec, -1
    s_cmp_lg_u32 s40, 63
    s_cbranch_scc1 SG_5
    buffer_store_dword v61, off, s[16:19], 0 offset:164 sc1
SG_5:
m_ln:
    s_load_dwordx2 s[84:85], s[0:1], 0
    s_lshl_b32 s36, s20, 2
    s_add_u32 s36, s36, s6
    s_sub_u32 s36, s36, 3
    v_lshlrev_b32 v1, 4, v60
    s_lshl_b32 s37, s36, 14
    s_lshl_b32 s38, s21, 12
    s_add_u32 s37, s37, s38
    s_waitcnt lgkmcnt(0)
    s_mov_b32 s44, s84
    s_and_b32 s45, s85, 0xffff
    s_mov_b32 s46, 0x200000
    s_mov_b32 s47, 0x20000
    buffer_load_dwordx4 v[8:11], v1, s[44:47], s37 offen offset:0
    buffer_load_dwordx4 v[12:15], v1, s[44:47], s37 offen offset:1024
    buffer_load_dwordx4 v[16:19], v1, s[44:47], s37 offen offset:2048
    buffer_load_dwordx4 v[20:23], v1, s[44:47], s37 offen offset:3072
    s_cmp_lt_u32 s6, 5
    s_cbranch_scc1 NPF_6
    s_load_dwordx8 s[88:95], s[0:1], 16
    s_cmp_lt_u32 s6, 3
    s_cselect_b32 s56, 1, 3
    s_sub_u32 s56, s6, s56
    s_lshl_b32 s56, s56, 5
    s_add_u32 s56, s56, s20
    s_lshl_b32 s56, s56, 15
    v_lshlrev_b32 v59, 4, v0
    s_waitcnt lgkmcnt(0)
    s_mov_b32 s52, s88
    s_and_b32 s53, s89, 0xffff
    s_mov_b32 s54, 0x400000
    s_mov_b32 s55, 0x20000
    s_mov_b32 s57, s56
    buffer_load_dwordx4 a[0:3], v59, s[52:55], s57 offen
    s_add_u32 s57, s57, 4096
    buffer_load_dwordx4 a[4:7], v59, s[52:55], s57 offen
    s_add_u32 s57, s57, 4096
    buffer_load_dwordx4 a[8:11], v59, s[52:55], s57 offen
    s_add_u32 s57, s57, 4096
    buffer_load_dwordx4 a[12:15], v59, s[52:55], s57 offen
    s_add_u32 s57, s57, 4096
    buffer_load_dwordx4 a[16:19], v59, s[52:55], s57 offen
    s_add_u32 s57, s57, 4096
    buffer_load_dwordx4 a[20:23], v59, s[52:55], s57 offen
    s_add_u32 s57, s57, 4096
    buffer_load_dwordx4 a[24:27], v59, s[52:55], s57 offen
    s_add_u32 s57, s57, 4096
    buffer_load_dwordx4 a[28:31], v59, s[52:55], s57 offen
    s_add_u32 s57, s57, 4096
    s_mov_b32 s52, s90
    s_and_b32 s53, s91, 0xffff
    s_mov_b32 s54, 0x400000
    s_mov_b32 s55, 0x20000
    s_mov_b32 s57, s56
    buffer_load_dwordx4 a[32:35], v59, s[52:55], s57 offen
    s_add_u32 s57, s57, 4096
    buffer_load_dwordx4 a[36:39], v59, s[52:55], s57 offen
    s_add_u32 s57, s57, 4096
    buffer_load_dwordx4 a[40:43], v59, s[52:55], s57 offen
    s_add_u32 s57, s57, 4096
    buffer_load_dwordx4 a[44:47], v59, s[52:55], s57 offen
    s_add_u32 s57, s57, 4096
    buffer_load_dwordx4 a[48:51], v59, s[52:55], s57 offen
    s_add_u32 s57, s57, 4096
    buffer_load_dwordx4 a[52:55], v59, s[52:55], s57 offen
    s_add_u32 s57, s57, 4096
    buffer_load_dwordx4 a[56:59], v59, s[52:55], s57 offen
    s_add_u32 s57, s57, 4096
    buffer_load_dwordx4 a[60:63], v59, s[52:55], s57 offen
    s_add_u32 s57, s57, 4096
    s_mov_b32 s52, s92
    s_and_b32 s53, s93, 0xffff
    s_mov_b32 s54, 0x400000
    s_mov_b32 s55, 0x20000
    s_mov_b32 s57, s56
    buffer_load_dwordx4 a[64:67], v59, s[52:55], s57 offen
    s_add_u32 s57, s57, 4096
    buffer_load_dwordx4 a[68:71], v59, s[52:55], s57 offen
    s_add_u32 s57, s57, 4096
    buffer_load_dwordx4 a[72:75], v59, s[52:55], s57 offen
    s_add_u32 s57, s57, 4096
    buffer_load_dwordx4 a[76:79], v59, s[52:55], s57 offen
    s_add_u32 s57, s57, 4096
    buffer_load_dwordx4 a[80:83], v59, s[52:55], s57 offen
    s_add_u32 s57, s57, 4096
    buffer_load_dwordx4 a[84:87], v59, s[52:55], s57 offen
    s_add_u32 s57, s57, 4096
    buffer_load_dwordx4 a[88:91], v59, s[52:55], s57 offen
    s_add_u32 s57, s57, 4096
    buffer_load_dwordx4 a[92:95], v59, s[52:55], s57 offen
    s_add_u32 s57, s57, 4096
    s_mov_b32 s52, s94
    s_and_b32 s53, s95, 0xffff
    s_mov_b32 s54, 0x400000
    s_mov_b32 s55, 0x20000
    s_mov_b32 s57, s56
    buffer_load_dwordx4 a[96:99], v59, s[52:55], s57 offen
    s_add_u32 s57, s57, 4096
    buffer_load_dwordx4 a[100:103], v59, s[52:55], s57 offen
    s_add_u32 s57, s57, 4096
    buffer_load_dwordx4 a[104:107], v59, s[52:55], s57 offen
    s_add_u32 s57, s57, 4096
    buffer_load_dwordx4 a[108:111], v59, s[52:55], s57 offen
    s_add_u32 s57, s57, 4096
    buffer_load_dwordx4 a[112:115], v59, s[52:55], s57 offen
    s_add_u32 s57, s57, 4096
    buffer_load_dwordx4 a[116:119], v59, s[52:55], s57 offen
    s_add_u32 s57, s57, 4096
    buffer_load_dwordx4 a[120:123], v59, s[52:55], s57 offen
    s_add_u32 s57, s57, 4096
    buffer_load_dwordx4 a[124:127], v59, s[52:55], s57 offen
    s_add_u32 s57, s57, 4096
    s_waitcnt vmcnt(32)
    s_branch JPF_7
NPF_6:
    s_waitcnt vmcnt(0)
JPF_7:
    v_and_b32 v65, 0xffff0000, v8
    v_lshlrev_b32 v64, 16, v8
    v_and_b32 v67, 0xffff0000, v9
    v_lshlrev_b32 v66, 16, v9
    v_and_b32 v69, 0xffff0000, v10
    v_lshlrev_b32 v68, 16, v10
    v_and_b32 v71, 0xffff0000, v11
    v_lshlrev_b32 v70, 16, v11
    v_and_b32 v73, 0xffff0000, v12
    v_lshlrev_b32 v72, 16, v12
    v_and_b32 v75, 0xffff0000, v13
    v_lshlrev_b32 v74, 16, v13
    v_and_b32 v77, 0xffff0000, v14
    v_lshlrev_b32 v76, 16, v14
    v_and_b32 v79, 0xffff0000, v15
    v_lshlrev_b32 v78, 16, v15
    v_and_b32 v81, 0xffff0000, v16
    v_lshlrev_b32 v80, 16, v16
    v_and_b32 v83, 0xffff0000, v17
    v_lshlrev_b32 v82, 16, v17
    v_and_b32 v85, 0xffff0000, v18
    v_lshlrev_b32 v84, 16, v18
    v_and_b32 v87, 0xffff0000, v19
    v_lshlrev_b32 v86, 16, v19
    v_and_b32 v89, 0xffff0000, v20
    v_lshlrev_b32 v88, 16, v20
    v_and_b32 v91, 0xffff0000, v21
    v_lshlrev_b32 v90, 16, v21
    v_and_b32 v93, 0xffff0000, v22
    v_lshlrev_b32 v92, 16, v22
    v_and_b32 v95, 0xffff0000, v23
    v_lshlrev_b32 v94, 16, v23
    v_add_f32 v24, v64, v65
    v_add_f32 v24, v24, v66
    v_add_f32 v24, v24, v67
    v_add_f32 v24, v24, v68
    v_add_f32 v24, v24, v69
    v_add_f32 v24, v24, v70
    v_add_f32 v24, v24, v71
    v_add_f32 v25, v72, v73
    v_add_f32 v25, v25, v74
    v_add_f32 v25, v25, v75
    v_add_f32 v25, v25, v76
    v_add_f32 v25, v25, v77
    v_add_f32 v25, v25, v78
    v_add_f32 v25, v25, v79
    v_add_f32 v26, v80, v81
    v_add_f32 v26, v26, v82
    v_add_f32 v26, v26, v83
    v_add_f32 v26, v26, v84
    v_add_f32 v26, v26, v85
    v_add_f32 v26, v26, v86
    v_add_f32 v26, v26, v87
    v_add_f32 v27, v88, v89
    v_add_f32 v27, v27, v90
    v_add_f32 v27, v27, v91
    v_add_f32 v27, v27, v92
    v_add_f32 v27, v27, v93
    v_add_f32 v27, v27, v94
    v_add_f32 v27, v27, v95
    v_add_f32_dpp v24, v24, v24 row_ror:1 row_mask:0xf bank_mask:0xf
    v_add_f32_dpp v25, v25, v25 row_ror:1 row_mask:0xf bank_mask:0xf
    v_add_f32_dpp v26, v26, v26 row_ror:1 row_mask:0xf bank_mask:0xf
    v_add_f32_dpp v27, v27, v27 row_ror:1 row_mask:0xf bank_mask:0xf
    v_add_f32_dpp v24, v24, v24 row_ror:2 row_mask:0xf bank_mask:0xf
    v_add_f32_dpp v25, v25, v25 row_ror:2 row_mask:0xf bank_mask:0xf
    v_add_f32_dpp v26, v26, v26 row_ror:2 row_mask:0xf bank_mask:0xf
    v_add_f32_dpp v27, v27, v27 row_ror:2 row_mask:0xf bank_mask:0xf
    v_add_f32_dpp v24, v24, v24 row_ror:4 row_mask:0xf bank_mask:0xf
    v_add_f32_dpp v25, v25, v25 row_ror:4 row_mask:0xf bank_mask:0xf
    v_add_f32_dpp v26, v26, v26 row_ror:4 row_mask:0xf bank_mask:0xf
    v_add_f32_dpp v27, v27, v27 row_ror:4 row_mask:0xf bank_mask:0xf
    v_add_f32_dpp v24, v24, v24 row_ror:8 row_mask:0xf bank_mask:0xf
    v_add_f32_dpp v25, v25, v25 row_ror:8 row_mask:0xf bank_mask:0xf
    v_add_f32_dpp v26, v26, v26 row_ror:8 row_mask:0xf bank_mask:0xf
    v_add_f32_dpp v27, v27, v27 row_ror:8 row_mask:0xf bank_mask:0xf
    v_mov_b32 v28, v24
    v_mov_b32 v29, v25
    v_mov_b32 v30, v26
    v_mov_b32 v31, v27
    v_permlane16_swap_b32 v24, v28
    v_permlane16_swap_b32 v25, v29
    v_permlane16_swap_b32 v26, v30
    v_permlane16_swap_b32 v27, v31
    v_add_f32 v24, v24, v28
    v_add_f32 v25, v25, v29
    v_add_f32 v26, v26, v30
    v_add_f32 v27, v27, v31
    v_mov_b32 v28, v24
    v_mov_b32 v29, v25
    v_mov_b32 v30, v26
    v_mov_b32 v31, v27
    v_permlane32_swap_b32 v24, v28
    v_permlane32_swap_b32 v25, v29
    v_permlane32_swap_b32 v26, v30
    v_permlane32_swap_b32 v27, v31
    v_add_f32 v24, v24, v28
    v_add_f32 v25, v25, v29
    v_add_f32 v26, v26, v30
    v_add_f32 v27, v27, v31
    s_mov_b32 s38, 0x3b000000
    v_mul_f32 v24, s38, v24
    v_mul_f32 v25, s38, v25
    v_mul_f32 v26, s38, v26
    v_mul_f32 v27, s38, v27
    v_sub_f32 v96, v64, v24
    v_sub_f32 v97, v65, v24
    v_sub_f32 v98, v66, v24
    v_sub_f32 v99, v67, v24
    v_sub_f32 v100, v68, v24
    v_sub_f32 v101, v69, v24
    v_sub_f32 v102, v70, v24
    v_sub_f32 v103, v71, v24
    v_sub_f32 v104, v72, v25
    v_sub_f32 v105, v73, v25
    v_sub_f32 v106, v74, v25
    v_sub_f32 v107, v75, v25
    v_sub_f32 v108, v76, v25
    v_sub_f32 v109, v77, v25
    v_sub_f32 v110, v78, v25
    v_sub_f32 v111, v79, v25
    v_sub_f32 v112, v80, v26
    v_sub_f32 v113, v81, v26
    v_sub_f32 v114, v82, v26
    v_sub_f32 v115, v83, v26
    v_sub_f32 v116, v84, v26
    v_sub_f32 v117, v85, v26
    v_sub_f32 v118, v86, v26
    v_sub_f32 v119, v87, v26
    v_sub_f32 v120, v88, v27
    v_sub_f32 v121, v89, v27
    v_sub_f32 v122, v90, v27
    v_sub_f32 v123, v91, v27
    v_sub_f32 v124, v92, v27
    v_sub_f32 v125, v93, v27
    v_sub_f32 v126, v94, v27
    v_sub_f32 v127, v95, v27
    v_mul_f32 v32, v96, v96
    v_fmac_f32 v32, v97, v97
    v_fmac_f32 v32, v98, v98
    v_fmac_f32 v32, v99, v99
    v_fmac_f32 v32, v100, v100
    v_fmac_f32 v32, v101, v101
    v_fmac_f32 v32, v102, v102
    v_fmac_f32 v32, v103, v103
    v_mul_f32 v33, v104, v104
    v_fmac_f32 v33, v105, v105
    v_fmac_f32 v33, v106, v106
    v_fmac_f32 v33, v107, v107
    v_fmac_f32 v33, v108, v108
    v_fmac_f32 v33, v109, v109
    v_fmac_f32 v33, v110, v110
    v_fmac_f32 v33, v111, v111
    v_mul_f32 v34, v112, v112
    v_fmac_f32 v34, v113, v113
    v_fmac_f32 v34, v114, v114
    v_fmac_f32 v34, v115, v115
    v_fmac_f32 v34, v116, v116
    v_fmac_f32 v34, v117, v117
    v_fmac_f32 v34, v118, v118
    v_fmac_f32 v34, v119, v119
    v_mul_f32 v35, v120, v120
    v_fmac_f32 v35, v121, v121
    v_fmac_f32 v35, v122, v122
    v_fmac_f32 v35, v123, v123
    v_fmac_f32 v35, v124, v124
    v_fmac_f32 v35, v125, v125
    v_fmac_f32 v35, v126, v126
    v_fmac_f32 v35, v127, v127
    v_add_f32_dpp v32, v32, v32 row_ror:1 row_mask:0xf bank_mask:0xf
    v_add_f32_dpp v33, v33, v33 row_ror:1 row_mask:0xf bank_mask:0xf
    v_add_f32_dpp v34, v34, v34 row_ror:1 row_mask:0xf bank_mask:0xf
    v_add_f32_dpp v35, v35, v35 row_ror:1 row_mask:0xf bank_mask:0xf
    v_add_f32_dpp v32, v32, v32 row_ror:2 row_mask:0xf bank_mask:0xf
    v_add_f32_dpp v33, v33, v33 row_ror:2 row_mask:0xf bank_mask:0xf
    v_add_f32_dpp v34, v34, v34 row_ror:2 row_mask:0xf bank_mask:0xf
    v_add_f32_dpp v35, v35, v35 row_ror:2 row_mask:0xf bank_mask:0xf
    v_add_f32_dpp v32, v32, v32 row_ror:4 row_mask:0xf bank_mask:0xf
    v_add_f32_dpp v33, v33, v33 row_ror:4 row_mask:0xf bank_mask:0xf
    v_add_f32_dpp v34, v34, v34 row_ror:4 row_mask:0xf bank_mask:0xf
    v_add_f32_dpp v35, v35, v35 row_ror:4 row_mask:0xf bank_mask:0xf
    v_add_f32_dpp v32, v32, v32 row_ror:8 row_mask:0xf bank_mask:0xf
    v_add_f32_dpp v33, v33, v33 row_ror:8 row_mask:0xf bank_mask:0xf
    v_add_f32_dpp v34, v34, v34 row_ror:8 row_mask:0xf bank_mask:0xf
    v_add_f32_dpp v35, v35, v35 row_ror:8 row_mask:0xf bank_mask:0xf
    v_mov_b32 v28, v32
    v_mov_b32 v29, v33
    v_mov_b32 v30, v34
    v_mov_b32 v31, v35
    v_permlane16_swap_b32 v32, v28
    v_permlane16_swap_b32 v33, v29
    v_permlane16_swap_b32 v34, v30
    v_permlane16_swap_b32 v35, v31
    v_add_f32 v32, v32, v28
    v_add_f32 v33, v33, v29
    v_add_f32 v34, v34, v30
    v_add_f32 v35, v35, v31
    v_mov_b32 v28, v32
    v_mov_b32 v29, v33
    v_mov_b32 v30, v34
    v_mov_b32 v31, v35
    v_permlane32_swap_b32 v32, v28
    v_permlane32_swap_b32 v33, v29
    v_permlane32_swap_b32 v34, v30
    v_permlane32_swap_b32 v35, v31
    v_add_f32 v32, v32, v28
    v_add_f32 v33, v33, v29
    v_add_f32 v34, v34, v30
    v_add_f32 v35, v35, v31
    v_mul_f32 v32, s38, v32
    v_mul_f32 v33, s38, v33
    v_mul_f32 v34, s38, v34
    v_mul_f32 v35, s38, v35
    v_cvt_pk_bf16_f32 v24, v24, v25
    v_cvt_pk_bf16_f32 v26, v26, v27
    v_cvt_pk_bf16_f32 v32, v32, v33
    v_cvt_pk_bf16_f32 v34, v34, v35
    v_and_b32 v25, 0xffff0000, v24
    v_lshlrev_b32 v24, 16, v24
    v_and_b32 v27, 0xffff0000, v26
    v_lshlrev_b32 v26, 16, v26
    v_and_b32 v33, 0xffff0000, v32
    v_lshlrev_b32 v32, 16, v32
    v_and_b32 v35, 0xffff0000, v34
    v_lshlrev_b32 v34, 16, v34
    v_add_f32 v32, 0x3727c5ac, v32
    v_add_f32 v33, 0x3727c5ac, v33
    v_add_f32 v34, 0x3727c5ac, v34
    v_add_f32 v35, 0x3727c5ac, v35
    v_cvt_pk_bf16_f32 v32, v32, v33
    v_cvt_pk_bf16_f32 v34, v34, v35
    v_and_b32 v33, 0xffff0000, v32
    v_lshlrev_b32 v32, 16, v32
    v_and_b32 v35, 0xffff0000, v34
    v_lshlrev_b32 v34, 16, v34
    v_sqrt_f32 v32, v32
    v_sqrt_f32 v33, v33
    v_sqrt_f32 v34, v34
    v_sqrt_f32 v35, v35
    v_cvt_pk_bf16_f32 v32, v32, v33
    v_cvt_pk_bf16_f32 v34, v34, v35
    v_and_b32 v33, 0xffff0000, v32
    v_lshlrev_b32 v32, 16, v32
    v_and_b32 v35, 0xffff0000, v34
    v_lshlrev_b32 v34, 16, v34
    v_rcp_f32 v32, v32
    v_rcp_f32 v33, v33
    v_rcp_f32 v34, v34
    v_rcp_f32 v35, v35
    v_sub_f32 v64, v64, v24
    v_sub_f32 v65, v65, v24
    v_sub_f32 v66, v66, v24
    v_sub_f32 v67, v67, v24
    v_sub_f32 v68, v68, v24
    v_sub_f32 v69, v69, v24
    v_sub_f32 v70, v70, v24
    v_sub_f32 v71, v71, v24
    v_sub_f32 v72, v72, v25
    v_sub_f32 v73, v73, v25
    v_sub_f32 v74, v74, v25
    v_sub_f32 v75, v75, v25
    v_sub_f32 v76, v76, v25
    v_sub_f32 v77, v77, v25
    v_sub_f32 v78, v78, v25
    v_sub_f32 v79, v79, v25
    v_sub_f32 v80, v80, v26
    v_sub_f32 v81, v81, v26
    v_sub_f32 v82, v82, v26
    v_sub_f32 v83, v83, v26
    v_sub_f32 v84, v84, v26
    v_sub_f32 v85, v85, v26
    v_sub_f32 v86, v86, v26
    v_sub_f32 v87, v87, v26
    v_sub_f32 v88, v88, v27
    v_sub_f32 v89, v89, v27
    v_sub_f32 v90, v90, v27
    v_sub_f32 v91, v91, v27
    v_sub_f32 v92, v92, v27
    v_sub_f32 v93, v93, v27
    v_sub_f32 v94, v94, v27
    v_sub_f32 v95, v95, v27
    v_cvt_pk_bf16_f32 v64, v64, v65
    v_cvt_pk_bf16_f32 v66, v66, v67
    v_cvt_pk_bf16_f32 v68, v68, v69
    v_cvt_pk_bf16_f32 v70, v70, v71
    v_cvt_pk_bf16_f32 v72, v72, v73
    v_cvt_pk_bf16_f32 v74, v74, v75
    v_cvt_pk_bf16_f32 v76, v76, v77
    v_cvt_pk_bf16_f32 v78, v78, v79
    v_cvt_pk_bf16_f32 v80, v80, v81
    v_cvt_pk_bf16_f32 v82, v82, v83
    v_cvt_pk_bf16_f32 v84, v84, v85
    v_cvt_pk_bf16_f32 v86, v86, v87
    v_cvt_pk_bf16_f32 v88, v88, v89
    v_cvt_pk_bf16_f32 v90, v90, v91
    v_cvt_pk_bf16_f32 v92, v92, v93
    v_cvt_pk_bf16_f32 v94, v94, v95
    v_and_b32 v65, 0xffff0000, v64
    v_lshlrev_b32 v64, 16, v64
    v_and_b32 v67, 0xffff0000, v66
    v_lshlrev_b32 v66, 16, v66
    v_and_b32 v69, 0xffff0000, v68
    v_lshlrev_b32 v68, 16, v68
    v_and_b32 v71, 0xffff0000, v70
    v_lshlrev_b32 v70, 16, v70
    v_and_b32 v73, 0xffff0000, v72
    v_lshlrev_b32 v72, 16, v72
    v_and_b32 v75, 0xffff0000, v74
    v_lshlrev_b32 v74, 16, v74
    v_and_b32 v77, 0xffff0000, v76
    v_lshlrev_b32 v76, 16, v76
    v_and_b32 v79, 0xffff0000, v78
    v_lshlrev_b32 v78, 16, v78
    v_and_b32 v81, 0xffff0000, v80
    v_lshlrev_b32 v80, 16, v80
    v_and_b32 v83, 0xffff0000, v82
    v_lshlrev_b32 v82, 16, v82
    v_and_b32 v85, 0xffff0000, v84
    v_lshlrev_b32 v84, 16, v84
    v_and_b32 v87, 0xffff0000, v86
    v_lshlrev_b32 v86, 16, v86
    v_and_b32 v89, 0xffff0000, v88
    v_lshlrev_b32 v88, 16, v88
    v_and_b32 v91, 0xffff0000, v90
    v_lshlrev_b32 v90, 16, v90
    v_and_b32 v93, 0xffff0000, v92
    v_lshlrev_b32 v92, 16, v92
    v_and_b32 v95, 0xffff0000, v94
    v_lshlrev_b32 v94, 16, v94
    v_mul_f32 v64, v64, v32
    v_mul_f32 v65, v65, v32
    v_mul_f32 v66, v66, v32
    v_mul_f32 v67, v67, v32
    v_mul_f32 v68, v68, v32
    v_mul_f32 v69, v69, v32
    v_mul_f32 v70, v70, v32
    v_mul_f32 v71, v71, v32
    v_mul_f32 v72, v72, v33
    v_mul_f32 v73, v73, v33
    v_mul_f32 v74, v74, v33
    v_mul_f32 v75, v75, v33
    v_mul_f32 v76, v76, v33
    v_mul_f32 v77, v77, v33
    v_mul_f32 v78, v78, v33
    v_mul_f32 v79, v79, v33
    v_mul_f32 v80, v80, v34
    v_mul_f32 v81, v81, v34
    v_mul_f32 v82, v82, v34
    v_mul_f32 v83, v83, v34
    v_mul_f32 v84, v84, v34
    v_mul_f32 v85, v85, v34
    v_mul_f32 v86, v86, v34
    v_mul_f32 v87, v87, v34
    v_mul_f32 v88, v88, v35
    v_mul_f32 v89, v89, v35
    v_mul_f32 v90, v90, v35
    v_mul_f32 v91, v91, v35
    v_mul_f32 v92, v92, v35
    v_mul_f32 v93, v93, v35
    v_mul_f32 v94, v94, v35
    v_mul_f32 v95, v95, v35
    v_cvt_pk_bf16_f32 v64, v64, v65
    v_cvt_pk_bf16_f32 v66, v66, v67
    v_cvt_pk_bf16_f32 v68, v68, v69
    v_cvt_pk_bf16_f32 v70, v70, v71
    v_cvt_pk_bf16_f32 v72, v72, v73
    v_cvt_pk_bf16_f32 v74, v74, v75
    v_cvt_pk_bf16_f32 v76, v76, v77
    v_cvt_pk_bf16_f32 v78, v78, v79
    v_cvt_pk_bf16_f32 v80, v80, v81
    v_cvt_pk_bf16_f32 v82, v82, v83
    v_cvt_pk_bf16_f32 v84, v84, v85
    v_cvt_pk_bf16_f32 v86, v86, v87
    v_cvt_pk_bf16_f32 v88, v88, v89
    v_cvt_pk_bf16_f32 v90, v90, v91
    v_cvt_pk_bf16_f32 v92, v92, v93
    v_cvt_pk_bf16_f32 v94, v94, v95
    v_and_b32 v65, 0xffff0000, v64
    v_lshlrev_b32 v64, 16, v64
    v_and_b32 v67, 0xffff0000, v66
    v_lshlrev_b32 v66, 16, v66
    v_and_b32 v69, 0xffff0000, v68
    v_lshlrev_b32 v68, 16, v68
    v_and_b32 v71, 0xffff0000, v70
    v_lshlrev_b32 v70, 16, v70
    v_and_b32 v73, 0xffff0000, v72
    v_lshlrev_b32 v72, 16, v72
    v_and_b32 v75, 0xffff0000, v74
    v_lshlrev_b32 v74, 16, v74
    v_and_b32 v77, 0xffff0000, v76
    v_lshlrev_b32 v76, 16, v76
    v_and_b32 v79, 0xffff0000, v78
    v_lshlrev_b32 v78, 16, v78
    v_and_b32 v81, 0xffff0000, v80
    v_lshlrev_b32 v80, 16, v80
    v_and_b32 v83, 0xffff0000, v82
    v_lshlrev_b32 v82, 16, v82
    v_and_b32 v85, 0xffff0000, v84
    v_lshlrev_b32 v84, 16, v84
    v_and_b32 v87, 0xffff0000, v86
    v_lshlrev_b32 v86, 16, v86
    v_and_b32 v89, 0xffff0000, v88
    v_lshlrev_b32 v88, 16, v88
    v_and_b32 v91, 0xffff0000, v90
    v_lshlrev_b32 v90, 16, v90
    v_and_b32 v93, 0xffff0000, v92
    v_lshlrev_b32 v92, 16, v92
    v_and_b32 v95, 0xffff0000, v94
    v_lshlrev_b32 v94, 16, v94
    s_cmp_lg_u32 s21, 0
    s_cbranch_scc1 PD_9
    s_mov_b32 s23, 0
PL_8:
    buffer_load_dword v61, off, s[16:19], 0 offset:164 sc1
    s_waitcnt vmcnt(0)
    v_readfirstlane_b32 s40, v61
    s_nop 0
    s_cmp_ge_u32 s40, 1
    s_cbranch_scc1 PD_9
    s_sleep 2
    s_add_u32 s23, s23, 1
    s_cmp_lt_u32 s23, 400000
    s_cbranch_scc1 PL_8
    s_branch m_exit
PD_9:
    s_barrier
    v_lshlrev_b32 v2, 5, v60
    s_mov_b32 s38, 65536
    buffer_load_dwordx4 v[32:35], v2, s[8:11], s38 offen sc1
    buffer_load_dwordx4 v[36:39], v2, s[8:11], s38 offen offset:16 sc1
    buffer_load_dwordx4 v[40:43], v2, s[8:11], s38 offen offset:2048 sc1
    buffer_load_dwordx4 v[44:47], v2, s[8:11], s38 offen offset:2064 sc1
    v_lshrrev_b32 v3, 2, v60
    v_lshlrev_b32 v3, 10, v3
    v_and_b32 v4, 3, v60
    v_lshlrev_b32 v4, 8, v4
    v_add_u32 v3, v3, v4
    s_lshl_b32 s37, s36, 14
    s_lshl_b32 s38, s21, 6
    s_add_u32 s37, s37, s38
    s_add_u32 s37, s37, 4194304
    s_waitcnt vmcnt(0)
    v_mul_f32 v64, v64, v40
    v_mul_f32 v65, v65, v41
    v_mul_f32 v66, v66, v42
    v_mul_f32 v67, v67, v43
    v_mul_f32 v68, v68, v44
    v_mul_f32 v69, v69, v45
    v_mul_f32 v70, v70, v46
    v_mul_f32 v71, v71, v47
    v_cvt_pk_bf16_f32 v64, v64, v65
    v_cvt_pk_bf16_f32 v66, v66, v67
    v_cvt_pk_bf16_f32 v68, v68, v69
    v_cvt_pk_bf16_f32 v70, v70, v71
    v_and_b32 v65, 0xffff0000, v64
    v_lshlrev_b32 v64, 16, v64
    v_and_b32 v67, 0xffff0000, v66
    v_lshlrev_b32 v66, 16, v66
    v_and_b32 v69, 0xffff0000, v68
    v_lshlrev_b32 v68, 16, v68
    v_and_b32 v71, 0xffff0000, v70
    v_lshlrev_b32 v70, 16, v70
    v_add_f32 v64, v64, v32
    v_add_f32 v65, v65, v33
    v_add_f32 v66, v66, v34
    v_add_f32 v67, v67, v35
    v_add_f32 v68, v68, v36
    v_add_f32 v69, v69, v37
    v_add_f32 v70, v70, v38
    v_add_f32 v71, v71, v39
    v_cvt_pk_bf16_f32 v8, v64, v65
    v_cvt_pk_bf16_f32 v9, v66, v67
    v_cvt_pk_bf16_f32 v10, v68, v69
    v_cvt_pk_bf16_f32 v11, v70, v71
    buffer_store_dwordx4 v[8:11], v3, s[8:11], s37 offen offset:0 sc1
    v_mul_f32 v72, v72, v40
    v_mul_f32 v73, v73, v41
    v_mul_f32 v74, v74, v42
    v_mul_f32 v75, v75, v43
    v_mul_f32 v76, v76, v44
    v_mul_f32 v77, v77, v45
    v_mul_f32 v78, v78, v46
    v_mul_f32 v79, v79, v47
    v_cvt_pk_bf16_f32 v72, v72, v73
    v_cvt_pk_bf16_f32 v74, v74, v75
    v_cvt_pk_bf16_f32 v76, v76, v77
    v_cvt_pk_bf16_f32 v78, v78, v79
    v_and_b32 v73, 0xffff0000, v72
    v_lshlrev_b32 v72, 16, v72
    v_and_b32 v75, 0xffff0000, v74
    v_lshlrev_b32 v74, 16, v74
    v_and_b32 v77, 0xffff0000, v76
    v_lshlrev_b32 v76, 16, v76
    v_and_b32 v79, 0xffff0000, v78
    v_lshlrev_b32 v78, 16, v78
    v_add_f32 v72, v72, v32
    v_add_f32 v73, v73, v33
    v_add_f32 v74, v74, v34
    v_add_f32 v75, v75, v35
    v_add_f32 v76, v76, v36
    v_add_f32 v77, v77, v37
    v_add_f32 v78, v78, v38
    v_add_f32 v79, v79, v39
    v_cvt_pk_bf16_f32 v12, v72, v73
    v_cvt_pk_bf16_f32 v13, v74, v75
    v_cvt_pk_bf16_f32 v14, v76, v77
    v_cvt_pk_bf16_f32 v15, v78, v79
    buffer_store_dwordx4 v[12:15], v3, s[8:11], s37 offen offset:16 sc1
    v_mul_f32 v80, v80, v40
    v_mul_f32 v81, v81, v41
    v_mul_f32 v82, v82, v42
    v_mul_f32 v83, v83, v43
    v_mul_f32 v84, v84, v44
    v_mul_f32 v85, v85, v45
    v_mul_f32 v86, v86, v46
    v_mul_f32 v87, v87, v47
    v_cvt_pk_bf16_f32 v80, v80, v81
    v_cvt_pk_bf16_f32 v82, v82, v83
    v_cvt_pk_bf16_f32 v84, v84, v85
    v_cvt_pk_bf16_f32 v86, v86, v87
    v_and_b32 v81, 0xffff0000, v80
    v_lshlrev_b32 v80, 16, v80
    v_and_b32 v83, 0xffff0000, v82
    v_lshlrev_b32 v82, 16, v82
    v_and_b32 v85, 0xffff0000, v84
    v_lshlrev_b32 v84, 16, v84
    v_and_b32 v87, 0xffff0000, v86
    v_lshlrev_b32 v86, 16, v86
    v_add_f32 v80, v80, v32
    v_add_f32 v81, v81, v33
    v_add_f32 v82, v82, v34
    v_add_f32 v83, v83, v35
    v_add_f32 v84, v84, v36
    v_add_f32 v85, v85, v37
    v_add_f32 v86, v86, v38
    v_add_f32 v87, v87, v39
    v_cvt_pk_bf16_f32 v16, v80, v81
    v_cvt_pk_bf16_f32 v17, v82, v83
    v_cvt_pk_bf16_f32 v18, v84, v85
    v_cvt_pk_bf16_f32 v19, v86, v87
    buffer_store_dwordx4 v[16:19], v3, s[8:11], s37 offen offset:32 sc1
    v_mul_f32 v88, v88, v40
    v_mul_f32 v89, v89, v41
    v_mul_f32 v90, v90, v42
    v_mul_f32 v91, v91, v43
    v_mul_f32 v92, v92, v44
    v_mul_f32 v93, v93, v45
    v_mul_f32 v94, v94, v46
    v_mul_f32 v95, v95, v47
    v_cvt_pk_bf16_f32 v88, v88, v89
    v_cvt_pk_bf16_f32 v90, v90, v91
    v_cvt_pk_bf16_f32 v92, v92, v93
    v_cvt_pk_bf16_f32 v94, v94, v95
    v_and_b32 v89, 0xffff0000, v88
    v_lshlrev_b32 v88, 16, v88
    v_and_b32 v91, 0xffff0000, v90
    v_lshlrev_b32 v90, 16, v90
    v_and_b32 v93, 0xffff0000, v92
    v_lshlrev_b32 v92, 16, v92
    v_and_b32 v95, 0xffff0000, v94
    v_lshlrev_b32 v94, 16, v94
    v_add_f32 v88, v88, v32
    v_add_f32 v89, v89, v33
    v_add_f32 v90, v90, v34
    v_add_f32 v91, v91, v35
    v_add_f32 v92, v92, v36
    v_add_f32 v93, v93, v37
    v_add_f32 v94, v94, v38
    v_add_f32 v95, v95, v39
    v_cvt_pk_bf16_f32 v20, v88, v89
    v_cvt_pk_bf16_f32 v21, v90, v91
    v_cvt_pk_bf16_f32 v22, v92, v93
    v_cvt_pk_bf16_f32 v23, v94, v95
    buffer_store_dwordx4 v[20:23], v3, s[8:11], s37 offen offset:48 sc1
    s_waitcnt vmcnt(0)
    s_barrier
    s_cmp_lg_u32 s21, 0
    s_cbranch_scc1 SG_10
    v_mov_b32 v61, 1
    s_mov_b64 exec, 1
    buffer_atomic_add v61, off, s[16:19], 0 offset:52 sc0
    s_waitcnt vmcnt(0)
    v_readfirstlane_b32 s40, v61
    s_mov_b64 exec, -1
    s_cmp_lg_u32 s40, 127
    s_cbranch_scc1 SG_10
    buffer_store_dword v61, off, s[16:19], 0 offset:180 sc1
SG_10:
    s_cmp_ge_u32 s6, 5
    s_cbranch_scc1 m_gate
    s_sub_u32 s36, s6, 3
    s_lshl_b32 s36, s36, 5
    s_add_u32 s36, s36, s20
    s_load_dwordx4 s[84:87], s[0:1], 88
    s_lshl_b32 s39, s36, 4
    s_waitcnt lgkmcnt(0)
    s_mov_b32 s44, s84
    s_and_b32 s45, s85, 0xffff
    s_mov_b32 s46, 0x400
    s_mov_b32 s47, 0x20000
    s_mov_b32 s48, s86
    s_and_b32 s49, s87, 0xffff
    s_mov_b32 s50, 0x300000
    s_mov_b32 s51, 0x20000
    v_lshlrev_b32 v1, 4, v0
    v_mov_b64 v[4:5], -1
    v_mov_b64 v[6:7], -1
    s_lshl_b32 s37, s36, 13
    s_add_u32 s37, s37, 131072
    buffer_store_dwordx4 v[4:7], v1, s[8:11], s37 offen sc1
    s_add_u32 s37, s37, 4096
    buffer_store_dwordx4 v[4:7], v1, s[8:11], s37 offen sc1
    s_lshl_b32 s39, s36, 5
    s_add_u32 s39, s39, 1024
    v_lshrrev_b32 v2, 2, v0
    v_mul_u32_u24 v3, 16, v2
    buffer_load_dwordx4 v[8:11], v3, s[44:47], 0 offen
    s_mov_b32 s37, 49152
    v_mul_lo_u32 v3, s37, v2
    v_and_b32 v4, 3, v0
    v_lshlrev_b32 v4, 4, v4
    v_add_u32 v3, v3, v4
    s_lshl_b32 s37, s39, 1
    buffer_load_dwordx4 v[64:67], v3, s[48:51], s37 offen
    s_add_u32 s37, s37, 6144
    buffer_load_dwordx4 v[68:71], v3, s[48:51], s37 offen
    s_add_u32 s37, s37, 6144
    buffer_load_dwordx4 v[72:75], v3, s[48:51], s37 offen
    s_add_u32 s37, s37, 6144
    buffer_load_dwordx4 v[76:79], v3, s[48:51], s37 offen
    s_add_u32 s37, s37, 6144
    buffer_load_dwordx4 v[80:83], v3, s[48:51], s37 offen
    s_add_u32 s37, s37, 6144
    buffer_load_dwordx4 v[84:87], v3, s[48:51], s37 offen
    s_add_u32 s37, s37, 6144
    buffer_load_dwordx4 v[88:91], v3, s[48:51], s37 offen
    s_add_u32 s37, s37, 6144
    buffer_load_dwordx4 v[92:95], v3, s[48:51], s37 offen
    s_add_u32 s37, s37, 6144
    s_waitcnt vmcnt(8)
    v_and_b32 v17, 0xffff0000, v8
    v_lshlrev_b32 v16, 16, v8
    v_and_b32 v19, 0xffff0000, v9
    v_lshlrev_b32 v18, 16, v9
    v_and_b32 v21, 0xffff0000, v10
    v_lshlrev_b32 v20, 16, v10
    v_and_b32 v23, 0xffff0000, v11
    v_lshlrev_b32 v22, 16, v11
    s_mov_b32 s38, 0xbfb8aa3b
    v_mul_f32 v32, s38, v16
    v_mul_f32 v33, s38, v17
    v_mul_f32 v34, s38, v18
    v_mul_f32 v35, s38, v19
    v_mul_f32 v36, s38, v20
    v_mul_f32 v37, s38, v21
    v_mul_f32 v38, s38, v22
    v_mul_f32 v39, s38, v23
    v_exp_f32 v32, v32
    v_exp_f32 v33, v33
    v_exp_f32 v34, v34
    v_exp_f32 v35, v35
    v_exp_f32 v36, v36
    v_exp_f32 v37, v37
    v_exp_f32 v38, v38
    v_exp_f32 v39, v39
    v_add_f32 v32, 1.0, v32
    v_add_f32 v33, 1.0, v33
    v_add_f32 v34, 1.0, v34
    v_add_f32 v35, 1.0, v35
    v_add_f32 v36, 1.0, v36
    v_add_f32 v37, 1.0, v37
    v_add_f32 v38, 1.0, v38
    v_add_f32 v39, 1.0, v39
    v_rcp_f32 v32, v32
    v_rcp_f32 v33, v33
    v_rcp_f32 v34, v34
    v_rcp_f32 v35, v35
    v_rcp_f32 v36, v36
    v_rcp_f32 v37, v37
    v_rcp_f32 v38, v38
    v_rcp_f32 v39, v39
    s_nop 0
    v_mul_f32 v16, v16, v32
    v_mul_f32 v17, v17, v33
    v_mul_f32 v18, v18, v34
    v_mul_f32 v19, v19, v35
    v_mul_f32 v20, v20, v36
    v_mul_f32 v21, v21, v37
    v_mul_f32 v22, v22, v38
    v_mul_f32 v23, v23, v39
    v_cvt_pk_bf16_f32 v8, v16, v17
    v_cvt_pk_bf16_f32 v9, v18, v19
    v_cvt_pk_bf16_f32 v10, v20, v21
    v_cvt_pk_bf16_f32 v11, v22, v23
    v_and_b32 v17, 0xffff0000, v8
    v_lshlrev_b32 v16, 16, v8
    v_and_b32 v19, 0xffff0000, v9
    v_lshlrev_b32 v18, 16, v9
    v_and_b32 v21, 0xffff0000, v10
    v_lshlrev_b32 v20, 16, v10
    v_and_b32 v23, 0xffff0000, v11
    v_lshlrev_b32 v22, 16, v11
    s_waitcnt vmcnt(7)
    v_and_b32 v41, 0xffff0000, v64
    v_lshlrev_b32 v40, 16, v64
    v_and_b32 v43, 0xffff0000, v65
    v_lshlrev_b32 v42, 16, v65
    v_and_b32 v45, 0xffff0000, v66
    v_lshlrev_b32 v44, 16, v66
    v_and_b32 v47, 0xffff0000, v67
    v_lshlrev_b32 v46, 16, v67
    v_mul_f32 v32, v16, v40
    v_mul_f32 v33, v16, v41
    v_mul_f32 v34, v16, v42
    v_mul_f32 v35, v16, v43
    v_mul_f32 v36, v16, v44
    v_mul_f32 v37, v16, v45
    v_mul_f32 v38, v16, v46
    v_mul_f32 v39, v16, v47
    s_waitcnt vmcnt(6)
    v_and_b32 v41, 0xffff0000, v68
    v_lshlrev_b32 v40, 16, v68
    v_and_b32 v43, 0xffff0000, v69
    v_lshlrev_b32 v42, 16, v69
    v_and_b32 v45, 0xffff0000, v70
    v_lshlrev_b32 v44, 16, v70
    v_and_b32 v47, 0xffff0000, v71
    v_lshlrev_b32 v46, 16, v71
    v_fmac_f32 v32, v17, v40
    v_fmac_f32 v33, v17, v41
    v_fmac_f32 v34, v17, v42
    v_fmac_f32 v35, v17, v43
    v_fmac_f32 v36, v17, v44
    v_fmac_f32 v37, v17, v45
    v_fmac_f32 v38, v17, v46
    v_fmac_f32 v39, v17, v47
    s_waitcnt vmcnt(5)
    v_and_b32 v41, 0xffff0000, v72
    v_lshlrev_b32 v40, 16, v72
    v_and_b32 v43, 0xffff0000, v73
    v_lshlrev_b32 v42, 16, v73
    v_and_b32 v45, 0xffff0000, v74
    v_lshlrev_b32 v44, 16, v74
    v_and_b32 v47, 0xffff0000, v75
    v_lshlrev_b32 v46, 16, v75
    v_fmac_f32 v32, v18, v40
    v_fmac_f32 v33, v18, v41
    v_fmac_f32 v34, v18, v42
    v_fmac_f32 v35, v18, v43
    v_fmac_f32 v36, v18, v44
    v_fmac_f32 v37, v18, v45
    v_fmac_f32 v38, v18, v46
    v_fmac_f32 v39, v18, v47
    s_waitcnt vmcnt(4)
    v_and_b32 v41, 0xffff0000, v76
    v_lshlrev_b32 v40, 16, v76
    v_and_b32 v43, 0xffff0000, v77
    v_lshlrev_b32 v42, 16, v77
    v_and_b32 v45, 0xffff0000, v78
    v_lshlrev_b32 v44, 16, v78
    v_and_b32 v47, 0xffff0000, v79
    v_lshlrev_b32 v46, 16, v79
    v_fmac_f32 v32, v19, v40
    v_fmac_f32 v33, v19, v41
    v_fmac_f32 v34, v19, v42
    v_fmac_f32 v35, v19, v43
    v_fmac_f32 v36, v19, v44
    v_fmac_f32 v37, v19, v45
    v_fmac_f32 v38, v19, v46
    v_fmac_f32 v39, v19, v47
    s_waitcnt vmcnt(3)
    v_and_b32 v41, 0xffff0000, v80
    v_lshlrev_b32 v40, 16, v80
    v_and_b32 v43, 0xffff0000, v81
    v_lshlrev_b32 v42, 16, v81
    v_and_b32 v45, 0xffff0000, v82
    v_lshlrev_b32 v44, 16, v82
    v_and_b32 v47, 0xffff0000, v83
    v_lshlrev_b32 v46, 16, v83
    v_fmac_f32 v32, v20, v40
    v_fmac_f32 v33, v20, v41
    v_fmac_f32 v34, v20, v42
    v_fmac_f32 v35, v20, v43
    v_fmac_f32 v36, v20, v44
    v_fmac_f32 v37, v20, v45
    v_fmac_f32 v38, v20, v46
    v_fmac_f32 v39, v20, v47
    s_waitcnt vmcnt(2)
    v_and_b32 v41, 0xffff0000, v84
    v_lshlrev_b32 v40, 16, v84
    v_and_b32 v43, 0xffff0000, v85
    v_lshlrev_b32 v42, 16, v85
    v_and_b32 v45, 0xffff0000, v86
    v_lshlrev_b32 v44, 16, v86
    v_and_b32 v47, 0xffff0000, v87
    v_lshlrev_b32 v46, 16, v87
    v_fmac_f32 v32, v21, v40
    v_fmac_f32 v33, v21, v41
    v_fmac_f32 v34, v21, v42
    v_fmac_f32 v35, v21, v43
    v_fmac_f32 v36, v21, v44
    v_fmac_f32 v37, v21, v45
    v_fmac_f32 v38, v21, v46
    v_fmac_f32 v39, v21, v47
    s_waitcnt vmcnt(1)
    v_and_b32 v41, 0xffff0000, v88
    v_lshlrev_b32 v40, 16, v88
    v_and_b32 v43, 0xffff0000, v89
    v_lshlrev_b32 v42, 16, v89
    v_and_b32 v45, 0xffff0000, v90
    v_lshlrev_b32 v44, 16, v90
    v_and_b32 v47, 0xffff0000, v91
    v_lshlrev_b32 v46, 16, v91
    v_fmac_f32 v32, v22, v40
    v_fmac_f32 v33, v22, v41
    v_fmac_f32 v34, v22, v42
    v_fmac_f32 v35, v22, v43
    v_fmac_f32 v36, v22, v44
    v_fmac_f32 v37, v22, v45
    v_fmac_f32 v38, v22, v46
    v_fmac_f32 v39, v22, v47
    s_waitcnt vmcnt(0)
    v_and_b32 v41, 0xffff0000, v92
    v_lshlrev_b32 v40, 16, v92
    v_and_b32 v43, 0xffff0000, v93
    v_lshlrev_b32 v42, 16, v93
    v_and_b32 v45, 0xffff0000, v94
    v_lshlrev_b32 v44, 16, v94
    v_and_b32 v47, 0xffff0000, v95
    v_lshlrev_b32 v46, 16, v95
    v_fmac_f32 v32, v23, v40
    v_fmac_f32 v33, v23, v41
    v_fmac_f32 v34, v23, v42
    v_fmac_f32 v35, v23, v43
    v_fmac_f32 v36, v23, v44
    v_fmac_f32 v37, v23, v45
    v_fmac_f32 v38, v23, v46
    v_fmac_f32 v39, v23, v47
    v_lshlrev_b32 v2, 5, v0
    ds_write_b128 v2, v[32:35]
    ds_write_b128 v2, v[36:39] offset:16
    s_waitcnt lgkmcnt(0)
    s_barrier
    s_cmp_lg_u32 s21, 0
    s_cbranch_scc1 NM_11
    v_lshlrev_b32 v2, 2, v0
    ds_read_b32 v64, v2 offset:0
    ds_read_b32 v65, v2 offset:256
    ds_read_b32 v66, v2 offset:512
    ds_read_b32 v67, v2 offset:768
    ds_read_b32 v68, v2 offset:1024
    ds_read_b32 v69, v2 offset:1280
    ds_read_b32 v70, v2 offset:1536
    ds_read_b32 v71, v2 offset:1792
    ds_read_b32 v72, v2 offset:2048
    ds_read_b32 v73, v2 offset:2304
    ds_read_b32 v74, v2 offset:2560
    ds_read_b32 v75, v2 offset:2816
    ds_read_b32 v76, v2 offset:3072
    ds_read_b32 v77, v2 offset:3328
    ds_read_b32 v78, v2 offset:3584
    ds_read_b32 v79, v2 offset:3840
    ds_read_b32 v80, v2 offset:4096
    ds_read_b32 v81, v2 offset:4352
    ds_read_b32 v82, v2 offset:4608
    ds_read_b32 v83, v2 offset:4864
    ds_read_b32 v84, v2 offset:5120
    ds_read_b32 v85, v2 offset:5376
    ds_read_b32 v86, v2 offset:5632
    ds_read_b32 v87, v2 offset:5888
    ds_read_b32 v88, v2 offset:6144
    ds_read_b32 v89, v2 offset:6400
    ds_read_b32 v90, v2 offset:6656
    ds_read_b32 v91, v2 offset:6912
    ds_read_b32 v92, v2 offset:7168
    ds_read_b32 v93, v2 offset:7424
    ds_read_b32 v94, v2 offset:7680
    ds_read_b32 v95, v2 offset:7936
    s_waitcnt lgkmcnt(0)
    v_add_f32 v64, v64, v80
    v_add_f32 v65, v65, v81
    v_add_f32 v66, v66, v82
    v_add_f32 v67, v67, v83
    v_add_f32 v68, v68, v84
    v_add_f32 v69, v69, v85
    v_add_f32 v70, v70, v86
    v_add_f32 v71, v71, v87
    v_add_f32 v72, v72, v88
    v_add_f32 v73, v73, v89
    v_add_f32 v74, v74, v90
    v_add_f32 v75, v75, v91
    v_add_f32 v76, v76, v92
    v_add_f32 v77, v77, v93
    v_add_f32 v78, v78, v94
    v_add_f32 v79, v79, v95
    v_add_f32 v64, v64, v72
    v_add_f32 v65, v65, v73
    v_add_f32 v66, v66, v74
    v_add_f32 v67, v67, v75
    v_add_f32 v68, v68, v76
    v_add_f32 v69, v69, v77
    v_add_f32 v70, v70, v78
    v_add_f32 v71, v71, v79
    v_add_f32 v64, v64, v68
    v_add_f32 v65, v65, v69
    v_add_f32 v66, v66, v70
    v_add_f32 v67, v67, v71
    v_add_f32 v64, v64, v66
    v_add_f32 v65, v65, v67
    v_add_f32 v64, v64, v65
    v_mov_b32 v65, v64
    s_nop 1
    v_permlane32_swap_b32 v64, v65
    v_add_f32 v64, v64, v65
    v_cvt_pk_bf16_f32 v64, v64, v64
    v_lshlrev_b32 v64, 16, v64
    s_lshr_b32 s37, s39, 9
    s_cmp_eq_u32 s37, 1
    s_cselect_b32 s38, 1.0, 0
    s_cmp_eq_u32 s37, 4
    s_cselect_b32 s38, 1.0, s38
    v_add_f32 v64, s38, v64
    v_cvt_pk_bf16_f32 v64, v64, v64
    v_lshlrev_b32 v64, 16, v64
    v_and_b32 v2, 127, v2
    s_lshl_b32 s37, s39, 2
    s_add_u32 s37, s37, 65536
    buffer_store_dword v64, v2, s[8:11], s37 offen sc1
NM_11:
    s_waitcnt vmcnt(0)
    s_barrier
    s_cmp_lg_u32 s21, 0
    s_cbranch_scc1 SG_12
    v_mov_b32 v61, 1
    s_mov_b64 exec, 1
    buffer_atomic_add v61, off, s[16:19], 0 offset:20 sc0
    s_waitcnt vmcnt(0)
    v_readfirstlane_b32 s40, v61
    s_mov_b64 exec, -1
    s_cmp_lg_u32 s40, 63
    s_cbranch_scc1 SG_12
    buffer_store_dword v61, off, s[16:19], 0 offset:148 sc1
SG_12:
    s_branch m_gate
m_pf:
    s_load_dwordx8 s[88:95], s[0:1], 16
    s_cmp_lt_u32 s6, 3
    s_cselect_b32 s56, 1, 3
    s_sub_u32 s56, s6, s56
    s_lshl_b32 s56, s56, 5
    s_add_u32 s56, s56, s20
    s_lshl_b32 s56, s56, 15
    v_lshlrev_b32 v59, 4, v0
    s_waitcnt lgkmcnt(0)
    s_mov_b32 s52, s88
    s_and_b32 s53, s89, 0xffff
    s_mov_b32 s54, 0x400000
    s_mov_b32 s55, 0x20000
    s_mov_b32 s57, s56
    buffer_load_dwordx4 a[0:3], v59, s[52:55], s57 offen
    s_add_u32 s57, s57, 4096
    buffer_load_dwordx4 a[4:7], v59, s[52:55], s57 offen
    s_add_u32 s57, s57, 4096
    buffer_load_dwordx4 a[8:11], v59, s[52:55], s57 offen
    s_add_u32 s57, s57, 4096
    buffer_load_dwordx4 a[12:15], v59, s[52:55], s57 offen
    s_add_u32 s57, s57, 4096
    buffer_load_dwordx4 a[16:19], v59, s[52:55], s57 offen
    s_add_u32 s57, s57, 4096
    buffer_load_dwordx4 a[20:23], v59, s[52:55], s57 offen
    s_add_u32 s57, s57, 4096
    buffer_load_dwordx4 a[24:27], v59, s[52:55], s57 offen
    s_add_u32 s57, s57, 4096
    buffer_load_dwordx4 a[28:31], v59, s[52:55], s57 offen
    s_add_u32 s57, s57, 4096
    s_mov_b32 s52, s90
    s_and_b32 s53, s91, 0xffff
    s_mov_b32 s54, 0x400000
    s_mov_b32 s55, 0x20000
    s_mov_b32 s57, s56
    buffer_load_dwordx4 a[32:35], v59, s[52:55], s57 offen
    s_add_u32 s57, s57, 4096
    buffer_load_dwordx4 a[36:39], v59, s[52:55], s57 offen
    s_add_u32 s57, s57, 4096
    buffer_load_dwordx4 a[40:43], v59, s[52:55], s57 offen
    s_add_u32 s57, s57, 4096
    buffer_load_dwordx4 a[44:47], v59, s[52:55], s57 offen
    s_add_u32 s57, s57, 4096
    buffer_load_dwordx4 a[48:51], v59, s[52:55], s57 offen
    s_add_u32 s57, s57, 4096
    buffer_load_dwordx4 a[52:55], v59, s[52:55], s57 offen
    s_add_u32 s57, s57, 4096
    buffer_load_dwordx4 a[56:59], v59, s[52:55], s57 offen
    s_add_u32 s57, s57, 4096
    buffer_load_dwordx4 a[60:63], v59, s[52:55], s57 offen
    s_add_u32 s57, s57, 4096
    s_mov_b32 s52, s92
    s_and_b32 s53, s93, 0xffff
    s_mov_b32 s54, 0x400000
    s_mov_b32 s55, 0x20000
    s_mov_b32 s57, s56
    buffer_load_dwordx4 a[64:67], v59, s[52:55], s57 offen
    s_add_u32 s57, s57, 4096
    buffer_load_dwordx4 a[68:71], v59, s[52:55], s57 offen
    s_add_u32 s57, s57, 4096
    buffer_load_dwordx4 a[72:75], v59, s[52:55], s57 offen
    s_add_u32 s57, s57, 4096
    buffer_load_dwordx4 a[76:79], v59, s[52:55], s57 offen
    s_add_u32 s57, s57, 4096
    buffer_load_dwordx4 a[80:83], v59, s[52:55], s57 offen
    s_add_u32 s57, s57, 4096
    buffer_load_dwordx4 a[84:87], v59, s[52:55], s57 offen
    s_add_u32 s57, s57, 4096
    buffer_load_dwordx4 a[88:91], v59, s[52:55], s57 offen
    s_add_u32 s57, s57, 4096
    buffer_load_dwordx4 a[92:95], v59, s[52:55], s57 offen
    s_add_u32 s57, s57, 4096
    s_mov_b32 s52, s94
    s_and_b32 s53, s95, 0xffff
    s_mov_b32 s54, 0x400000
    s_mov_b32 s55, 0x20000
    s_mov_b32 s57, s56
    buffer_load_dwordx4 a[96:99], v59, s[52:55], s57 offen
    s_add_u32 s57, s57, 4096
    buffer_load_dwordx4 a[100:103], v59, s[52:55], s57 offen
    s_add_u32 s57, s57, 4096
    buffer_load_dwordx4 a[104:107], v59, s[52:55], s57 offen
    s_add_u32 s57, s57, 4096
    buffer_load_dwordx4 a[108:111], v59, s[52:55], s57 offen
    s_add_u32 s57, s57, 4096
    buffer_load_dwordx4 a[112:115], v59, s[52:55], s57 offen
    s_add_u32 s57, s57, 4096
    buffer_load_dwordx4 a[116:119], v59, s[52:55], s57 offen
    s_add_u32 s57, s57, 4096
    buffer_load_dwordx4 a[120:123], v59, s[52:55], s57 offen
    s_add_u32 s57, s57, 4096
    buffer_load_dwordx4 a[124:127], v59, s[52:55], s57 offen
    s_add_u32 s57, s57, 4096
    s_waitcnt vmcnt(0)
    s_branch m_qkv
m_gate:
    s_cmp_lg_u32 s21, 0
    s_cbranch_scc1 PD_14
    s_mov_b32 s23, 0
PL_13:
    buffer_load_dword v61, off, s[16:19], 0 offset:136 sc1
    s_waitcnt vmcnt(0)
    v_readfirstlane_b32 s40, v61
    s_nop 0
    s_cmp_ge_u32 s40, 1
    s_cbranch_scc1 PD_14
    s_sleep 8
    s_add_u32 s23, s23, 1
    s_cmp_lt_u32 s23, 400000
    s_cbranch_scc1 PL_13
    s_branch m_exit
PD_14:
    s_barrier
m_qkv:
    s_load_dwordx4 s[84:87], s[0:1], 16
    s_load_dwordx2 s[88:89], s[0:1], 32
    s_waitcnt lgkmcnt(0)
    s_mov_b32 s44, s84
    s_and_b32 s45, s85, 0xffff
    s_mov_b32 s46, 0x400000
    s_mov_b32 s47, 0x20000
    s_mov_b32 s48, s86
    s_and_b32 s49, s87, 0xffff
    s_mov_b32 s50, 0x400000
    s_mov_b32 s51, 0x20000
    s_mov_b32 s52, s88
    s_and_b32 s53, s89, 0xffff
    s_mov_b32 s54, 0x400000
    s_mov_b32 s55, 0x20000
    v_lshrrev_b32 v61, 4, v60
    v_lshlrev_b32 v62, 13, v61
    v_and_b32 v63, 15, v60
    v_lshlrev_b32 v63, 4, v63
    v_lshlrev_b32 v64, 5, v61
    v_xor_b32 v63, v63, v64
    s_and_b32 s40, s21, 1
    s_lshl_b32 s40, s40, 7
    v_xor_b32 v63, s40, v63
    s_lshl_b32 s40, s20, 8
    s_lshl_b32 s41, s21, 16
    s_add_u32 s40, s40, s41
    v_add3_u32 v62, v62, v63, s40
    s_lshl_b32 s42, s21, 11
    s_add_u32 s42, s42, 32768
    v_lshrrev_b32 v63, 4, v60
    v_bfe_u32 v64, v60, 2, 2
    v_and_b32 v65, 3, v60
    v_lshlrev_b32 v66, 3, v63
    v_add_u32 v66, v66, v64
    v_lshlrev_b32 v66, 8, v66
    v_and_b32 v67, 1, v63
    v_lshlrev_b32 v67, 2, v67
    v_or_b32 v67, v67, v64
    s_lshl_b32 s40, s21, 1
    v_xor_b32 v67, s40, v67
    v_lshlrev_b32 v67, 5, v67
    v_lshlrev_b32 v68, 3, v65
    v_add3_u32 v66, v66, v67, v68
    v_add_u32 v66, 32768, v66
    v_xor_b32 v67, 32, v66
    v_add_u32 v73, 0x10000, v66
    v_add_u32 v74, 0x10000, v67
    s_add_u32 m0, s42, 0
    s_mov_b32 s43, 0
    buffer_load_dwordx4 v62, s[44:47], s43 offen lds
    s_add_u32 m0, s42, 1024
    s_mov_b32 s43, 32768
    buffer_load_dwordx4 v62, s[44:47], s43 offen lds
    s_add_u32 m0, s42, 8192
    s_mov_b32 s43, 262144
    buffer_load_dwordx4 v62, s[44:47], s43 offen lds
    s_add_u32 m0, s42, 9216
    s_mov_b32 s43, 294912
    buffer_load_dwordx4 v62, s[44:47], s43 offen lds
    s_add_u32 m0, s42, 16384
    s_mov_b32 s43, 524288
    buffer_load_dwordx4 v62, s[44:47], s43 offen lds
    s_add_u32 m0, s42, 17408
    s_mov_b32 s43, 557056
    buffer_load_dwordx4 v62, s[44:47], s43 offen lds
    s_add_u32 m0, s42, 24576
    s_mov_b32 s43, 786432
    buffer_load_dwordx4 v62, s[44:47], s43 offen lds
    s_add_u32 m0, s42, 25600
    s_mov_b32 s43, 819200
    buffer_load_dwordx4 v62, s[44:47], s43 offen lds
    s_add_u32 m0, s42, 32768
    s_mov_b32 s43, 1048576
    buffer_load_dwordx4 v62, s[44:47], s43 offen lds
    s_add_u32 m0, s42, 33792
    s_mov_b32 s43, 1081344
    buffer_load_dwordx4 v62, s[44:47], s43 offen lds
    s_add_u32 m0, s42, 40960
    s_mov_b32 s43, 1310720
    buffer_load_dwordx4 v62, s[44:47], s43 offen lds
    s_add_u32 m0, s42, 41984
    s_mov_b32 s43, 1343488
    buffer_load_dwordx4 v62, s[44:47], s43 offen lds
    s_add_u32 m0, s42, 49152
    s_mov_b32 s43, 1572864
    buffer_load_dwordx4 v62, s[44:47], s43 offen lds
    s_add_u32 m0, s42, 50176
    s_mov_b32 s43, 1605632
    buffer_load_dwordx4 v62, s[44:47], s43 offen lds
    s_add_u32 m0, s42, 57344
    s_mov_b32 s43, 1835008
    buffer_load_dwordx4 v62, s[44:47], s43 offen lds
    s_add_u32 m0, s42, 58368
    s_mov_b32 s43, 1867776
    buffer_load_dwordx4 v62, s[44:47], s43 offen lds
    s_add_u32 m0, s42, 65536
    s_mov_b32 s43, 2097152
    buffer_load_dwordx4 v62, s[44:47], s43 offen lds
    s_add_u32 m0, s42, 66560
    s_mov_b32 s43, 2129920
    buffer_load_dwordx4 v62, s[44:47], s43 offen lds
    s_add_u32 m0, s42, 73728
    s_mov_b32 s43, 2359296
    buffer_load_dwordx4 v62, s[44:47], s43 offen lds
    s_add_u32 m0, s42, 74752
    s_mov_b32 s43, 2392064
    buffer_load_dwordx4 v62, s[44:47], s43 offen lds
    s_add_u32 m0, s42, 81920
    s_mov_b32 s43, 2621440
    buffer_load_dwordx4 v62, s[44:47], s43 offen lds
    s_add_u32 m0, s42, 82944
    s_mov_b32 s43, 2654208
    buffer_load_dwordx4 v62, s[44:47], s43 offen lds
    s_add_u32 m0, s42, 90112
    s_mov_b32 s43, 2883584
    buffer_load_dwordx4 v62, s[44:47], s43 offen lds
    s_add_u32 m0, s42, 91136
    s_mov_b32 s43, 2916352
    buffer_load_dwordx4 v62, s[44:47], s43 offen lds
    s_add_u32 m0, s42, 98304
    s_mov_b32 s43, 3145728
    buffer_load_dwordx4 v62, s[44:47], s43 offen lds
    s_add_u32 m0, s42, 99328
    s_mov_b32 s43, 3178496
    buffer_load_dwordx4 v62, s[44:47], s43 offen lds
    s_add_u32 m0, s42, 106496
    s_mov_b32 s43, 3407872
    buffer_load_dwordx4 v62, s[44:47], s43 offen lds
    s_add_u32 m0, s42, 107520
    s_mov_b32 s43, 3440640
    buffer_load_dwordx4 v62, s[44:47], s43 offen lds
    s_waitcnt vmcnt(24) lgkmcnt(0)
    s_barrier
    s_add_u32 m0, s42, 114688
    s_mov_b32 s43, 3670016
    buffer_load_dwordx4 v62, s[44:47], s43 offen lds
    s_add_u32 m0, s42, 115712
    s_mov_b32 s43, 3702784
    buffer_load_dwordx4 v62, s[44:47], s43 offen lds
    s_add_u32 m0, s42, 122880
    s_mov_b32 s43, 3932160
    buffer_load_dwordx4 v62, s[44:47], s43 offen lds
    s_add_u32 m0, s42, 123904
    s_mov_b32 s43, 3964928
    buffer_load_dwordx4 v62, s[44:47], s43 offen lds
    ds_read_b64_tr_b16 a[0:1], v66 offset:0
    ds_read_b64_tr_b16 a[2:3], v66 offset:1024
    ds_read_b64_tr_b16 a[8:9], v67 offset:0
    ds_read_b64_tr_b16 a[10:11], v67 offset:1024
    ds_read_b64_tr_b16 a[32:33], v66 offset:8192
    ds_read_b64_tr_b16 a[34:35], v66 offset:9216
    ds_read_b64_tr_b16 a[40:41], v67 offset:8192
    ds_read_b64_tr_b16 a[42:43], v67 offset:9216
    s_waitcnt vmcnt(24) lgkmcnt(0)
    s_barrier
    s_add_u32 m0, s42, 0
    s_mov_b32 s43, 0
    buffer_load_dwordx4 v62, s[48:51], s43 offen lds
    s_add_u32 m0, s42, 1024
    s_mov_b32 s43, 32768
    buffer_load_dwordx4 v62, s[48:51], s43 offen lds
    s_add_u32 m0, s42, 8192
    s_mov_b32 s43, 262144
    buffer_load_dwordx4 v62, s[48:51], s43 offen lds
    s_add_u32 m0, s42, 9216
    s_mov_b32 s43, 294912
    buffer_load_dwordx4 v62, s[48:51], s43 offen lds
    ds_read_b64_tr_b16 a[64:65], v66 offset:16384
    ds_read_b64_tr_b16 a[66:67], v66 offset:17408
    ds_read_b64_tr_b16 a[72:73], v67 offset:16384
    ds_read_b64_tr_b16 a[74:75], v67 offset:17408
    ds_read_b64_tr_b16 a[96:97], v66 offset:24576
    ds_read_b64_tr_b16 a[98:99], v66 offset:25600
    ds_read_b64_tr_b16 a[104:105], v67 offset:24576
    ds_read_b64_tr_b16 a[106:107], v67 offset:25600
    s_waitcnt vmcnt(24) lgkmcnt(0)
    s_barrier
    s_add_u32 m0, s42, 16384
    s_mov_b32 s43, 524288
    buffer_load_dwordx4 v62, s[48:51], s43 offen lds
    s_add_u32 m0, s42, 17408
    s_mov_b32 s43, 557056
    buffer_load_dwordx4 v62, s[48:51], s43 offen lds
    s_add_u32 m0, s42, 24576
    s_mov_b32 s43, 786432
    buffer_load_dwordx4 v62, s[48:51], s43 offen lds
    s_add_u32 m0, s42, 25600
    s_mov_b32 s43, 819200
    buffer_load_dwordx4 v62, s[48:51], s43 offen lds
    ds_read_b64_tr_b16 a[4:5], v66 offset:32768
    ds_read_b64_tr_b16 a[6:7], v66 offset:33792
    ds_read_b64_tr_b16 a[12:13], v67 offset:32768
    ds_read_b64_tr_b16 a[14:15], v67 offset:33792
    ds_read_b64_tr_b16 a[36:37], v66 offset:40960
    ds_read_b64_tr_b16 a[38:39], v66 offset:41984
    ds_read_b64_tr_b16 a[44:45], v67 offset:40960
    ds_read_b64_tr_b16 a[46:47], v67 offset:41984
    s_waitcnt vmcnt(24) lgkmcnt(0)
    s_barrier
    s_add_u32 m0, s42, 32768
    s_mov_b32 s43, 1048576
    buffer_load_dwordx4 v62, s[48:51], s43 offen lds
    s_add_u32 m0, s42, 33792
    s_mov_b32 s43, 1081344
    buffer_load_dwordx4 v62, s[48:51], s43 offen lds
    s_add_u32 m0, s42, 40960
    s_mov_b32 s43, 1310720
    buffer_load_dwordx4 v62, s[48:51], s43 offen lds
    s_add_u32 m0, s42, 41984
    s_mov_b32 s43, 1343488
    buffer_load_dwordx4 v62, s[48:51], s43 offen lds
    ds_read_b64_tr_b16 a[68:69], v66 offset:49152
    ds_read_b64_tr_b16 a[70:71], v66 offset:50176
    ds_read_b64_tr_b16 a[76:77], v67 offset:49152
    ds_read_b64_tr_b16 a[78:79], v67 offset:50176
    ds_read_b64_tr_b16 a[100:101], v66 offset:57344
    ds_read_b64_tr_b16 a[102:103], v66 offset:58368
    ds_read_b64_tr_b16 a[108:109], v67 offset:57344
    ds_read_b64_tr_b16 a[110:111], v67 offset:58368
    s_waitcnt vmcnt(24) lgkmcnt(0)
    s_barrier
    s_add_u32 m0, s42, 49152
    s_mov_b32 s43, 1572864
    buffer_load_dwordx4 v62, s[48:51], s43 offen lds
    s_add_u32 m0, s42, 50176
    s_mov_b32 s43, 1605632
    buffer_load_dwordx4 v62, s[48:51], s43 offen lds
    s_add_u32 m0, s42, 57344
    s_mov_b32 s43, 1835008
    buffer_load_dwordx4 v62, s[48:51], s43 offen lds
    s_add_u32 m0, s42, 58368
    s_mov_b32 s43, 1867776
    buffer_load_dwordx4 v62, s[48:51], s43 offen lds
    ds_read_b64_tr_b16 a[16:17], v73 offset:0
    ds_read_b64_tr_b16 a[18:19], v73 offset:1024
    ds_read_b64_tr_b16 a[24:25], v74 offset:0
    ds_read_b64_tr_b16 a[26:27], v74 offset:1024
    ds_read_b64_tr_b16 a[48:49], v73 offset:8192
    ds_read_b64_tr_b16 a[50:51], v73 offset:9216
    ds_read_b64_tr_b16 a[56:57], v74 offset:8192
    ds_read_b64_tr_b16 a[58:59], v74 offset:9216
    s_waitcnt vmcnt(24) lgkmcnt(0)
    s_barrier
    s_add_u32 m0, s42, 65536
    s_mov_b32 s43, 2097152
    buffer_load_dwordx4 v62, s[48:51], s43 offen lds
    s_add_u32 m0, s42, 66560
    s_mov_b32 s43, 2129920
    buffer_load_dwordx4 v62, s[48:51], s43 offen lds
    s_add_u32 m0, s42, 73728
    s_mov_b32 s43, 2359296
    buffer_load_dwordx4 v62, s[48:51], s43 offen lds
    s_add_u32 m0, s42, 74752
    s_mov_b32 s43, 2392064
    buffer_load_dwordx4 v62, s[48:51], s43 offen lds
    ds_read_b64_tr_b16 a[80:81], v73 offset:16384
    ds_read_b64_tr_b16 a[82:83], v73 offset:17408
    ds_read_b64_tr_b16 a[88:89], v74 offset:16384
    ds_read_b64_tr_b16 a[90:91], v74 offset:17408
    ds_read_b64_tr_b16 a[112:113], v73 offset:24576
    ds_read_b64_tr_b16 a[114:115], v73 offset:25600
    ds_read_b64_tr_b16 a[120:121], v74 offset:24576
    ds_read_b64_tr_b16 a[122:123], v74 offset:25600
    s_waitcnt vmcnt(24) lgkmcnt(0)
    s_barrier
    s_add_u32 m0, s42, 81920
    s_mov_b32 s43, 2621440
    buffer_load_dwordx4 v62, s[48:51], s43 offen lds
    s_add_u32 m0, s42, 82944
    s_mov_b32 s43, 2654208
    buffer_load_dwordx4 v62, s[48:51], s43 offen lds
    s_add_u32 m0, s42, 90112
    s_mov_b32 s43, 2883584
    buffer_load_dwordx4 v62, s[48:51], s43 offen lds
    s_add_u32 m0, s42, 91136
    s_mov_b32 s43, 2916352
    buffer_load_dwordx4 v62, s[48:51], s43 offen lds
    ds_read_b64_tr_b16 a[20:21], v73 offset:32768
    ds_read_b64_tr_b16 a[22:23], v73 offset:33792
    ds_read_b64_tr_b16 a[28:29], v74 offset:32768
    ds_read_b64_tr_b16 a[30:31], v74 offset:33792
    ds_read_b64_tr_b16 a[52:53], v73 offset:40960
    ds_read_b64_tr_b16 a[54:55], v73 offset:41984
    ds_read_b64_tr_b16 a[60:61], v74 offset:40960
    ds_read_b64_tr_b16 a[62:63], v74 offset:41984
    s_waitcnt vmcnt(24) lgkmcnt(0)
    s_barrier
    s_add_u32 m0, s42, 98304
    s_mov_b32 s43, 3145728
    buffer_load_dwordx4 v62, s[48:51], s43 offen lds
    s_add_u32 m0, s42, 99328
    s_mov_b32 s43, 3178496
    buffer_load_dwordx4 v62, s[48:51], s43 offen lds
    s_add_u32 m0, s42, 106496
    s_mov_b32 s43, 3407872
    buffer_load_dwordx4 v62, s[48:51], s43 offen lds
    s_add_u32 m0, s42, 107520
    s_mov_b32 s43, 3440640
    buffer_load_dwordx4 v62, s[48:51], s43 offen lds
    ds_read_b64_tr_b16 a[84:85], v73 offset:49152
    ds_read_b64_tr_b16 a[86:87], v73 offset:50176
    ds_read_b64_tr_b16 a[92:93], v74 offset:49152
    ds_read_b64_tr_b16 a[94:95], v74 offset:50176
    ds_read_b64_tr_b16 a[116:117], v73 offset:57344
    ds_read_b64_tr_b16 a[118:119], v73 offset:58368
    ds_read_b64_tr_b16 a[124:125], v74 offset:57344
    ds_read_b64_tr_b16 a[126:127], v74 offset:58368
    s_waitcnt vmcnt(24) lgkmcnt(0)
    s_barrier
    s_add_u32 m0, s42, 114688
    s_mov_b32 s43, 3670016
    buffer_load_dwordx4 v62, s[48:51], s43 offen lds
    s_add_u32 m0, s42, 115712
    s_mov_b32 s43, 3702784
    buffer_load_dwordx4 v62, s[48:51], s43 offen lds
    s_add_u32 m0, s42, 122880
    s_mov_b32 s43, 3932160
    buffer_load_dwordx4 v62, s[48:51], s43 offen lds
    s_add_u32 m0, s42, 123904
    s_mov_b32 s43, 3964928
    buffer_load_dwordx4 v62, s[48:51], s43 offen lds
    ds_read_b64_tr_b16 a[128:129], v66 offset:0
    ds_read_b64_tr_b16 a[130:131], v66 offset:1024
    ds_read_b64_tr_b16 a[136:137], v67 offset:0
    ds_read_b64_tr_b16 a[138:139], v67 offset:1024
    ds_read_b64_tr_b16 a[160:161], v66 offset:8192
    ds_read_b64_tr_b16 a[162:163], v66 offset:9216
    ds_read_b64_tr_b16 a[168:169], v67 offset:8192
    ds_read_b64_tr_b16 a[170:171], v67 offset:9216
    s_waitcnt vmcnt(24) lgkmcnt(0)
    s_barrier
    s_add_u32 m0, s42, 0
    s_mov_b32 s43, 0
    buffer_load_dwordx4 v62, s[52:55], s43 offen lds
    s_add_u32 m0, s42, 1024
    s_mov_b32 s43, 32768
    buffer_load_dwordx4 v62, s[52:55], s43 offen lds
    s_add_u32 m0, s42, 8192
    s_mov_b32 s43, 262144
    buffer_load_dwordx4 v62, s[52:55], s43 offen lds
    s_add_u32 m0, s42, 9216
    s_mov_b32 s43, 294912
    buffer_load_dwordx4 v62, s[52:55], s43 offen lds
    ds_read_b64_tr_b16 a[192:193], v66 offset:16384
    ds_read_b64_tr_b16 a[194:195], v66 offset:17408
    ds_read_b64_tr_b16 a[200:201], v67 offset:16384
    ds_read_b64_tr_b16 a[202:203], v67 offset:17408
    ds_read_b64_tr_b16 a[224:225], v66 offset:24576
    ds_read_b64_tr_b16 a[226:227], v66 offset:25600
    ds_read_b64_tr_b16 a[232:233], v67 offset:24576
    ds_read_b64_tr_b16 a[234:235], v67 offset:25600
    s_waitcnt vmcnt(24) lgkmcnt(0)
    s_barrier
    s_add_u32 m0, s42, 16384
    s_mov_b32 s43, 524288
    buffer_load_dwordx4 v62, s[52:55], s43 offen lds
    s_add_u32 m0, s42, 17408
    s_mov_b32 s43, 557056
    buffer_load_dwordx4 v62, s[52:55], s43 offen lds
    s_add_u32 m0, s42, 24576
    s_mov_b32 s43, 786432
    buffer_load_dwordx4 v62, s[52:55], s43 offen lds
    s_add_u32 m0, s42, 25600
    s_mov_b32 s43, 819200
    buffer_load_dwordx4 v62, s[52:55], s43 offen lds
    ds_read_b64_tr_b16 a[132:133], v66 offset:32768
    ds_read_b64_tr_b16 a[134:135], v66 offset:33792
    ds_read_b64_tr_b16 a[140:141], v67 offset:32768
    ds_read_b64_tr_b16 a[142:143], v67 offset:33792
    ds_read_b64_tr_b16 a[164:165], v66 offset:40960
    ds_read_b64_tr_b16 a[166:167], v66 offset:41984
    ds_read_b64_tr_b16 a[172:173], v67 offset:40960
    ds_read_b64_tr_b16 a[174:175], v67 offset:41984
    s_waitcnt vmcnt(24) lgkmcnt(0)
    s_barrier
    s_add_u32 m0, s42, 32768
    s_mov_b32 s43, 1048576
    buffer_load_dwordx4 v62, s[52:55], s43 offen lds
    s_add_u32 m0, s42, 33792
    s_mov_b32 s43, 1081344
    buffer_load_dwordx4 v62, s[52:55], s43 offen lds
    s_add_u32 m0, s42, 40960
    s_mov_b32 s43, 1310720
    buffer_load_dwordx4 v62, s[52:55], s43 offen lds
    s_add_u32 m0, s42, 41984
    s_mov_b32 s43, 1343488
    buffer_load_dwordx4 v62, s[52:55], s43 offen lds
    ds_read_b64_tr_b16 a[196:197], v66 offset:49152
    ds_read_b64_tr_b16 a[198:199], v66 offset:50176
    ds_read_b64_tr_b16 a[204:205], v67 offset:49152
    ds_read_b64_tr_b16 a[206:207], v67 offset:50176
    ds_read_b64_tr_b16 a[228:229], v66 offset:57344
    ds_read_b64_tr_b16 a[230:231], v66 offset:58368
    ds_read_b64_tr_b16 a[236:237], v67 offset:57344
    ds_read_b64_tr_b16 a[238:239], v67 offset:58368
    s_waitcnt vmcnt(24) lgkmcnt(0)
    s_barrier
    s_add_u32 m0, s42, 49152
    s_mov_b32 s43, 1572864
    buffer_load_dwordx4 v62, s[52:55], s43 offen lds
    s_add_u32 m0, s42, 50176
    s_mov_b32 s43, 1605632
    buffer_load_dwordx4 v62, s[52:55], s43 offen lds
    s_add_u32 m0, s42, 57344
    s_mov_b32 s43, 1835008
    buffer_load_dwordx4 v62, s[52:55], s43 offen lds
    s_add_u32 m0, s42, 58368
    s_mov_b32 s43, 1867776
    buffer_load_dwordx4 v62, s[52:55], s43 offen lds
    ds_read_b64_tr_b16 a[144:145], v73 offset:0
    ds_read_b64_tr_b16 a[146:147], v73 offset:1024
    ds_read_b64_tr_b16 a[152:153], v74 offset:0
    ds_read_b64_tr_b16 a[154:155], v74 offset:1024
    ds_read_b64_tr_b16 a[176:177], v73 offset:8192
    ds_read_b64_tr_b16 a[178:179], v73 offset:9216
    ds_read_b64_tr_b16 a[184:185], v74 offset:8192
    ds_read_b64_tr_b16 a[186:187], v74 offset:9216
    s_waitcnt vmcnt(24) lgkmcnt(0)
    s_barrier
    s_add_u32 m0, s42, 65536
    s_mov_b32 s43, 2097152
    buffer_load_dwordx4 v62, s[52:55], s43 offen lds
    s_add_u32 m0, s42, 66560
    s_mov_b32 s43, 2129920
    buffer_load_dwordx4 v62, s[52:55], s43 offen lds
    s_add_u32 m0, s42, 73728
    s_mov_b32 s43, 2359296
    buffer_load_dwordx4 v62, s[52:55], s43 offen lds
    s_add_u32 m0, s42, 74752
    s_mov_b32 s43, 2392064
    buffer_load_dwordx4 v62, s[52:55], s43 offen lds
    ds_read_b64_tr_b16 a[208:209], v73 offset:16384
    ds_read_b64_tr_b16 a[210:211], v73 offset:17408
    ds_read_b64_tr_b16 a[216:217], v74 offset:16384
    ds_read_b64_tr_b16 a[218:219], v74 offset:17408
    ds_read_b64_tr_b16 a[240:241], v73 offset:24576
    ds_read_b64_tr_b16 a[242:243], v73 offset:25600
    ds_read_b64_tr_b16 a[248:249], v74 offset:24576
    ds_read_b64_tr_b16 a[250:251], v74 offset:25600
    s_waitcnt vmcnt(24) lgkmcnt(0)
    s_barrier
    s_add_u32 m0, s42, 81920
    s_mov_b32 s43, 2621440
    buffer_load_dwordx4 v62, s[52:55], s43 offen lds
    s_add_u32 m0, s42, 82944
    s_mov_b32 s43, 2654208
    buffer_load_dwordx4 v62, s[52:55], s43 offen lds
    s_add_u32 m0, s42, 90112
    s_mov_b32 s43, 2883584
    buffer_load_dwordx4 v62, s[52:55], s43 offen lds
    s_add_u32 m0, s42, 91136
    s_mov_b32 s43, 2916352
    buffer_load_dwordx4 v62, s[52:55], s43 offen lds
    ds_read_b64_tr_b16 a[148:149], v73 offset:32768
    ds_read_b64_tr_b16 a[150:151], v73 offset:33792
    ds_read_b64_tr_b16 a[156:157], v74 offset:32768
    ds_read_b64_tr_b16 a[158:159], v74 offset:33792
    ds_read_b64_tr_b16 a[180:181], v73 offset:40960
    ds_read_b64_tr_b16 a[182:183], v73 offset:41984
    ds_read_b64_tr_b16 a[188:189], v74 offset:40960
    ds_read_b64_tr_b16 a[190:191], v74 offset:41984
    s_waitcnt vmcnt(24) lgkmcnt(0)
    s_barrier
    s_add_u32 m0, s42, 98304
    s_mov_b32 s43, 3145728
    buffer_load_dwordx4 v62, s[52:55], s43 offen lds
    s_add_u32 m0, s42, 99328
    s_mov_b32 s43, 3178496
    buffer_load_dwordx4 v62, s[52:55], s43 offen lds
    s_add_u32 m0, s42, 106496
    s_mov_b32 s43, 3407872
    buffer_load_dwordx4 v62, s[52:55], s43 offen lds
    s_add_u32 m0, s42, 107520
    s_mov_b32 s43, 3440640
    buffer_load_dwordx4 v62, s[52:55], s43 offen lds
    ds_read_b64_tr_b16 a[212:213], v73 offset:49152
    ds_read_b64_tr_b16 a[214:215], v73 offset:50176
    ds_read_b64_tr_b16 a[220:221], v74 offset:49152
    ds_read_b64_tr_b16 a[222:223], v74 offset:50176
    ds_read_b64_tr_b16 a[244:245], v73 offset:57344
    ds_read_b64_tr_b16 a[246:247], v73 offset:58368
    ds_read_b64_tr_b16 a[252:253], v74 offset:57344
    ds_read_b64_tr_b16 a[254:255], v74 offset:58368
    s_waitcnt vmcnt(24) lgkmcnt(0)
    s_barrier
    s_add_u32 m0, s42, 114688
    s_mov_b32 s43, 3670016
    buffer_load_dwordx4 v62, s[52:55], s43 offen lds
    s_add_u32 m0, s42, 115712
    s_mov_b32 s43, 3702784
    buffer_load_dwordx4 v62, s[52:55], s43 offen lds
    s_add_u32 m0, s42, 122880
    s_mov_b32 s43, 3932160
    buffer_load_dwordx4 v62, s[52:55], s43 offen lds
    s_add_u32 m0, s42, 123904
    s_mov_b32 s43, 3964928
    buffer_load_dwordx4 v62, s[52:55], s43 offen lds
    ds_read_b64_tr_b16 v[128:129], v66 offset:0
    ds_read_b64_tr_b16 v[130:131], v66 offset:1024
    ds_read_b64_tr_b16 v[136:137], v67 offset:0
    ds_read_b64_tr_b16 v[138:139], v67 offset:1024
    ds_read_b64_tr_b16 v[160:161], v66 offset:8192
    ds_read_b64_tr_b16 v[162:163], v66 offset:9216
    ds_read_b64_tr_b16 v[168:169], v67 offset:8192
    ds_read_b64_tr_b16 v[170:171], v67 offset:9216
    s_waitcnt vmcnt(24) lgkmcnt(0)
    s_barrier
    ds_read_b64_tr_b16 v[192:193], v66 offset:16384
    ds_read_b64_tr_b16 v[194:195], v66 offset:17408
    ds_read_b64_tr_b16 v[200:201], v67 offset:16384
    ds_read_b64_tr_b16 v[202:203], v67 offset:17408
    ds_read_b64_tr_b16 v[224:225], v66 offset:24576
    ds_read_b64_tr_b16 v[226:227], v66 offset:25600
    ds_read_b64_tr_b16 v[232:233], v67 offset:24576
    ds_read_b64_tr_b16 v[234:235], v67 offset:25600
    s_waitcnt vmcnt(20) lgkmcnt(0)
    s_barrier
    ds_read_b64_tr_b16 v[132:133], v66 offset:32768
    ds_read_b64_tr_b16 v[134:135], v66 offset:33792
    ds_read_b64_tr_b16 v[140:141], v67 offset:32768
    ds_read_b64_tr_b16 v[142:143], v67 offset:33792
    ds_read_b64_tr_b16 v[164:165], v66 offset:40960
    ds_read_b64_tr_b16 v[166:167], v66 offset:41984
    ds_read_b64_tr_b16 v[172:173], v67 offset:40960
    ds_read_b64_tr_b16 v[174:175], v67 offset:41984
    s_waitcnt vmcnt(16) lgkmcnt(0)
    s_barrier
    ds_read_b64_tr_b16 v[196:197], v66 offset:49152
    ds_read_b64_tr_b16 v[198:199], v66 offset:50176
    ds_read_b64_tr_b16 v[204:205], v67 offset:49152
    ds_read_b64_tr_b16 v[206:207], v67 offset:50176
    ds_read_b64_tr_b16 v[228:229], v66 offset:57344
    ds_read_b64_tr_b16 v[230:231], v66 offset:58368
    ds_read_b64_tr_b16 v[236:237], v67 offset:57344
    ds_read_b64_tr_b16 v[238:239], v67 offset:58368
    s_waitcnt vmcnt(12) lgkmcnt(0)
    s_barrier
    ds_read_b64_tr_b16 v[144:145], v73 offset:0
    ds_read_b64_tr_b16 v[146:147], v73 offset:1024
    ds_read_b64_tr_b16 v[152:153], v74 offset:0
    ds_read_b64_tr_b16 v[154:155], v74 offset:1024
    ds_read_b64_tr_b16 v[176:177], v73 offset:8192
    ds_read_b64_tr_b16 v[178:179], v73 offset:9216
    ds_read_b64_tr_b16 v[184:185], v74 offset:8192
    ds_read_b64_tr_b16 v[186:187], v74 offset:9216
    s_waitcnt vmcnt(8) lgkmcnt(0)
    s_barrier
    ds_read_b64_tr_b16 v[208:209], v73 offset:16384
    ds_read_b64_tr_b16 v[210:211], v73 offset:17408
    ds_read_b64_tr_b16 v[216:217], v74 offset:16384
    ds_read_b64_tr_b16 v[218:219], v74 offset:17408
    ds_read_b64_tr_b16 v[240:241], v73 offset:24576
    ds_read_b64_tr_b16 v[242:243], v73 offset:25600
    ds_read_b64_tr_b16 v[248:249], v74 offset:24576
    ds_read_b64_tr_b16 v[250:251], v74 offset:25600
    s_waitcnt vmcnt(4) lgkmcnt(0)
    s_barrier
    ds_read_b64_tr_b16 v[148:149], v73 offset:32768
    ds_read_b64_tr_b16 v[150:151], v73 offset:33792
    ds_read_b64_tr_b16 v[156:157], v74 offset:32768
    ds_read_b64_tr_b16 v[158:159], v74 offset:33792
    ds_read_b64_tr_b16 v[180:181], v73 offset:40960
    ds_read_b64_tr_b16 v[182:183], v73 offset:41984
    ds_read_b64_tr_b16 v[188:189], v74 offset:40960
    ds_read_b64_tr_b16 v[190:191], v74 offset:41984
    s_waitcnt vmcnt(0) lgkmcnt(0)
    s_barrier
    ds_read_b64_tr_b16 v[212:213], v73 offset:49152
    ds_read_b64_tr_b16 v[214:215], v73 offset:50176
    ds_read_b64_tr_b16 v[220:221], v74 offset:49152
    ds_read_b64_tr_b16 v[222:223], v74 offset:50176
    ds_read_b64_tr_b16 v[244:245], v73 offset:57344
    ds_read_b64_tr_b16 v[246:247], v73 offset:58368
    ds_read_b64_tr_b16 v[252:253], v74 offset:57344
    ds_read_b64_tr_b16 v[254:255], v74 offset:58368
    s_waitcnt lgkmcnt(0)
    s_barrier
    s_cmp_lg_u32 s21, 0
    s_cbranch_scc1 PD_16
    s_mov_b32 s23, 0
PL_15:
    buffer_load_dword v61, off, s[16:19], 0 offset:180 sc1
    s_waitcnt vmcnt(0)
    v_readfirstlane_b32 s40, v61
    s_nop 0
    s_cmp_ge_u32 s40, 1
    s_cbranch_scc1 PD_16
    s_sleep 2
    s_add_u32 s23, s23, 1
    s_cmp_lt_u32 s23, 400000
    s_cbranch_scc1 PL_15
    s_branch m_exit
PD_16:
    s_barrier
    v_lshlrev_b32 v1, 4, v60
    s_lshl_b32 s39, s21, 13
    v_add_u32 v2, s39, v1
    s_lshl_b32 s40, s20, 14
    s_lshl_b32 s41, s21, 12
    s_add_u32 s40, s40, s41
    v_add_u32 v3, s40, v1
    s_lshr_b32 s40, s40, 1
    v_add_u32 v4, s40, v1
    v_mov_b32 v5, 1
    v_mov_b32 v7, 2
    s_add_u32 s40, s6, 6
    s_cmp_lt_u32 s6, 3
    s_cselect_b32 s36, s6, s40
    s_mov_b32 s37, 0
    s_mov_b32 s38, -1
    s_lshl_b32 s40, s36, 15
    s_add_u32 s40, s40, 4194304
    s_add_u32 s41, s37, s39
    s_add_u32 m0, s41, 0
    s_nop 0
    buffer_load_dwordx4 v2, s[8:11], s40 offen offset:0 sc1 lds
    buffer_load_dwordx4 v2, s[8:11], s40 offen offset:1024 sc1 lds
    buffer_load_dwordx4 v2, s[8:11], s40 offen offset:2048 sc1 lds
    buffer_load_dwordx4 v2, s[8:11], s40 offen offset:3072 sc1 lds
    s_add_u32 m0, s41, 4096
    s_add_u32 s40, s40, 4096
    buffer_load_dwordx4 v2, s[8:11], s40 offen offset:0 sc1 lds
    buffer_load_dwordx4 v2, s[8:11], s40 offen offset:1024 sc1 lds
    buffer_load_dwordx4 v2, s[8:11], s40 offen offset:2048 sc1 lds
    buffer_load_dwordx4 v2, s[8:11], s40 offen offset:3072 sc1 lds
    s_waitcnt vmcnt(0)
QL_17:
    s_waitcnt vmcnt(2)
    s_barrier
    s_cmp_lt_u32 s36, 6
    s_cselect_b32 s42, 3, 7
    s_add_u32 s42, s42, s36
    s_min_u32 s44, s42, 63
    s_xor_b32 s43, s37, 32768
    v_add_u32 v6, s37, v1
    s_lshl_b32 s40, s44, 15
    s_add_u32 s40, s40, 4194304
    s_add_u32 s41, s43, s39
    s_add_u32 m0, s41, 0
    s_nop 0
    buffer_load_dwordx4 v2, s[8:11], s40 offen offset:0 sc1 lds
    buffer_load_dwordx4 v2, s[8:11], s40 offen offset:1024 sc1 lds
    buffer_load_dwordx4 v2, s[8:11], s40 offen offset:2048 sc1 lds
    buffer_load_dwordx4 v2, s[8:11], s40 offen offset:3072 sc1 lds
    s_add_u32 m0, s41, 4096
    s_add_u32 s40, s40, 4096
    buffer_load_dwordx4 v2, s[8:11], s40 offen offset:0 sc1 lds
    buffer_load_dwordx4 v2, s[8:11], s40 offen offset:1024 sc1 lds
    buffer_load_dwordx4 v2, s[8:11], s40 offen offset:2048 sc1 lds
    buffer_load_dwordx4 v2, s[8:11], s40 offen offset:3072 sc1 lds
    ds_read_b128 v[8:11], v6 offset:0
    ds_read_b128 v[12:15], v6 offset:16384
    ds_read_b128 v[16:19], v6 offset:1024
    ds_read_b128 v[20:23], v6 offset:17408
    s_waitcnt lgkmcnt(2)
    v_mfma_f32_16x16x32_bf16 v[80:83], a[128:131], v[8:11], 0
    v_mfma_f32_16x16x32_bf16 v[88:91], a[128:131], v[12:15], 0
    v_mfma_f32_16x16x32_bf16 v[84:87], a[136:139], v[8:11], 0
    v_mfma_f32_16x16x32_bf16 v[92:95], a[136:139], v[12:15], 0
    v_mfma_f32_16x16x32_bf16 v[96:99], v[8:11], v[128:131], 0
    v_mfma_f32_16x16x32_bf16 v[100:103], v[12:15], v[128:131], 0
    v_mfma_f32_16x16x32_bf16 v[104:107], v[8:11], v[136:139], 0
    v_mfma_f32_16x16x32_bf16 v[108:111], v[12:15], v[136:139], 0
    ds_read_b128 v[8:11], v6 offset:2048
    ds_read_b128 v[12:15], v6 offset:18432
    s_waitcnt lgkmcnt(2)
    v_mfma_f32_16x16x32_bf16 v[80:83], a[160:163], v[16:19], v[80:83]
    v_mfma_f32_16x16x32_bf16 v[88:91], a[160:163], v[20:23], v[88:91]
    v_mfma_f32_16x16x32_bf16 v[84:87], a[168:171], v[16:19], v[84:87]
    v_mfma_f32_16x16x32_bf16 v[92:95], a[168:171], v[20:23], v[92:95]
    v_mfma_f32_16x16x32_bf16 v[96:99], v[16:19], v[160:163], v[96:99]
    v_mfma_f32_16x16x32_bf16 v[100:103], v[20:23], v[160:163], v[100:103]
    v_mfma_f32_16x16x32_bf16 v[104:107], v[16:19], v[168:171], v[104:107]
    v_mfma_f32_16x16x32_bf16 v[108:111], v[20:23], v[168:171], v[108:111]
    ds_read_b128 v[16:19], v6 offset:3072
    ds_read_b128 v[20:23], v6 offset:19456
    s_waitcnt lgkmcnt(2)
    v_mfma_f32_16x16x32_bf16 v[80:83], a[192:195], v[8:11], v[80:83]
    v_mfma_f32_16x16x32_bf16 v[88:91], a[192:195], v[12:15], v[88:91]
    v_mfma_f32_16x16x32_bf16 v[84:87], a[200:203], v[8:11], v[84:87]
    v_mfma_f32_16x16x32_bf16 v[92:95], a[200:203], v[12:15], v[92:95]
    v_mfma_f32_16x16x32_bf16 v[96:99], v[8:11], v[192:195], v[96:99]
    v_mfma_f32_16x16x32_bf16 v[100:103], v[12:15], v[192:195], v[100:103]
    v_mfma_f32_16x16x32_bf16 v[104:107], v[8:11], v[200:203], v[104:107]
    v_mfma_f32_16x16x32_bf16 v[108:111], v[12:15], v[200:203], v[108:111]
    ds_read_b128 v[8:11], v6 offset:4096
    ds_read_b128 v[12:15], v6 offset:20480
    s_waitcnt lgkmcnt(2)
    v_mfma_f32_16x16x32_bf16 v[80:83], a[224:227], v[16:19], v[80:83]
    v_mfma_f32_16x16x32_bf16 v[88:91], a[224:227], v[20:23], v[88:91]
    v_mfma_f32_16x16x32_bf16 v[84:87], a[232:235], v[16:19], v[84:87]
    v_mfma_f32_16x16x32_bf16 v[92:95], a[232:235], v[20:23], v[92:95]
    v_mfma_f32_16x16x32_bf16 v[96:99], v[16:19], v[224:227], v[96:99]
    v_mfma_f32_16x16x32_bf16 v[100:103], v[20:23], v[224:227], v[100:103]
    v_mfma_f32_16x16x32_bf16 v[104:107], v[16:19], v[232:235], v[104:107]
    v_mfma_f32_16x16x32_bf16 v[108:111], v[20:23], v[232:235], v[108:111]
    ds_read_b128 v[16:19], v6 offset:5120
    ds_read_b128 v[20:23], v6 offset:21504
    s_waitcnt lgkmcnt(2)
    v_mfma_f32_16x16x32_bf16 v[80:83], a[132:135], v[8:11], v[80:83]
    v_mfma_f32_16x16x32_bf16 v[88:91], a[132:135], v[12:15], v[88:91]
    v_mfma_f32_16x16x32_bf16 v[84:87], a[140:143], v[8:11], v[84:87]
    v_mfma_f32_16x16x32_bf16 v[92:95], a[140:143], v[12:15], v[92:95]
    v_mfma_f32_16x16x32_bf16 v[96:99], v[8:11], v[132:135], v[96:99]
    v_mfma_f32_16x16x32_bf16 v[100:103], v[12:15], v[132:135], v[100:103]
    v_mfma_f32_16x16x32_bf16 v[104:107], v[8:11], v[140:143], v[104:107]
    v_mfma_f32_16x16x32_bf16 v[108:111], v[12:15], v[140:143], v[108:111]
    ds_read_b128 v[8:11], v6 offset:6144
    ds_read_b128 v[12:15], v6 offset:22528
    s_waitcnt lgkmcnt(2)
    v_mfma_f32_16x16x32_bf16 v[80:83], a[164:167], v[16:19], v[80:83]
    v_mfma_f32_16x16x32_bf16 v[88:91], a[164:167], v[20:23], v[88:91]
    v_mfma_f32_16x16x32_bf16 v[84:87], a[172:175], v[16:19], v[84:87]
    v_mfma_f32_16x16x32_bf16 v[92:95], a[172:175], v[20:23], v[92:95]
    v_mfma_f32_16x16x32_bf16 v[96:99], v[16:19], v[164:167], v[96:99]
    v_mfma_f32_16x16x32_bf16 v[100:103], v[20:23], v[164:167], v[100:103]
    v_mfma_f32_16x16x32_bf16 v[104:107], v[16:19], v[172:175], v[104:107]
    v_mfma_f32_16x16x32_bf16 v[108:111], v[20:23], v[172:175], v[108:111]
    ds_read_b128 v[16:19], v6 offset:7168
    ds_read_b128 v[20:23], v6 offset:23552
    s_waitcnt lgkmcnt(2)
    v_mfma_f32_16x16x32_bf16 v[80:83], a[196:199], v[8:11], v[80:83]
    v_mfma_f32_16x16x32_bf16 v[88:91], a[196:199], v[12:15], v[88:91]
    v_mfma_f32_16x16x32_bf16 v[84:87], a[204:207], v[8:11], v[84:87]
    v_mfma_f32_16x16x32_bf16 v[92:95], a[204:207], v[12:15], v[92:95]
    v_mfma_f32_16x16x32_bf16 v[96:99], v[8:11], v[196:199], v[96:99]
    v_mfma_f32_16x16x32_bf16 v[100:103], v[12:15], v[196:199], v[100:103]
    v_mfma_f32_16x16x32_bf16 v[104:107], v[8:11], v[204:207], v[104:107]
    v_mfma_f32_16x16x32_bf16 v[108:111], v[12:15], v[204:207], v[108:111]
    ds_read_b128 v[8:11], v6 offset:8192
    ds_read_b128 v[12:15], v6 offset:24576
    s_waitcnt lgkmcnt(2)
    v_mfma_f32_16x16x32_bf16 v[80:83], a[228:231], v[16:19], v[80:83]
    v_mfma_f32_16x16x32_bf16 v[88:91], a[228:231], v[20:23], v[88:91]
    v_mfma_f32_16x16x32_bf16 v[84:87], a[236:239], v[16:19], v[84:87]
    v_mfma_f32_16x16x32_bf16 v[92:95], a[236:239], v[20:23], v[92:95]
    v_mfma_f32_16x16x32_bf16 v[96:99], v[16:19], v[228:231], v[96:99]
    v_mfma_f32_16x16x32_bf16 v[100:103], v[20:23], v[228:231], v[100:103]
    v_mfma_f32_16x16x32_bf16 v[104:107], v[16:19], v[236:239], v[104:107]
    v_mfma_f32_16x16x32_bf16 v[108:111], v[20:23], v[236:239], v[108:111]
    ds_read_b128 v[16:19], v6 offset:9216
    ds_read_b128 v[20:23], v6 offset:25600
    s_waitcnt lgkmcnt(2)
    v_mfma_f32_16x16x32_bf16 v[80:83], a[144:147], v[8:11], v[80:83]
    v_mfma_f32_16x16x32_bf16 v[88:91], a[144:147], v[12:15], v[88:91]
    v_mfma_f32_16x16x32_bf16 v[84:87], a[152:155], v[8:11], v[84:87]
    v_mfma_f32_16x16x32_bf16 v[92:95], a[152:155], v[12:15], v[92:95]
    v_mfma_f32_16x16x32_bf16 v[96:99], v[8:11], v[144:147], v[96:99]
    v_mfma_f32_16x16x32_bf16 v[100:103], v[12:15], v[144:147], v[100:103]
    v_mfma_f32_16x16x32_bf16 v[104:107], v[8:11], v[152:155], v[104:107]
    v_mfma_f32_16x16x32_bf16 v[108:111], v[12:15], v[152:155], v[108:111]
    ds_read_b128 v[8:11], v6 offset:10240
    ds_read_b128 v[12:15], v6 offset:26624
    s_waitcnt lgkmcnt(2)
    v_mfma_f32_16x16x32_bf16 v[80:83], a[176:179], v[16:19], v[80:83]
    v_mfma_f32_16x16x32_bf16 v[88:91], a[176:179], v[20:23], v[88:91]
    v_mfma_f32_16x16x32_bf16 v[84:87], a[184:187], v[16:19], v[84:87]
    v_mfma_f32_16x16x32_bf16 v[92:95], a[184:187], v[20:23], v[92:95]
    v_mfma_f32_16x16x32_bf16 v[96:99], v[16:19], v[176:179], v[96:99]
    v_mfma_f32_16x16x32_bf16 v[100:103], v[20:23], v[176:179], v[100:103]
    v_mfma_f32_16x16x32_bf16 v[104:107], v[16:19], v[184:187], v[104:107]
    v_mfma_f32_16x16x32_bf16 v[108:111], v[20:23], v[184:187], v[108:111]
    ds_read_b128 v[16:19], v6 offset:11264
    ds_read_b128 v[20:23], v6 offset:27648
    s_waitcnt lgkmcnt(2)
    v_mfma_f32_16x16x32_bf16 v[80:83], a[208:211], v[8:11], v[80:83]
    v_mfma_f32_16x16x32_bf16 v[88:91], a[208:211], v[12:15], v[88:91]
    v_mfma_f32_16x16x32_bf16 v[84:87], a[216:219], v[8:11], v[84:87]
    v_mfma_f32_16x16x32_bf16 v[92:95], a[216:219], v[12:15], v[92:95]
    v_mfma_f32_16x16x32_bf16 v[96:99], v[8:11], v[208:211], v[96:99]
    v_mfma_f32_16x16x32_bf16 v[100:103], v[12:15], v[208:211], v[100:103]
    v_mfma_f32_16x16x32_bf16 v[104:107], v[8:11], v[216:219], v[104:107]
    v_mfma_f32_16x16x32_bf16 v[108:111], v[12:15], v[216:219], v[108:111]
    ds_read_b128 v[8:11], v6 offset:12288
    ds_read_b128 v[12:15], v6 offset:28672
    s_waitcnt lgkmcnt(2)
    v_mfma_f32_16x16x32_bf16 v[80:83], a[240:243], v[16:19], v[80:83]
    v_mfma_f32_16x16x32_bf16 v[88:91], a[240:243], v[20:23], v[88:91]
    v_mfma_f32_16x16x32_bf16 v[84:87], a[248:251], v[16:19], v[84:87]
    v_mfma_f32_16x16x32_bf16 v[92:95], a[248:251], v[20:23], v[92:95]
    v_mfma_f32_16x16x32_bf16 v[96:99], v[16:19], v[240:243], v[96:99]
    v_mfma_f32_16x16x32_bf16 v[100:103], v[20:23], v[240:243], v[100:103]
    v_mfma_f32_16x16x32_bf16 v[104:107], v[16:19], v[248:251], v[104:107]
    v_mfma_f32_16x16x32_bf16 v[108:111], v[20:23], v[248:251], v[108:111]
    ds_read_b128 v[16:19], v6 offset:13312
    ds_read_b128 v[20:23], v6 offset:29696
    s_waitcnt lgkmcnt(2)
    v_mfma_f32_16x16x32_bf16 v[80:83], a[148:151], v[8:11], v[80:83]
    v_mfma_f32_16x16x32_bf16 v[88:91], a[148:151], v[12:15], v[88:91]
    v_mfma_f32_16x16x32_bf16 v[84:87], a[156:159], v[8:11], v[84:87]
    v_mfma_f32_16x16x32_bf16 v[92:95], a[156:159], v[12:15], v[92:95]
    v_mfma_f32_16x16x32_bf16 v[96:99], v[8:11], v[148:151], v[96:99]
    v_mfma_f32_16x16x32_bf16 v[100:103], v[12:15], v[148:151], v[100:103]
    v_mfma_f32_16x16x32_bf16 v[104:107], v[8:11], v[156:159], v[104:107]
    v_mfma_f32_16x16x32_bf16 v[108:111], v[12:15], v[156:159], v[108:111]
    ds_read_b128 v[8:11], v6 offset:14336
    ds_read_b128 v[12:15], v6 offset:30720
    s_waitcnt lgkmcnt(2)
    v_mfma_f32_16x16x32_bf16 v[80:83], a[180:183], v[16:19], v[80:83]
    v_mfma_f32_16x16x32_bf16 v[88:91], a[180:183], v[20:23], v[88:91]
    v_mfma_f32_16x16x32_bf16 v[84:87], a[188:191], v[16:19], v[84:87]
    v_mfma_f32_16x16x32_bf16 v[92:95], a[188:191], v[20:23], v[92:95]
    v_mfma_f32_16x16x32_bf16 v[96:99], v[16:19], v[180:183], v[96:99]
    v_mfma_f32_16x16x32_bf16 v[100:103], v[20:23], v[180:183], v[100:103]
    v_mfma_f32_16x16x32_bf16 v[104:107], v[16:19], v[188:191], v[104:107]
    v_mfma_f32_16x16x32_bf16 v[108:111], v[20:23], v[188:191], v[108:111]
    ds_read_b128 v[16:19], v6 offset:15360
    ds_read_b128 v[20:23], v6 offset:31744
    s_waitcnt lgkmcnt(2)
    v_mfma_f32_16x16x32_bf16 v[80:83], a[212:215], v[8:11], v[80:83]
    v_mfma_f32_16x16x32_bf16 v[88:91], a[212:215], v[12:15], v[88:91]
    v_mfma_f32_16x16x32_bf16 v[84:87], a[220:223], v[8:11], v[84:87]
    v_mfma_f32_16x16x32_bf16 v[92:95], a[220:223], v[12:15], v[92:95]
    v_mfma_f32_16x16x32_bf16 v[96:99], v[8:11], v[212:215], v[96:99]
    v_mfma_f32_16x16x32_bf16 v[100:103], v[12:15], v[212:215], v[100:103]
    v_mfma_f32_16x16x32_bf16 v[104:107], v[8:11], v[220:223], v[104:107]
    v_mfma_f32_16x16x32_bf16 v[108:111], v[12:15], v[220:223], v[108:111]
    s_waitcnt lgkmcnt(0)
    v_mfma_f32_16x16x32_bf16 v[80:83], a[244:247], v[16:19], v[80:83]
    v_mfma_f32_16x16x32_bf16 v[88:91], a[244:247], v[20:23], v[88:91]
    v_mfma_f32_16x16x32_bf16 v[84:87], a[252:255], v[16:19], v[84:87]
    v_mfma_f32_16x16x32_bf16 v[92:95], a[252:255], v[20:23], v[92:95]
    v_mfma_f32_16x16x32_bf16 v[96:99], v[16:19], v[244:247], v[96:99]
    v_mfma_f32_16x16x32_bf16 v[100:103], v[20:23], v[244:247], v[100:103]
    v_mfma_f32_16x16x32_bf16 v[104:107], v[16:19], v[252:255], v[104:107]
    v_mfma_f32_16x16x32_bf16 v[108:111], v[20:23], v[252:255], v[108:111]
    s_mul_i32 s40, s36, 524288
    s_add_u32 s40, s40, 50331648
    s_lshl_b32 s41, s36, 18
    s_add_u32 s41, s41, 33554432
    v_cvt_pk_bf16_f32 v24, v80, v81
    v_cvt_pk_bf16_f32 v25, v82, v83
    v_cvt_pk_bf16_f32 v26, v84, v85
    v_cvt_pk_bf16_f32 v27, v86, v87
    buffer_store_dwordx4 v[24:27], v3, s[8:11], s40 offen offset:0 sc1
    v_cvt_pk_bf16_f32 v28, v88, v89
    v_cvt_pk_bf16_f32 v29, v90, v91
    v_cvt_pk_bf16_f32 v30, v92, v93
    v_cvt_pk_bf16_f32 v31, v94, v95
    buffer_store_dwordx4 v[28:31], v3, s[8:11], s40 offen offset:1024 sc1
    v_cvt_pk_bf16_f32 v32, v96, v97
    v_cvt_pk_bf16_f32 v33, v98, v99
    v_cvt_pk_bf16_f32 v34, v100, v101
    v_cvt_pk_bf16_f32 v35, v102, v103
    buffer_store_dwordx4 v[32:35], v3, s[8:11], s40 offen offset:2048 sc1
    v_cvt_pk_bf16_f32 v36, v104, v105
    v_cvt_pk_bf16_f32 v37, v106, v107
    v_cvt_pk_bf16_f32 v38, v108, v109
    v_cvt_pk_bf16_f32 v39, v110, v111
    buffer_store_dwordx4 v[36:39], v3, s[8:11], s40 offen offset:3072 sc1
    ds_read_b128 v[8:11], v6 offset:0
    ds_read_b128 v[12:15], v6 offset:16384
    ds_read_b128 v[16:19], v6 offset:1024
    ds_read_b128 v[20:23], v6 offset:17408
    s_waitcnt lgkmcnt(2)
    v_mfma_f32_16x16x32_bf16 v[64:67], a[0:3], v[8:11], 0
    v_mfma_f32_16x16x32_bf16 v[72:75], a[0:3], v[12:15], 0
    v_mfma_f32_16x16x32_bf16 v[68:71], a[8:11], v[8:11], 0
    v_mfma_f32_16x16x32_bf16 v[76:79], a[8:11], v[12:15], 0
    ds_read_b128 v[8:11], v6 offset:2048
    ds_read_b128 v[12:15], v6 offset:18432
    s_waitcnt lgkmcnt(2)
    v_mfma_f32_16x16x32_bf16 v[64:67], a[32:35], v[16:19], v[64:67]
    v_mfma_f32_16x16x32_bf16 v[72:75], a[32:35], v[20:23], v[72:75]
    v_mfma_f32_16x16x32_bf16 v[68:71], a[40:43], v[16:19], v[68:71]
    v_mfma_f32_16x16x32_bf16 v[76:79], a[40:43], v[20:23], v[76:79]
    ds_read_b128 v[16:19], v6 offset:3072
    ds_read_b128 v[20:23], v6 offset:19456
    s_waitcnt lgkmcnt(2)
    v_mfma_f32_16x16x32_bf16 v[64:67], a[64:67], v[8:11], v[64:67]
    v_mfma_f32_16x16x32_bf16 v[72:75], a[64:67], v[12:15], v[72:75]
    v_mfma_f32_16x16x32_bf16 v[68:71], a[72:75], v[8:11], v[68:71]
    v_mfma_f32_16x16x32_bf16 v[76:79], a[72:75], v[12:15], v[76:79]
    ds_read_b128 v[8:11], v6 offset:4096
    ds_read_b128 v[12:15], v6 offset:20480
    s_waitcnt lgkmcnt(2)
    v_mfma_f32_16x16x32_bf16 v[64:67], a[96:99], v[16:19], v[64:67]
    v_mfma_f32_16x16x32_bf16 v[72:75], a[96:99], v[20:23], v[72:75]
    v_mfma_f32_16x16x32_bf16 v[68:71], a[104:107], v[16:19], v[68:71]
    v_mfma_f32_16x16x32_bf16 v[76:79], a[104:107], v[20:23], v[76:79]
    ds_read_b128 v[16:19], v6 offset:5120
    ds_read_b128 v[20:23], v6 offset:21504
    s_waitcnt lgkmcnt(2)
    v_mfma_f32_16x16x32_bf16 v[64:67], a[4:7], v[8:11], v[64:67]
    v_mfma_f32_16x16x32_bf16 v[72:75], a[4:7], v[12:15], v[72:75]
    v_mfma_f32_16x16x32_bf16 v[68:71], a[12:15], v[8:11], v[68:71]
    v_mfma_f32_16x16x32_bf16 v[76:79], a[12:15], v[12:15], v[76:79]
    ds_read_b128 v[8:11], v6 offset:6144
    ds_read_b128 v[12:15], v6 offset:22528
    s_waitcnt lgkmcnt(2)
    v_mfma_f32_16x16x32_bf16 v[64:67], a[36:39], v[16:19], v[64:67]
    v_mfma_f32_16x16x32_bf16 v[72:75], a[36:39], v[20:23], v[72:75]
    v_mfma_f32_16x16x32_bf16 v[68:71], a[44:47], v[16:19], v[68:71]
    v_mfma_f32_16x16x32_bf16 v[76:79], a[44:47], v[20:23], v[76:79]
    ds_read_b128 v[16:19], v6 offset:7168
    ds_read_b128 v[20:23], v6 offset:23552
    s_waitcnt lgkmcnt(2)
    v_mfma_f32_16x16x32_bf16 v[64:67], a[68:71], v[8:11], v[64:67]
    v_mfma_f32_16x16x32_bf16 v[72:75], a[68:71], v[12:15], v[72:75]
    v_mfma_f32_16x16x32_bf16 v[68:71], a[76:79], v[8:11], v[68:71]
    v_mfma_f32_16x16x32_bf16 v[76:79], a[76:79], v[12:15], v[76:79]
    ds_read_b128 v[8:11], v6 offset:8192
    ds_read_b128 v[12:15], v6 offset:24576
    s_waitcnt lgkmcnt(2)
    v_mfma_f32_16x16x32_bf16 v[64:67], a[100:103], v[16:19], v[64:67]
    v_mfma_f32_16x16x32_bf16 v[72:75], a[100:103], v[20:23], v[72:75]
    v_mfma_f32_16x16x32_bf16 v[68:71], a[108:111], v[16:19], v[68:71]
    v_mfma_f32_16x16x32_bf16 v[76:79], a[108:111], v[20:23], v[76:79]
    ds_read_b128 v[16:19], v6 offset:9216
    ds_read_b128 v[20:23], v6 offset:25600
    s_waitcnt lgkmcnt(2)
    v_mfma_f32_16x16x32_bf16 v[64:67], a[16:19], v[8:11], v[64:67]
    v_mfma_f32_16x16x32_bf16 v[72:75], a[16:19], v[12:15], v[72:75]
    v_mfma_f32_16x16x32_bf16 v[68:71], a[24:27], v[8:11], v[68:71]
    v_mfma_f32_16x16x32_bf16 v[76:79], a[24:27], v[12:15], v[76:79]
    ds_read_b128 v[8:11], v6 offset:10240
    ds_read_b128 v[12:15], v6 offset:26624
    s_waitcnt lgkmcnt(2)
    v_mfma_f32_16x16x32_bf16 v[64:67], a[48:51], v[16:19], v[64:67]
    v_mfma_f32_16x16x32_bf16 v[72:75], a[48:51], v[20:23], v[72:75]
    v_mfma_f32_16x16x32_bf16 v[68:71], a[56:59], v[16:19], v[68:71]
    v_mfma_f32_16x16x32_bf16 v[76:79], a[56:59], v[20:23], v[76:79]
    ds_read_b128 v[16:19], v6 offset:11264
    ds_read_b128 v[20:23], v6 offset:27648
    s_waitcnt lgkmcnt(2)
    v_mfma_f32_16x16x32_bf16 v[64:67], a[80:83], v[8:11], v[64:67]
    v_mfma_f32_16x16x32_bf16 v[72:75], a[80:83], v[12:15], v[72:75]
    v_mfma_f32_16x16x32_bf16 v[68:71], a[88:91], v[8:11], v[68:71]
    v_mfma_f32_16x16x32_bf16 v[76:79], a[88:91], v[12:15], v[76:79]
    ds_read_b128 v[8:11], v6 offset:12288
    ds_read_b128 v[12:15], v6 offset:28672
    s_waitcnt lgkmcnt(2)
    v_mfma_f32_16x16x32_bf16 v[64:67], a[112:115], v[16:19], v[64:67]
    v_mfma_f32_16x16x32_bf16 v[72:75], a[112:115], v[20:23], v[72:75]
    v_mfma_f32_16x16x32_bf16 v[68:71], a[120:123], v[16:19], v[68:71]
    v_mfma_f32_16x16x32_bf16 v[76:79], a[120:123], v[20:23], v[76:79]
    ds_read_b128 v[16:19], v6 offset:13312
    ds_read_b128 v[20:23], v6 offset:29696
    s_waitcnt lgkmcnt(2)
    v_mfma_f32_16x16x32_bf16 v[64:67], a[20:23], v[8:11], v[64:67]
    v_mfma_f32_16x16x32_bf16 v[72:75], a[20:23], v[12:15], v[72:75]
    v_mfma_f32_16x16x32_bf16 v[68:71], a[28:31], v[8:11], v[68:71]
    v_mfma_f32_16x16x32_bf16 v[76:79], a[28:31], v[12:15], v[76:79]
    ds_read_b128 v[8:11], v6 offset:14336
    ds_read_b128 v[12:15], v6 offset:30720
    s_waitcnt lgkmcnt(2)
    v_mfma_f32_16x16x32_bf16 v[64:67], a[52:55], v[16:19], v[64:67]
    v_mfma_f32_16x16x32_bf16 v[72:75], a[52:55], v[20:23], v[72:75]
    v_mfma_f32_16x16x32_bf16 v[68:71], a[60:63], v[16:19], v[68:71]
    v_mfma_f32_16x16x32_bf16 v[76:79], a[60:63], v[20:23], v[76:79]
    ds_read_b128 v[16:19], v6 offset:15360
    ds_read_b128 v[20:23], v6 offset:31744
    s_waitcnt lgkmcnt(2)
    v_mfma_f32_16x16x32_bf16 v[64:67], a[84:87], v[8:11], v[64:67]
    v_mfma_f32_16x16x32_bf16 v[72:75], a[84:87], v[12:15], v[72:75]
    v_mfma_f32_16x16x32_bf16 v[68:71], a[92:95], v[8:11], v[68:71]
    v_mfma_f32_16x16x32_bf16 v[76:79], a[92:95], v[12:15], v[76:79]
    s_waitcnt lgkmcnt(0)
    v_mfma_f32_16x16x32_bf16 v[64:67], a[116:119], v[16:19], v[64:67]
    v_mfma_f32_16x16x32_bf16 v[72:75], a[116:119], v[20:23], v[72:75]
    v_mfma_f32_16x16x32_bf16 v[68:71], a[124:127], v[16:19], v[68:71]
    v_mfma_f32_16x16x32_bf16 v[76:79], a[124:127], v[20:23], v[76:79]
    s_lshl_b32 s45, s20, 8
    s_lshl_b32 s40, s36, 2
    s_add_u32 s45, s45, s40
    s_waitcnt vmcnt(0)
    s_barrier
    s_cmp_lg_u32 s21, 0
    s_cbranch_scc1 QF_19
    s_mov_b64 exec, 1
    buffer_store_dword v5, off, s[8:11], s45 sc1
    s_cmp_eq_u32 s38, -1
    s_cbranch_scc1 QG_20
    buffer_store_dword v7, off, s[8:11], s38 sc1
QG_20:
    s_mov_b64 exec, -1
QF_19:
    v_cvt_pk_bf16_f32 v40, v64, v65
    v_cvt_pk_bf16_f32 v41, v66, v67
    v_cvt_pk_bf16_f32 v42, v68, v69
    v_cvt_pk_bf16_f32 v43, v70, v71
    buffer_store_dwordx4 v[40:43], v4, s[8:11], s41 offen offset:0 sc1
    v_cvt_pk_bf16_f32 v44, v72, v73
    v_cvt_pk_bf16_f32 v45, v74, v75
    v_cvt_pk_bf16_f32 v46, v76, v77
    v_cvt_pk_bf16_f32 v47, v78, v79
    buffer_store_dwordx4 v[44:47], v4, s[8:11], s41 offen offset:1024 sc1
    s_mov_b32 s38, s45
    s_mov_b32 s36, s42
    s_xor_b32 s37, s37, 32768
    s_cmp_lt_u32 s36, 64
    s_cbranch_scc1 QL_17
    s_waitcnt vmcnt(0)
    s_barrier
    s_cmp_lg_u32 s21, 0
    s_cbranch_scc1 QE_18
    s_mov_b64 exec, 1
    buffer_store_dword v7, off, s[8:11], s38 sc1
    s_mov_b64 exec, -1
QE_18:
    s_cmp_lg_u32 s21, 0
    s_cbranch_scc1 PD_22
    s_mov_b32 s23, 0
PL_21:
    buffer_load_dword v61, off, s[16:19], 0 offset:148 sc1
    s_waitcnt vmcnt(0)
    v_readfirstlane_b32 s40, v61
    s_nop 0
    s_cmp_ge_u32 s40, 1
    s_cbranch_scc1 PD_22
    s_sleep 2
    s_add_u32 s23, s23, 1
    s_cmp_lt_u32 s23, 400000
    s_cbranch_scc1 PL_21
    s_branch m_exit
PD_22:
    s_barrier
    s_cmp_lt_u32 s6, 3
    s_cbranch_scc1 m_ab
    s_mul_i32 s5, s20, 4
    s_add_u32 s5, s5, s6
    s_sub_u32 s5, s5, 3
    v_lshlrev_b32 v1, 4, v0
    v_mov_b64 v[4:5], -1
    v_mov_b64 v[6:7], -1
    s_mul_i32 s37, s5, 32768
    s_min_u32 s38, s37, 4190208
    s_add_u32 s38, s38, 163577856
    buffer_store_dwordx4 v[4:7], v1, s[8:11], s38 offen sc1
    s_add_u32 s37, s37, 4096
    s_min_u32 s38, s37, 4190208
    s_add_u32 s38, s38, 163577856
    buffer_store_dwordx4 v[4:7], v1, s[8:11], s38 offen sc1
    s_add_u32 s37, s37, 4096
    s_min_u32 s38, s37, 4190208
    s_add_u32 s38, s38, 163577856
    buffer_store_dwordx4 v[4:7], v1, s[8:11], s38 offen sc1
    s_add_u32 s37, s37, 4096
    s_min_u32 s38, s37, 4190208
    s_add_u32 s38, s38, 163577856
    buffer_store_dwordx4 v[4:7], v1, s[8:11], s38 offen sc1
    s_add_u32 s37, s37, 4096
    s_min_u32 s38, s37, 4190208
    s_add_u32 s38, s38, 163577856
    buffer_store_dwordx4 v[4:7], v1, s[8:11], s38 offen sc1
    s_add_u32 s37, s37, 4096
    s_min_u32 s38, s37, 4190208
    s_add_u32 s38, s38, 163577856
    buffer_store_dwordx4 v[4:7], v1, s[8:11], s38 offen sc1
    s_add_u32 s37, s37, 4096
    s_min_u32 s38, s37, 4190208
    s_add_u32 s38, s38, 163577856
    buffer_store_dwordx4 v[4:7], v1, s[8:11], s38 offen sc1
    s_add_u32 s37, s37, 4096
    s_min_u32 s38, s37, 4190208
    s_add_u32 s38, s38, 163577856
    buffer_store_dwordx4 v[4:7], v1, s[8:11], s38 offen sc1
    s_add_u32 s37, s37, 4096
    s_mul_i32 s37, s5, 4096
    s_min_u32 s38, s37, 126976
    s_add_u32 s38, s38, 10354688
    buffer_store_dwordx4 v[4:7], v1, s[8:11], s38 offen sc1
    s_add_u32 s37, s37, 4096
    s_mul_i32 s37, s5, 4096
    s_min_u32 s38, s37, 348160
    s_add_u32 s38, s38, 15769600
    buffer_store_dwordx4 v[4:7], v1, s[8:11], s38 offen sc1
    s_add_u32 s37, s37, 4096
    s_waitcnt vmcnt(0)
    s_barrier
    s_cmp_lg_u32 s21, 0
    s_cbranch_scc1 SG_23
    v_mov_b32 v61, 1
    s_mov_b64 exec, 1
    buffer_atomic_add v61, off, s[16:19], 0 offset:68 sc0
    s_waitcnt vmcnt(0)
    v_readfirstlane_b32 s40, v61
    s_mov_b64 exec, -1
    s_cmp_lg_u32 s40, 127
    s_cbranch_scc1 SG_23
    buffer_store_dword v61, off, s[16:19], 0 offset:196 sc1
SG_23:
    s_cmp_lt_u32 s5, 52
    s_cbranch_scc1 m_r1
    s_sub_u32 s5, s5, 52
    s_cmp_lt_u32 s5, 44
    s_cbranch_scc1 m_c
    s_sub_u32 s5, s5, 44
    s_cmp_lt_u32 s5, 32
    s_cbranch_scc0 m_exit
    s_load_dwordx2 s[84:85], s[0:1], 80
    s_load_dwordx2 s[86:87], s[0:1], 104
    s_waitcnt lgkmcnt(0)
    s_barrier
    s_mov_b32 s44, s84
    s_and_b32 s45, s85, 0xffff
    s_mov_b32 s46, 0x158000
    s_mov_b32 s47, 0x20000
    s_mov_b32 s48, s86
    s_and_b32 s49, s87, 0xffff
    s_mov_b32 s50, 0x200000
    s_mov_b32 s51, 0x20000
    v_and_b32 v61, 15, v60
    v_lshrrev_b32 v62, 4, v60
    v_bfe_u32 v63, v60, 2, 2
    v_and_b32 v64, 3, v60
    s_lshl_b32 s42, s21, 15
    s_add_u32 s42, s42, 32768
    s_and_b32 s37, s5, 15
    s_lshr_b32 s36, s5, 4
    v_lshrrev_b32 v65, 2, v60
    v_lshlrev_b32 v65, 10, v65
    v_lshlrev_b32 v66, 4, v64
    s_mul_i32 s40, s21, 360448
    s_lshl_b32 s41, s37, 6
    s_add_u32 s40, s40, s41
    v_add3_u32 v65, v65, v66, s40
    s_add_u32 m0, s42, 0
    s_mov_b32 s43, 0
    buffer_load_dwordx4 v65, s[44:47], s43 offen lds
    s_add_u32 m0, s42, 1024
    s_mov_b32 s43, 16384
    buffer_load_dwordx4 v65, s[44:47], s43 offen lds
    s_add_u32 m0, s42, 2048
    s_mov_b32 s43, 32768
    buffer_load_dwordx4 v65, s[44:47], s43 offen lds
    s_add_u32 m0, s42, 3072
    s_mov_b32 s43, 49152
    buffer_load_dwordx4 v65, s[44:47], s43 offen lds
    s_add_u32 m0, s42, 4096
    s_mov_b32 s43, 65536
    buffer_load_dwordx4 v65, s[44:47], s43 offen lds
    s_add_u32 m0, s42, 5120
    s_mov_b32 s43, 81920
    buffer_load_dwordx4 v65, s[44:47], s43 offen lds
    s_add_u32 m0, s42, 6144
    s_mov_b32 s43, 98304
    buffer_load_dwordx4 v65, s[44:47], s43 offen lds
    s_add_u32 m0, s42, 7168
    s_mov_b32 s43, 114688
    buffer_load_dwordx4 v65, s[44:47], s43 offen lds
    s_add_u32 m0, s42, 8192
    s_mov_b32 s43, 131072
    buffer_load_dwordx4 v65, s[44:47], s43 offen lds
    s_add_u32 m0, s42, 9216
    s_mov_b32 s43, 147456
    buffer_load_dwordx4 v65, s[44:47], s43 offen lds
    s_add_u32 m0, s42, 10240
    s_mov_b32 s43, 163840
    buffer_load_dwordx4 v65, s[44:47], s43 offen lds
    s_add_u32 m0, s42, 11264
    s_mov_b32 s43, 180224
    buffer_load_dwordx4 v65, s[44:47], s43 offen lds
    s_add_u32 m0, s42, 12288
    s_mov_b32 s43, 196608
    buffer_load_dwordx4 v65, s[44:47], s43 offen lds
    s_add_u32 m0, s42, 13312
    s_mov_b32 s43, 212992
    buffer_load_dwordx4 v65, s[44:47], s43 offen lds
    s_add_u32 m0, s42, 14336
    s_mov_b32 s43, 229376
    buffer_load_dwordx4 v65, s[44:47], s43 offen lds
    s_add_u32 m0, s42, 15360
    s_mov_b32 s43, 245760
    buffer_load_dwordx4 v65, s[44:47], s43 offen lds
    s_add_u32 m0, s42, 16384
    s_mov_b32 s43, 262144
    buffer_load_dwordx4 v65, s[44:47], s43 offen lds
    s_add_u32 m0, s42, 17408
    s_mov_b32 s43, 278528
    buffer_load_dwordx4 v65, s[44:47], s43 offen lds
    s_add_u32 m0, s42, 18432
    s_mov_b32 s43, 294912
    buffer_load_dwordx4 v65, s[44:47], s43 offen lds
    s_add_u32 m0, s42, 19456
    s_mov_b32 s43, 311296
    buffer_load_dwordx4 v65, s[44:47], s43 offen lds
    s_add_u32 m0, s42, 20480
    s_mov_b32 s43, 327680
    buffer_load_dwordx4 v65, s[44:47], s43 offen lds
    s_add_u32 m0, s42, 21504
    s_mov_b32 s43, 344064
    buffer_load_dwordx4 v65, s[44:47], s43 offen lds
    v_lshlrev_b32 v66, 2, v62
    v_add_u32 v66, v66, v63
    v_lshlrev_b32 v66, 6, v66
    v_lshlrev_b32 v67, 3, v64
    v_add3_u32 v66, v66, v67, s42
    s_waitcnt vmcnt(20)
    ds_read_b64_tr_b16 a[0:1], v66 offset:0
    ds_read_b64_tr_b16 a[2:3], v66 offset:1024
    ds_read_b64_tr_b16 a[4:5], v66 offset:32
    ds_read_b64_tr_b16 a[6:7], v66 offset:1056
    s_waitcnt vmcnt(18)
    ds_read_b64_tr_b16 a[8:9], v66 offset:2048
    ds_read_b64_tr_b16 a[10:11], v66 offset:3072
    ds_read_b64_tr_b16 a[12:13], v66 offset:2080
    ds_read_b64_tr_b16 a[14:15], v66 offset:3104
    s_waitcnt vmcnt(16)
    ds_read_b64_tr_b16 a[16:17], v66 offset:4096
    ds_read_b64_tr_b16 a[18:19], v66 offset:5120
    ds_read_b64_tr_b16 a[20:21], v66 offset:4128
    ds_read_b64_tr_b16 a[22:23], v66 offset:5152
    s_waitcnt vmcnt(14)
    ds_read_b64_tr_b16 a[24:25], v66 offset:6144
    ds_read_b64_tr_b16 a[26:27], v66 offset:7168
    ds_read_b64_tr_b16 a[28:29], v66 offset:6176
    ds_read_b64_tr_b16 a[30:31], v66 offset:7200
    s_waitcnt vmcnt(12)
    ds_read_b64_tr_b16 a[32:33], v66 offset:8192
    ds_read_b64_tr_b16 a[34:35], v66 offset:9216
    ds_read_b64_tr_b16 a[36:37], v66 offset:8224
    ds_read_b64_tr_b16 a[38:39], v66 offset:9248
    s_waitcnt vmcnt(10)
    ds_read_b64_tr_b16 a[40:41], v66 offset:10240
    ds_read_b64_tr_b16 a[42:43], v66 offset:11264
    ds_read_b64_tr_b16 a[44:45], v66 offset:10272
    ds_read_b64_tr_b16 a[46:47], v66 offset:11296
    s_waitcnt vmcnt(8)
    ds_read_b64_tr_b16 a[48:49], v66 offset:12288
    ds_read_b64_tr_b16 a[50:51], v66 offset:13312
    ds_read_b64_tr_b16 a[52:53], v66 offset:12320
    ds_read_b64_tr_b16 a[54:55], v66 offset:13344
    s_waitcnt vmcnt(6)
    ds_read_b64_tr_b16 a[56:57], v66 offset:14336
    ds_read_b64_tr_b16 a[58:59], v66 offset:15360
    ds_read_b64_tr_b16 a[60:61], v66 offset:14368
    ds_read_b64_tr_b16 a[62:63], v66 offset:15392
    s_waitcnt vmcnt(4)
    ds_read_b64_tr_b16 a[64:65], v66 offset:16384
    ds_read_b64_tr_b16 a[66:67], v66 offset:17408
    ds_read_b64_tr_b16 a[68:69], v66 offset:16416
    ds_read_b64_tr_b16 a[70:71], v66 offset:17440
    s_waitcnt vmcnt(2)
    ds_read_b64_tr_b16 a[72:73], v66 offset:18432
    ds_read_b64_tr_b16 a[74:75], v66 offset:19456
    ds_read_b64_tr_b16 a[76:77], v66 offset:18464
    ds_read_b64_tr_b16 a[78:79], v66 offset:19488
    s_waitcnt vmcnt(0)
    ds_read_b64_tr_b16 a[80:81], v66 offset:20480
    ds_read_b64_tr_b16 a[82:83], v66 offset:21504
    ds_read_b64_tr_b16 a[84:85], v66 offset:20512
    ds_read_b64_tr_b16 a[86:87], v66 offset:21536
    v_lshlrev_b32 v1, 4, v60
    s_mul_i32 s40, s21, 11264
    v_add_u32 v2, s40, v1
    s_lshl_b32 s40, s21, 12
    v_add_u32 v3, s40, v1
    s_lshl_b32 s40, s21, 10
    v_add_u32 v4, s40, v1
    s_lshr_b32 s40, s21, 1
    s_lshl_b32 s40, s40, 4
    s_lshl_b32 s41, s37, 5
    s_add_u32 s40, s40, s41
    v_lshlrev_b32 v65, 2, v62
    v_add_u32 v65, s40, v65
    v_lshlrev_b32 v66, 2, v65
    s_mov_b32 s43, 75776
    buffer_load_dwordx4 v[8:11], v66, s[8:11], s43 offen sc1
    v_lshlrev_b32 v65, 1, v65
    v_lshlrev_b32 v66, 10, v61
    s_and_b32 s40, s21, 1
    s_lshl_b32 s40, s40, 14
    v_add3_u32 v5, v65, v66, s40
    v_bfe_u32 v65, v60, 1, 4
    s_cmp_eq_u32 s21, 3
    s_cselect_b32 s40, 9, 10
    v_min_u32 v65, s40, v65
    v_lshlrev_b32 v65, 10, v65
    v_and_b32 v66, 1, v60
    v_lshlrev_b32 v66, 3, v66
    v_sub_u32 v67, v2, v1
    v_add3_u32 v65, v65, v66, v67
    v_lshrrev_b32 v66, 5, v60
    v_mul_u32_u24 v66, 44032, v66
    v_add_u32 v120, v65, v66
    v_mov_b64 v[112:113], 0
    v_mov_b64 v[114:115], 0
    v_mov_b64 v[116:117], 0
    v_mov_b64 v[118:119], 0
    s_waitcnt lgkmcnt(0)
DL_24:
    s_sub_u32 s40, s36, 40
    s_cmp_ge_u32 s40, 2
    s_cbranch_scc1 FG_27
    s_cmp_lg_u32 s21, 0
    s_cbranch_scc1 PD_29
    s_mov_b32 s23, 0
PL_28:
    buffer_load_dword v6, off, s[16:19], 0 offset:196 sc1
    s_waitcnt vmcnt(0)
    v_readfirstlane_b32 s40, v6
    s_nop 0
    s_cmp_ge_u32 s40, 1
    s_cbranch_scc1 PD_29
    s_sleep 2
    s_add_u32 s23, s23, 1
    s_cmp_lt_u32 s23, 400000
    s_cbranch_scc1 PL_28
    s_branch m_exit
PD_29:
    s_barrier
FG_27:
    s_lshl_b32 s52, s36, 7
    s_cmp_ge_u32 s36, 60
    s_cselect_b32 s53, 0, 8192
    s_cselect_b32 s55, 32, 22
    s_add_u32 s52, s52, s53
    s_add_u32 s52, s52, 16384
    s_cmp_lg_u32 s21, 0
    s_cbranch_scc1 PD_31
    s_mov_b32 s23, 0
PL_30:
    buffer_load_dword v6, off, s[8:11], s52 offset:0 sc1
    s_waitcnt vmcnt(0)
    v_readfirstlane_b32 s40, v6
    s_nop 0
    s_cmp_ge_u32 s40, s55
    s_cbranch_scc1 PD_31
    s_sleep 4
    s_add_u32 s23, s23, 1
    s_cmp_lt_u32 s23, 400000
    s_cbranch_scc1 PL_30
    s_branch m_exit
PD_31:
    s_barrier
    s_mul_i32 s40, s36, 88064
    s_add_u32 s40, s40, 10485760
    s_lshl_b32 s53, s36, 15
    s_add_u32 s54, s53, 6291456
    buffer_load_dwordx2 v[6:7], v5, s[8:11], s54 offen sc1
    s_mov_b32 s58, s40
    s_cmp_lt_u32 s36, 60
    s_cbranch_scc1 DX_32
    s_mov_b32 s23, 0
CY_34:
    buffer_load_dword v24, v120, s[8:11], s58 offen sc1
    s_add_u32 s23, s23, 1
    s_cmp_ge_u32 s23, 400000
    s_cbranch_scc1 m_exit
    s_waitcnt vmcnt(0)
    v_cmp_eq_u32 vcc, -1, v24
    s_cbranch_vccz CZ_35
    s_sleep 1
    s_branch CY_34
CZ_35:
DX_32:
    s_mov_b32 s56, s58
    s_add_u32 s57, s58, 44032
    buffer_load_dwordx4 v[32:35], v2, s[8:11], s56 offen offset:0 sc1
    buffer_load_dwordx4 v[36:39], v2, s[8:11], s57 offen offset:0 sc1
    buffer_load_dwordx4 v[40:43], v2, s[8:11], s56 offen offset:1024 sc1
    buffer_load_dwordx4 v[44:47], v2, s[8:11], s57 offen offset:1024 sc1
    buffer_load_dwordx4 v[48:51], v2, s[8:11], s56 offen offset:2048 sc1
    buffer_load_dwordx4 v[52:55], v2, s[8:11], s57 offen offset:2048 sc1
    buffer_load_dwordx4 v[56:59], v2, s[8:11], s56 offen offset:3072 sc1
    buffer_load_dwordx4 v[60:63], v2, s[8:11], s57 offen offset:3072 sc1
    s_add_u32 s56, s56, 4096
    s_add_u32 s57, s57, 4096
    buffer_load_dwordx4 v[64:67], v2, s[8:11], s56 offen offset:0 sc1
    buffer_load_dwordx4 v[68:71], v2, s[8:11], s57 offen offset:0 sc1
    buffer_load_dwordx4 v[72:75], v2, s[8:11], s56 offen offset:1024 sc1
    buffer_load_dwordx4 v[76:79], v2, s[8:11], s57 offen offset:1024 sc1
    buffer_load_dwordx4 v[80:83], v2, s[8:11], s56 offen offset:2048 sc1
    buffer_load_dwordx4 v[84:87], v2, s[8:11], s57 offen offset:2048 sc1
    buffer_load_dwordx4 v[88:91], v2, s[8:11], s56 offen offset:3072 sc1
    buffer_load_dwordx4 v[92:95], v2, s[8:11], s57 offen offset:3072 sc1
    s_add_u32 s56, s56, 4096
    s_add_u32 s57, s57, 4096
    buffer_load_dwordx4 v[96:99], v2, s[8:11], s56 offen offset:0 sc1
    buffer_load_dwordx4 v[100:103], v2, s[8:11], s57 offen offset:0 sc1
    buffer_load_dwordx4 v[104:107], v2, s[8:11], s56 offen offset:1024 sc1
    buffer_load_dwordx4 v[108:111], v2, s[8:11], s57 offen offset:1024 sc1
    s_cmp_eq_u32 s21, 3
    s_cbranch_scc1 DS_25
    buffer_load_dwordx4 v[112:115], v2, s[8:11], s56 offen offset:2048 sc1
    buffer_load_dwordx4 v[116:119], v2, s[8:11], s57 offen offset:2048 sc1
DS_25:
    s_cmp_lt_u32 s36, 60
    s_cbranch_scc1 DY_33
    s_waitcnt vmcnt(0)
    v_max3_u32 v24, v32, v33, v34
    v_max3_u32 v24, v24, v35, v36
    v_max3_u32 v24, v24, v37, v38
    v_max3_u32 v24, v24, v39, v40
    v_max3_u32 v24, v24, v41, v42
    v_max3_u32 v24, v24, v43, v44
    v_max3_u32 v24, v24, v45, v46
    v_max3_u32 v24, v24, v47, v48
    v_max3_u32 v24, v24, v49, v50
    v_max3_u32 v24, v24, v51, v52
    v_max3_u32 v24, v24, v53, v54
    v_max3_u32 v24, v24, v55, v56
    v_max3_u32 v24, v24, v57, v58
    v_max3_u32 v24, v24, v59, v60
    v_max3_u32 v24, v24, v61, v62
    v_max3_u32 v24, v24, v63, v64
    v_max3_u32 v24, v24, v65, v66
    v_max3_u32 v24, v24, v67, v68
    v_max3_u32 v24, v24, v69, v70
    v_max3_u32 v24, v24, v71, v72
    v_max3_u32 v24, v24, v73, v74
    v_max3_u32 v24, v24, v75, v76
    v_max3_u32 v24, v24, v77, v78
    v_max3_u32 v24, v24, v79, v80
    v_max3_u32 v24, v24, v81, v82
    v_max3_u32 v24, v24, v83, v84
    v_max3_u32 v24, v24, v85, v86
    v_max3_u32 v24, v24, v87, v88
    v_max3_u32 v24, v24, v89, v90
    v_max3_u32 v24, v24, v91, v92
    v_max3_u32 v24, v24, v93, v94
    v_max3_u32 v24, v24, v95, v96
    v_max3_u32 v24, v24, v97, v98
    v_max3_u32 v24, v24, v99, v100
    v_max3_u32 v24, v24, v101, v102
    v_max3_u32 v24, v24, v103, v104
    v_max3_u32 v24, v24, v105, v106
    v_max3_u32 v24, v24, v107, v108
    v_max3_u32 v24, v24, v109, v110
    v_max3_u32 v24, v24, v111, v112
    v_max3_u32 v24, v24, v113, v114
    v_max3_u32 v24, v24, v115, v116
    v_max3_u32 v24, v24, v117, v118
    v_max_u32 v24, v24, v119
    v_cmp_eq_u32 vcc, -1, v24
    s_cbranch_vccnz CY_34
DY_33:
    s_waitcnt vmcnt(18)
    v_mfma_f32_16x16x32_bf16 v[12:15], a[0:3], v[32:35], 0
    v_mfma_f32_16x16x32_bf16 v[16:19], a[0:3], v[36:39], 0
    v_mfma_f32_16x16x32_bf16 v[20:23], a[4:7], v[32:35], 0
    v_mfma_f32_16x16x32_bf16 v[24:27], a[4:7], v[36:39], 0
    s_waitcnt vmcnt(16)
    v_mfma_f32_16x16x32_bf16 v[12:15], a[8:11], v[40:43], v[12:15]
    v_mfma_f32_16x16x32_bf16 v[16:19], a[8:11], v[44:47], v[16:19]
    v_mfma_f32_16x16x32_bf16 v[20:23], a[12:15], v[40:43], v[20:23]
    v_mfma_f32_16x16x32_bf16 v[24:27], a[12:15], v[44:47], v[24:27]
    s_waitcnt vmcnt(14)
    v_mfma_f32_16x16x32_bf16 v[12:15], a[16:19], v[48:51], v[12:15]
    v_mfma_f32_16x16x32_bf16 v[16:19], a[16:19], v[52:55], v[16:19]
    v_mfma_f32_16x16x32_bf16 v[20:23], a[20:23], v[48:51], v[20:23]
    v_mfma_f32_16x16x32_bf16 v[24:27], a[20:23], v[52:55], v[24:27]
    s_waitcnt vmcnt(12)
    v_mfma_f32_16x16x32_bf16 v[12:15], a[24:27], v[56:59], v[12:15]
    v_mfma_f32_16x16x32_bf16 v[16:19], a[24:27], v[60:63], v[16:19]
    v_mfma_f32_16x16x32_bf16 v[20:23], a[28:31], v[56:59], v[20:23]
    v_mfma_f32_16x16x32_bf16 v[24:27], a[28:31], v[60:63], v[24:27]
    s_waitcnt vmcnt(10)
    v_mfma_f32_16x16x32_bf16 v[12:15], a[32:35], v[64:67], v[12:15]
    v_mfma_f32_16x16x32_bf16 v[16:19], a[32:35], v[68:71], v[16:19]
    v_mfma_f32_16x16x32_bf16 v[20:23], a[36:39], v[64:67], v[20:23]
    v_mfma_f32_16x16x32_bf16 v[24:27], a[36:39], v[68:71], v[24:27]
    s_waitcnt vmcnt(8)
    v_mfma_f32_16x16x32_bf16 v[12:15], a[40:43], v[72:75], v[12:15]
    v_mfma_f32_16x16x32_bf16 v[16:19], a[40:43], v[76:79], v[16:19]
    v_mfma_f32_16x16x32_bf16 v[20:23], a[44:47], v[72:75], v[20:23]
    v_mfma_f32_16x16x32_bf16 v[24:27], a[44:47], v[76:79], v[24:27]
    s_waitcnt vmcnt(6)
    v_mfma_f32_16x16x32_bf16 v[12:15], a[48:51], v[80:83], v[12:15]
    v_mfma_f32_16x16x32_bf16 v[16:19], a[48:51], v[84:87], v[16:19]
    v_mfma_f32_16x16x32_bf16 v[20:23], a[52:55], v[80:83], v[20:23]
    v_mfma_f32_16x16x32_bf16 v[24:27], a[52:55], v[84:87], v[24:27]
    s_waitcnt vmcnt(4)
    v_mfma_f32_16x16x32_bf16 v[12:15], a[56:59], v[88:91], v[12:15]
    v_mfma_f32_16x16x32_bf16 v[16:19], a[56:59], v[92:95], v[16:19]
    v_mfma_f32_16x16x32_bf16 v[20:23], a[60:63], v[88:91], v[20:23]
    v_mfma_f32_16x16x32_bf16 v[24:27], a[60:63], v[92:95], v[24:27]
    s_waitcnt vmcnt(2)
    v_mfma_f32_16x16x32_bf16 v[12:15], a[64:67], v[96:99], v[12:15]
    v_mfma_f32_16x16x32_bf16 v[16:19], a[64:67], v[100:103], v[16:19]
    v_mfma_f32_16x16x32_bf16 v[20:23], a[68:71], v[96:99], v[20:23]
    v_mfma_f32_16x16x32_bf16 v[24:27], a[68:71], v[100:103], v[24:27]
    s_waitcnt vmcnt(0)
    v_mfma_f32_16x16x32_bf16 v[12:15], a[72:75], v[104:107], v[12:15]
    v_mfma_f32_16x16x32_bf16 v[16:19], a[72:75], v[108:111], v[16:19]
    v_mfma_f32_16x16x32_bf16 v[20:23], a[76:79], v[104:107], v[20:23]
    v_mfma_f32_16x16x32_bf16 v[24:27], a[76:79], v[108:111], v[24:27]
    s_waitcnt vmcnt(0)
    s_cmp_eq_u32 s21, 3
    s_cbranch_scc1 DT_26
    v_mfma_f32_16x16x32_bf16 v[12:15], a[80:83], v[112:115], v[12:15]
    v_mfma_f32_16x16x32_bf16 v[16:19], a[80:83], v[116:119], v[16:19]
    v_mfma_f32_16x16x32_bf16 v[20:23], a[84:87], v[112:115], v[20:23]
    v_mfma_f32_16x16x32_bf16 v[24:27], a[84:87], v[116:119], v[24:27]
DT_26:
    s_nop 4
    ds_write_b128 v3, v[12:15] offset:0
    ds_write_b128 v3, v[16:19] offset:1024
    ds_write_b128 v3, v[20:23] offset:2048
    ds_write_b128 v3, v[24:27] offset:3072
    s_waitcnt lgkmcnt(0)
    s_barrier
    ds_read_b128 v[32:35], v4 offset:0
    ds_read_b128 v[36:39], v4 offset:4096
    ds_read_b128 v[40:43], v4 offset:8192
    ds_read_b128 v[44:47], v4 offset:12288
    v_and_b32 v29, 0xffff0000, v6
    v_lshlrev_b32 v28, 16, v6
    v_and_b32 v31, 0xffff0000, v7
    v_lshlrev_b32 v30, 16, v7
    s_waitcnt lgkmcnt(0)
    v_add_f32 v32, v32, v36
    v_add_f32 v40, v40, v44
    v_add_f32 v33, v33, v37
    v_add_f32 v41, v41, v45
    v_add_f32 v34, v34, v38
    v_add_f32 v42, v42, v46
    v_add_f32 v35, v35, v39
    v_add_f32 v43, v43, v47
    v_add_f32 v32, v32, v40
    v_add_f32 v33, v33, v41
    v_add_f32 v34, v34, v42
    v_add_f32 v35, v35, v43
    v_fma_f32 v32, v32, v8, v28
    v_fma_f32 v33, v33, v9, v29
    v_fma_f32 v34, v34, v10, v30
    v_fma_f32 v35, v35, v11, v31
    v_cvt_pk_bf16_f32 v6, v32, v33
    v_cvt_pk_bf16_f32 v7, v34, v35
    buffer_store_dwordx2 v[6:7], v5, s[48:51], s53 offen
    s_barrier
    s_add_u32 s36, s36, 2
    s_cmp_lt_u32 s36, 63
    s_cbranch_scc1 DL_24
    s_branch m_fin
m_c:
    s_load_dwordx4 s[84:87], s[0:1], 64
    s_waitcnt lgkmcnt(0)
    s_barrier
    s_mov_b32 s44, s84
    s_and_b32 s45, s85, 0xffff
    s_mov_b32 s46, 0x158000
    s_mov_b32 s47, 0x20000
    s_mov_b32 s48, s86
    s_and_b32 s49, s87, 0xffff
    s_mov_b32 s50, 0x158000
    s_mov_b32 s51, 0x20000
    v_and_b32 v61, 15, v60
    v_lshrrev_b32 v62, 4, v60
    v_bfe_u32 v63, v60, 2, 2
    v_and_b32 v64, 3, v60
    s_lshl_b32 s42, s21, 15
    s_add_u32 s42, s42, 32768
    s_cmp_ge_u32 s5, 22
    s_cselect_b32 s36, 1, 0
    s_cselect_b32 s40, 22, 0
    s_sub_u32 s37, s5, s40
    v_lshrrev_b32 v65, 1, v60
    v_mul_u32_u24 v65, 2752, v65
    v_and_b32 v66, 1, v60
    v_lshlrev_b32 v66, 4, v66
    s_lshl_b32 s40, s37, 7
    s_lshl_b32 s41, s21, 5
    s_add_u32 s40, s40, s41
    v_add3_u32 v65, v65, v66, s40
    s_add_u32 m0, s42, 0
    s_mov_b32 s43, 0
    buffer_load_dwordx4 v65, s[44:47], s43 offen lds
    s_add_u32 m0, s42, 1024
    s_mov_b32 s43, 88064
    buffer_load_dwordx4 v65, s[44:47], s43 offen lds
    s_add_u32 m0, s42, 2048
    s_mov_b32 s43, 176128
    buffer_load_dwordx4 v65, s[44:47], s43 offen lds
    s_add_u32 m0, s42, 3072
    s_mov_b32 s43, 264192
    buffer_load_dwordx4 v65, s[44:47], s43 offen lds
    s_add_u32 m0, s42, 4096
    s_mov_b32 s43, 352256
    buffer_load_dwordx4 v65, s[44:47], s43 offen lds
    s_add_u32 m0, s42, 5120
    s_mov_b32 s43, 440320
    buffer_load_dwordx4 v65, s[44:47], s43 offen lds
    s_add_u32 m0, s42, 6144
    s_mov_b32 s43, 528384
    buffer_load_dwordx4 v65, s[44:47], s43 offen lds
    s_add_u32 m0, s42, 7168
    s_mov_b32 s43, 616448
    buffer_load_dwordx4 v65, s[44:47], s43 offen lds
    s_add_u32 m0, s42, 8192
    s_mov_b32 s43, 704512
    buffer_load_dwordx4 v65, s[44:47], s43 offen lds
    s_add_u32 m0, s42, 9216
    s_mov_b32 s43, 792576
    buffer_load_dwordx4 v65, s[44:47], s43 offen lds
    s_add_u32 m0, s42, 10240
    s_mov_b32 s43, 880640
    buffer_load_dwordx4 v65, s[44:47], s43 offen lds
    s_add_u32 m0, s42, 11264
    s_mov_b32 s43, 968704
    buffer_load_dwordx4 v65, s[44:47], s43 offen lds
    s_add_u32 m0, s42, 12288
    s_mov_b32 s43, 1056768
    buffer_load_dwordx4 v65, s[44:47], s43 offen lds
    s_add_u32 m0, s42, 13312
    s_mov_b32 s43, 1144832
    buffer_load_dwordx4 v65, s[44:47], s43 offen lds
    s_add_u32 m0, s42, 14336
    s_mov_b32 s43, 1232896
    buffer_load_dwordx4 v65, s[44:47], s43 offen lds
    s_add_u32 m0, s42, 15360
    s_mov_b32 s43, 1320960
    buffer_load_dwordx4 v65, s[44:47], s43 offen lds
    s_add_u32 m0, s42, 16384
    s_mov_b32 s43, 0
    buffer_load_dwordx4 v65, s[48:51], s43 offen lds
    s_add_u32 m0, s42, 17408
    s_mov_b32 s43, 88064
    buffer_load_dwordx4 v65, s[48:51], s43 offen lds
    s_add_u32 m0, s42, 18432
    s_mov_b32 s43, 176128
    buffer_load_dwordx4 v65, s[48:51], s43 offen lds
    s_add_u32 m0, s42, 19456
    s_mov_b32 s43, 264192
    buffer_load_dwordx4 v65, s[48:51], s43 offen lds
    s_add_u32 m0, s42, 20480
    s_mov_b32 s43, 352256
    buffer_load_dwordx4 v65, s[48:51], s43 offen lds
    s_add_u32 m0, s42, 21504
    s_mov_b32 s43, 440320
    buffer_load_dwordx4 v65, s[48:51], s43 offen lds
    s_add_u32 m0, s42, 22528
    s_mov_b32 s43, 528384
    buffer_load_dwordx4 v65, s[48:51], s43 offen lds
    s_add_u32 m0, s42, 23552
    s_mov_b32 s43, 616448
    buffer_load_dwordx4 v65, s[48:51], s43 offen lds
    s_add_u32 m0, s42, 24576
    s_mov_b32 s43, 704512
    buffer_load_dwordx4 v65, s[48:51], s43 offen lds
    s_add_u32 m0, s42, 25600
    s_mov_b32 s43, 792576
    buffer_load_dwordx4 v65, s[48:51], s43 offen lds
    s_add_u32 m0, s42, 26624
    s_mov_b32 s43, 880640
    buffer_load_dwordx4 v65, s[48:51], s43 offen lds
    s_add_u32 m0, s42, 27648
    s_mov_b32 s43, 968704
    buffer_load_dwordx4 v65, s[48:51], s43 offen lds
    s_add_u32 m0, s42, 28672
    s_mov_b32 s43, 1056768
    buffer_load_dwordx4 v65, s[48:51], s43 offen lds
    s_add_u32 m0, s42, 29696
    s_mov_b32 s43, 1144832
    buffer_load_dwordx4 v65, s[48:51], s43 offen lds
    s_add_u32 m0, s42, 30720
    s_mov_b32 s43, 1232896
    buffer_load_dwordx4 v65, s[48:51], s43 offen lds
    s_add_u32 m0, s42, 31744
    s_mov_b32 s43, 1320960
    buffer_load_dwordx4 v65, s[48:51], s43 offen lds
    v_lshlrev_b32 v66, 3, v62
    v_add_u32 v66, v66, v63
    v_lshlrev_b32 v66, 5, v66
    v_lshlrev_b32 v67, 3, v64
    v_add3_u32 v66, v66, v67, s42
    s_waitcnt vmcnt(28)
    ds_read_b64_tr_b16 a[0:1], v66 offset:0
    ds_read_b64_tr_b16 a[2:3], v66 offset:128
    ds_read_b64_tr_b16 a[4:5], v66 offset:1024
    ds_read_b64_tr_b16 a[6:7], v66 offset:1152
    ds_read_b64_tr_b16 a[8:9], v66 offset:2048
    ds_read_b64_tr_b16 a[10:11], v66 offset:2176
    ds_read_b64_tr_b16 a[12:13], v66 offset:3072
    ds_read_b64_tr_b16 a[14:15], v66 offset:3200
    s_waitcnt vmcnt(24)
    ds_read_b64_tr_b16 a[16:17], v66 offset:4096
    ds_read_b64_tr_b16 a[18:19], v66 offset:4224
    ds_read_b64_tr_b16 a[20:21], v66 offset:5120
    ds_read_b64_tr_b16 a[22:23], v66 offset:5248
    ds_read_b64_tr_b16 a[24:25], v66 offset:6144
    ds_read_b64_tr_b16 a[26:27], v66 offset:6272
    ds_read_b64_tr_b16 a[28:29], v66 offset:7168
    ds_read_b64_tr_b16 a[30:31], v66 offset:7296
    s_waitcnt vmcnt(20)
    ds_read_b64_tr_b16 a[32:33], v66 offset:8192
    ds_read_b64_tr_b16 a[34:35], v66 offset:8320
    ds_read_b64_tr_b16 a[36:37], v66 offset:9216
    ds_read_b64_tr_b16 a[38:39], v66 offset:9344
    ds_read_b64_tr_b16 a[40:41], v66 offset:10240
    ds_read_b64_tr_b16 a[42:43], v66 offset:10368
    ds_read_b64_tr_b16 a[44:45], v66 offset:11264
    ds_read_b64_tr_b16 a[46:47], v66 offset:11392
    s_waitcnt vmcnt(16)
    ds_read_b64_tr_b16 a[48:49], v66 offset:12288
    ds_read_b64_tr_b16 a[50:51], v66 offset:12416
    ds_read_b64_tr_b16 a[52:53], v66 offset:13312
    ds_read_b64_tr_b16 a[54:55], v66 offset:13440
    ds_read_b64_tr_b16 a[56:57], v66 offset:14336
    ds_read_b64_tr_b16 a[58:59], v66 offset:14464
    ds_read_b64_tr_b16 a[60:61], v66 offset:15360
    ds_read_b64_tr_b16 a[62:63], v66 offset:15488
    s_waitcnt vmcnt(12)
    ds_read_b64_tr_b16 a[64:65], v66 offset:16384
    ds_read_b64_tr_b16 a[66:67], v66 offset:16512
    ds_read_b64_tr_b16 a[68:69], v66 offset:17408
    ds_read_b64_tr_b16 a[70:71], v66 offset:17536
    ds_read_b64_tr_b16 a[72:73], v66 offset:18432
    ds_read_b64_tr_b16 a[74:75], v66 offset:18560
    ds_read_b64_tr_b16 a[76:77], v66 offset:19456
    ds_read_b64_tr_b16 a[78:79], v66 offset:19584
    s_waitcnt vmcnt(8)
    ds_read_b64_tr_b16 a[80:81], v66 offset:20480
    ds_read_b64_tr_b16 a[82:83], v66 offset:20608
    ds_read_b64_tr_b16 a[84:85], v66 offset:21504
    ds_read_b64_tr_b16 a[86:87], v66 offset:21632
    ds_read_b64_tr_b16 a[88:89], v66 offset:22528
    ds_read_b64_tr_b16 a[90:91], v66 offset:22656
    ds_read_b64_tr_b16 a[92:93], v66 offset:23552
    ds_read_b64_tr_b16 a[94:95], v66 offset:23680
    s_waitcnt vmcnt(4)
    ds_read_b64_tr_b16 a[96:97], v66 offset:24576
    ds_read_b64_tr_b16 a[98:99], v66 offset:24704
    ds_read_b64_tr_b16 a[100:101], v66 offset:25600
    ds_read_b64_tr_b16 a[102:103], v66 offset:25728
    ds_read_b64_tr_b16 a[104:105], v66 offset:26624
    ds_read_b64_tr_b16 a[106:107], v66 offset:26752
    ds_read_b64_tr_b16 a[108:109], v66 offset:27648
    ds_read_b64_tr_b16 a[110:111], v66 offset:27776
    s_waitcnt vmcnt(0)
    ds_read_b64_tr_b16 a[112:113], v66 offset:28672
    ds_read_b64_tr_b16 a[114:115], v66 offset:28800
    ds_read_b64_tr_b16 a[116:117], v66 offset:29696
    ds_read_b64_tr_b16 a[118:119], v66 offset:29824
    ds_read_b64_tr_b16 a[120:121], v66 offset:30720
    ds_read_b64_tr_b16 a[122:123], v66 offset:30848
    ds_read_b64_tr_b16 a[124:125], v66 offset:31744
    ds_read_b64_tr_b16 a[126:127], v66 offset:31872
    v_lshlrev_b32 v1, 4, v60
    s_lshl_b32 s39, s21, 13
    v_add_u32 v2, s39, v1
    v_lshlrev_b32 v65, 4, v62
    v_mul_u32_u24 v66, 1040, v61
    v_add_u32 v3, v65, v66
    s_mul_i32 s39, s21, 8320
    s_lshl_b32 s40, s37, 1
    s_lshr_b32 s41, s21, 1
    s_add_u32 s38, s40, s41
    s_lshl_b32 s40, s38, 10
    s_and_b32 s41, s21, 1
    s_lshl_b32 s41, s41, 3
    s_add_u32 s40, s40, s41
    v_add_u32 v4, s40, v1
    s_mov_b32 s52, 0xc0135761
    v_mov_b32 v5, 0xbdd2d3e8
    s_waitcnt lgkmcnt(0)
    s_barrier
CL_36:
    s_sub_u32 s40, s36, 40
    s_cmp_ge_u32 s40, 2
    s_cbranch_scc1 FG_38
    s_cmp_lg_u32 s21, 0
    s_cbranch_scc1 PD_40
    s_mov_b32 s23, 0
PL_39:
    buffer_load_dword v6, off, s[16:19], 0 offset:196 sc1
    s_waitcnt vmcnt(0)
    v_readfirstlane_b32 s40, v6
    s_nop 0
    s_cmp_ge_u32 s40, 1
    s_cbranch_scc1 PD_40
    s_sleep 2
    s_add_u32 s23, s23, 1
    s_cmp_lt_u32 s23, 400000
    s_cbranch_scc1 PL_39
    s_branch m_exit
PD_40:
    s_barrier
FG_38:
    s_lshl_b32 s50, s36, 7
    s_add_u32 s50, s50, 16384
    s_lshl_b32 s53, s36, 15
    s_add_u32 s53, s53, 8388608
    s_cmp_ge_u32 s36, 60
    s_cbranch_scc1 CX_41
    s_cmp_lg_u32 s21, 0
    s_cbranch_scc1 PD_45
    s_mov_b32 s23, 0
PL_44:
    buffer_load_dword v6, off, s[8:11], s50 offset:0 sc1
    s_waitcnt vmcnt(0)
    v_readfirstlane_b32 s40, v6
    s_nop 0
    s_cmp_ge_u32 s40, 32
    s_cbranch_scc1 PD_45
    s_sleep 4
    s_add_u32 s23, s23, 1
    s_cmp_lt_u32 s23, 400000
    s_cbranch_scc1 PL_44
    s_branch m_exit
PD_45:
    s_barrier
    s_branch CW_42
CX_41:
    v_and_b32 v7, 31, v60
    v_lshlrev_b32 v7, 8, v7
    s_lshl_b32 s54, s21, 13
    s_add_u32 s54, s54, s53
    v_add_u32 v40, s39, v1
    s_mov_b32 s23, 0
CY_46:
    buffer_load_dword v6, v7, s[8:11], s54 offen sc1
    s_add_u32 s23, s23, 1
    s_cmp_ge_u32 s23, 400000
    s_cbranch_scc1 m_exit
    s_waitcnt vmcnt(0)
    v_cmp_eq_u32 vcc, -1, v6
    s_cbranch_vccz CZ_47
    s_sleep 1
    s_branch CY_46
CZ_47:
CW_42:
    s_mov_b32 s55, s53
    s_add_u32 m0, s39, 0
    s_nop 0
    buffer_load_dwordx4 v2, s[8:11], s55 offen offset:0 sc1 lds
    s_add_u32 m0, s39, 16
    s_nop 0
    buffer_load_dwordx4 v2, s[8:11], s55 offen offset:1024 sc1 lds
    s_add_u32 m0, s39, 32
    s_nop 0
    buffer_load_dwordx4 v2, s[8:11], s55 offen offset:2048 sc1 lds
    s_add_u32 m0, s39, 48
    s_nop 0
    buffer_load_dwordx4 v2, s[8:11], s55 offen offset:3072 sc1 lds
    s_add_u32 m0, s39, 4160
    s_add_u32 s55, s55, 4096
    buffer_load_dwordx4 v2, s[8:11], s55 offen offset:0 sc1 lds
    s_add_u32 m0, s39, 4176
    s_nop 0
    buffer_load_dwordx4 v2, s[8:11], s55 offen offset:1024 sc1 lds
    s_add_u32 m0, s39, 4192
    s_nop 0
    buffer_load_dwordx4 v2, s[8:11], s55 offen offset:2048 sc1 lds
    s_add_u32 m0, s39, 4208
    s_nop 0
    buffer_load_dwordx4 v2, s[8:11], s55 offen offset:3072 sc1 lds
    s_cmp_lt_u32 s36, 60
    s_cbranch_scc1 CV_43
    s_waitcnt vmcnt(0)
    ds_read_b128 v[64:67], v40 offset:0
    ds_read_b128 v[68:71], v40 offset:1040
    ds_read_b128 v[72:75], v40 offset:2080
    ds_read_b128 v[76:79], v40 offset:3120
    ds_read_b128 v[80:83], v40 offset:4160
    ds_read_b128 v[84:87], v40 offset:5200
    ds_read_b128 v[88:91], v40 offset:6240
    ds_read_b128 v[92:95], v40 offset:7280
    s_waitcnt lgkmcnt(0)
    v_max3_u32 v6, v64, v65, v66
    v_max3_u32 v6, v6, v67, v68
    v_max3_u32 v6, v6, v69, v70
    v_max3_u32 v6, v6, v71, v72
    v_max3_u32 v6, v6, v73, v74
    v_max3_u32 v6, v6, v75, v76
    v_max3_u32 v6, v6, v77, v78
    v_max3_u32 v6, v6, v79, v80
    v_max3_u32 v6, v6, v81, v82
    v_max3_u32 v6, v6, v83, v84
    v_max3_u32 v6, v6, v85, v86
    v_max3_u32 v6, v6, v87, v88
    v_max3_u32 v6, v6, v89, v90
    v_max3_u32 v6, v6, v91, v92
    v_max3_u32 v6, v6, v93, v94
    v_max_u32 v6, v6, v95
    v_cmp_eq_u32 vcc, -1, v6
    s_cbranch_vccnz CY_46
CV_43:
    s_mul_i32 s40, s36, 88064
    s_add_u32 s40, s40, 10485760
    s_add_u32 s41, s40, 44032
    s_add_u32 s50, s50, 8192
    s_waitcnt vmcnt(0)
    s_barrier
    ds_read_b128 v[64:67], v3 offset:0
    ds_read_b128 v[68:71], v3 offset:64
    ds_read_b128 v[72:75], v3 offset:128
    ds_read_b128 v[76:79], v3 offset:192
    ds_read_b128 v[80:83], v3 offset:256
    ds_read_b128 v[84:87], v3 offset:320
    ds_read_b128 v[88:91], v3 offset:384
    ds_read_b128 v[92:95], v3 offset:448
    ds_read_b128 v[96:99], v3 offset:512
    ds_read_b128 v[100:103], v3 offset:576
    ds_read_b128 v[104:107], v3 offset:640
    ds_read_b128 v[108:111], v3 offset:704
    s_waitcnt lgkmcnt(11)
    v_mfma_f32_16x16x32_bf16 v[8:11], a[0:3], v[64:67], 0
    v_mfma_f32_16x16x32_bf16 v[12:15], a[64:67], v[64:67], 0
    ds_read_b128 v[64:67], v3 offset:768
    s_waitcnt lgkmcnt(11)
    v_mfma_f32_16x16x32_bf16 v[8:11], a[4:7], v[68:71], v[8:11]
    v_mfma_f32_16x16x32_bf16 v[12:15], a[68:71], v[68:71], v[12:15]
    ds_read_b128 v[68:71], v3 offset:832
    s_waitcnt lgkmcnt(11)
    v_mfma_f32_16x16x32_bf16 v[8:11], a[8:11], v[72:75], v[8:11]
    v_mfma_f32_16x16x32_bf16 v[12:15], a[72:75], v[72:75], v[12:15]
    ds_read_b128 v[72:75], v3 offset:896
    s_waitcnt lgkmcnt(11)
    v_mfma_f32_16x16x32_bf16 v[8:11], a[12:15], v[76:79], v[8:11]
    v_mfma_f32_16x16x32_bf16 v[12:15], a[76:79], v[76:79], v[12:15]
    ds_read_b128 v[76:79], v3 offset:960
    s_waitcnt lgkmcnt(11)
    v_mfma_f32_16x16x32_bf16 v[8:11], a[16:19], v[80:83], v[8:11]
    v_mfma_f32_16x16x32_bf16 v[12:15], a[80:83], v[80:83], v[12:15]
    ds_read_b128 v[80:83], v3 offset:16640
    s_waitcnt lgkmcnt(11)
    v_mfma_f32_16x16x32_bf16 v[8:11], a[20:23], v[84:87], v[8:11]
    v_mfma_f32_16x16x32_bf16 v[12:15], a[84:87], v[84:87], v[12:15]
    ds_read_b128 v[84:87], v3 offset:16704
    s_waitcnt lgkmcnt(11)
    v_mfma_f32_16x16x32_bf16 v[8:11], a[24:27], v[88:91], v[8:11]
    v_mfma_f32_16x16x32_bf16 v[12:15], a[88:91], v[88:91], v[12:15]
    ds_read_b128 v[88:91], v3 offset:16768
    s_waitcnt lgkmcnt(11)
    v_mfma_f32_16x16x32_bf16 v[8:11], a[28:31], v[92:95], v[8:11]
    v_mfma_f32_16x16x32_bf16 v[12:15], a[92:95], v[92:95], v[12:15]
    ds_read_b128 v[92:95], v3 offset:16832
    s_waitcnt lgkmcnt(11)
    v_mfma_f32_16x16x32_bf16 v[8:11], a[32:35], v[96:99], v[8:11]
    v_mfma_f32_16x16x32_bf16 v[12:15], a[96:99], v[96:99], v[12:15]
    ds_read_b128 v[96:99], v3 offset:16896
    s_waitcnt lgkmcnt(11)
    v_mfma_f32_16x16x32_bf16 v[8:11], a[36:39], v[100:103], v[8:11]
    v_mfma_f32_16x16x32_bf16 v[12:15], a[100:103], v[100:103], v[12:15]
    ds_read_b128 v[100:103], v3 offset:16960
    s_waitcnt lgkmcnt(11)
    v_mfma_f32_16x16x32_bf16 v[8:11], a[40:43], v[104:107], v[8:11]
    v_mfma_f32_16x16x32_bf16 v[12:15], a[104:107], v[104:107], v[12:15]
    ds_read_b128 v[104:107], v3 offset:17024
    s_waitcnt lgkmcnt(11)
    v_mfma_f32_16x16x32_bf16 v[8:11], a[44:47], v[108:111], v[8:11]
    v_mfma_f32_16x16x32_bf16 v[12:15], a[108:111], v[108:111], v[12:15]
    ds_read_b128 v[108:111], v3 offset:17088
    s_waitcnt lgkmcnt(11)
    v_mfma_f32_16x16x32_bf16 v[8:11], a[48:51], v[64:67], v[8:11]
    v_mfma_f32_16x16x32_bf16 v[12:15], a[112:115], v[64:67], v[12:15]
    ds_read_b128 v[64:67], v3 offset:17152
    s_waitcnt lgkmcnt(11)
    v_mfma_f32_16x16x32_bf16 v[8:11], a[52:55], v[68:71], v[8:11]
    v_mfma_f32_16x16x32_bf16 v[12:15], a[116:119], v[68:71], v[12:15]
    ds_read_b128 v[68:71], v3 offset:17216
    s_waitcnt lgkmcnt(11)
    v_mfma_f32_16x16x32_bf16 v[8:11], a[56:59], v[72:75], v[8:11]
    v_mfma_f32_16x16x32_bf16 v[12:15], a[120:123], v[72:75], v[12:15]
    ds_read_b128 v[72:75], v3 offset:17280
    s_waitcnt lgkmcnt(11)
    v_mfma_f32_16x16x32_bf16 v[8:11], a[60:63], v[76:79], v[8:11]
    v_mfma_f32_16x16x32_bf16 v[12:15], a[124:127], v[76:79], v[12:15]
    ds_read_b128 v[76:79], v3 offset:17344
    s_waitcnt lgkmcnt(11)
    v_mfma_f32_16x16x32_bf16 v[24:27], a[0:3], v[80:83], 0
    v_mfma_f32_16x16x32_bf16 v[28:31], a[64:67], v[80:83], 0
    ds_read_b128 v[80:83], v3 offset:17408
    s_waitcnt lgkmcnt(11)
    v_mfma_f32_16x16x32_bf16 v[24:27], a[4:7], v[84:87], v[24:27]
    v_mfma_f32_16x16x32_bf16 v[28:31], a[68:71], v[84:87], v[28:31]
    ds_read_b128 v[84:87], v3 offset:17472
    s_waitcnt lgkmcnt(11)
    v_mfma_f32_16x16x32_bf16 v[24:27], a[8:11], v[88:91], v[24:27]
    v_mfma_f32_16x16x32_bf16 v[28:31], a[72:75], v[88:91], v[28:31]
    ds_read_b128 v[88:91], v3 offset:17536
    s_waitcnt lgkmcnt(11)
    v_mfma_f32_16x16x32_bf16 v[24:27], a[12:15], v[92:95], v[24:27]
    v_mul_f32 v16, v8, v8
    v_mul_f32 v17, v9, v9
    v_mfma_f32_16x16x32_bf16 v[28:31], a[76:79], v[92:95], v[28:31]
    v_mul_f32 v18, v10, v10
    v_mul_f32 v19, v11, v11
    ds_read_b128 v[92:95], v3 offset:17600
    s_waitcnt lgkmcnt(11)
    v_mfma_f32_16x16x32_bf16 v[24:27], a[16:19], v[96:99], v[24:27]
    v_fma_f32 v16, v16, v5, s52
    v_fma_f32 v17, v17, v5, s52
    v_mfma_f32_16x16x32_bf16 v[28:31], a[80:83], v[96:99], v[28:31]
    v_fma_f32 v18, v18, v5, s52
    v_fma_f32 v19, v19, v5, s52
    s_waitcnt lgkmcnt(10)
    v_mfma_f32_16x16x32_bf16 v[24:27], a[20:23], v[100:103], v[24:27]
    v_mul_f32 v16, v16, v8
    v_mul_f32 v17, v17, v9
    v_mfma_f32_16x16x32_bf16 v[28:31], a[84:87], v[100:103], v[28:31]
    v_mul_f32 v18, v18, v10
    v_mul_f32 v19, v19, v11
    s_waitcnt lgkmcnt(9)
    v_mfma_f32_16x16x32_bf16 v[24:27], a[24:27], v[104:107], v[24:27]
    v_exp_f32 v16, v16
    v_exp_f32 v17, v17
    v_mfma_f32_16x16x32_bf16 v[28:31], a[88:91], v[104:107], v[28:31]
    v_exp_f32 v18, v18
    v_exp_f32 v19, v19
    s_waitcnt lgkmcnt(8)
    v_mfma_f32_16x16x32_bf16 v[24:27], a[28:31], v[108:111], v[24:27]
    v_mul_f32 v8, v8, v12
    v_mul_f32 v9, v9, v13
    v_mfma_f32_16x16x32_bf16 v[28:31], a[92:95], v[108:111], v[28:31]
    v_mul_f32 v10, v10, v14
    v_mul_f32 v11, v11, v15
    s_waitcnt lgkmcnt(7)
    v_mfma_f32_16x16x32_bf16 v[24:27], a[32:35], v[64:67], v[24:27]
    v_add_f32 v16, 1.0, v16
    v_add_f32 v17, 1.0, v17
    v_mfma_f32_16x16x32_bf16 v[28:31], a[96:99], v[64:67], v[28:31]
    v_add_f32 v18, 1.0, v18
    v_add_f32 v19, 1.0, v19
    s_waitcnt lgkmcnt(6)
    v_mfma_f32_16x16x32_bf16 v[24:27], a[36:39], v[68:71], v[24:27]
    v_rcp_f32 v16, v16
    v_rcp_f32 v17, v17
    v_mfma_f32_16x16x32_bf16 v[28:31], a[100:103], v[68:71], v[28:31]
    v_rcp_f32 v18, v18
    v_rcp_f32 v19, v19
    s_waitcnt lgkmcnt(5)
    v_mfma_f32_16x16x32_bf16 v[24:27], a[40:43], v[72:75], v[24:27]
    v_mul_f32 v8, v8, v16
    v_mul_f32 v9, v9, v17
    v_mfma_f32_16x16x32_bf16 v[28:31], a[104:107], v[72:75], v[28:31]
    v_mul_f32 v10, v10, v18
    v_mul_f32 v11, v11, v19
    s_waitcnt lgkmcnt(4)
    v_mfma_f32_16x16x32_bf16 v[24:27], a[44:47], v[76:79], v[24:27]
    v_cvt_pk_bf16_f32 v12, v8, v9
    v_cvt_pk_bf16_f32 v13, v10, v11
    v_mfma_f32_16x16x32_bf16 v[28:31], a[108:111], v[76:79], v[28:31]
    s_waitcnt lgkmcnt(3)
    v_mfma_f32_16x16x32_bf16 v[24:27], a[48:51], v[80:83], v[24:27]
    v_mfma_f32_16x16x32_bf16 v[28:31], a[112:115], v[80:83], v[28:31]
    s_waitcnt lgkmcnt(2)
    v_mfma_f32_16x16x32_bf16 v[24:27], a[52:55], v[84:87], v[24:27]
    v_mfma_f32_16x16x32_bf16 v[28:31], a[116:119], v[84:87], v[28:31]
    s_waitcnt lgkmcnt(1)
    v_mfma_f32_16x16x32_bf16 v[24:27], a[56:59], v[88:91], v[24:27]
    v_mfma_f32_16x16x32_bf16 v[28:31], a[120:123], v[88:91], v[28:31]
    s_waitcnt lgkmcnt(0)
    v_mfma_f32_16x16x32_bf16 v[24:27], a[60:63], v[92:95], v[24:27]
    v_mfma_f32_16x16x32_bf16 v[28:31], a[124:127], v[92:95], v[28:31]
    s_nop 6
    v_mul_f32 v32, v24, v24
    v_mul_f32 v33, v25, v25
    v_mul_f32 v34, v26, v26
    v_mul_f32 v35, v27, v27
    v_fma_f32 v32, v32, v5, s52
    v_fma_f32 v33, v33, v5, s52
    v_fma_f32 v34, v34, v5, s52
    v_fma_f32 v35, v35, v5, s52
    v_mul_f32 v32, v32, v24
    v_mul_f32 v33, v33, v25
    v_mul_f32 v34, v34, v26
    v_mul_f32 v35, v35, v27
    v_exp_f32 v32, v32
    v_exp_f32 v33, v33
    v_exp_f32 v34, v34
    v_exp_f32 v35, v35
    v_mul_f32 v24, v24, v28
    v_mul_f32 v25, v25, v29
    v_mul_f32 v26, v26, v30
    v_mul_f32 v27, v27, v31
    v_add_f32 v32, 1.0, v32
    v_add_f32 v33, 1.0, v33
    v_add_f32 v34, 1.0, v34
    v_add_f32 v35, 1.0, v35
    v_rcp_f32 v32, v32
    v_rcp_f32 v33, v33
    v_rcp_f32 v34, v34
    v_rcp_f32 v35, v35
    v_mul_f32 v24, v24, v32
    v_mul_f32 v25, v25, v33
    v_mul_f32 v26, v26, v34
    v_mul_f32 v27, v27, v35
    v_cvt_pk_bf16_f32 v28, v24, v25
    v_cvt_pk_bf16_f32 v29, v26, v27
    s_cmp_ge_u32 s38, 43
    s_cbranch_scc1 CN_37
    buffer_store_dwordx2 v[12:13], v4, s[8:11], s40 offen sc1
    buffer_store_dwordx2 v[28:29], v4, s[8:11], s41 offen sc1
CN_37:
    s_waitcnt vmcnt(0)
    s_barrier
    s_cmp_lg_u32 s21, 0
    s_cbranch_scc1 SG_48
    v_mov_b32 v6, 1
    s_mov_b64 exec, 1
    buffer_atomic_add v6, off, s[8:11], s50 offset:0
    s_mov_b64 exec, -1
SG_48:
    s_add_u32 s36, s36, 2
    s_cmp_lt_u32 s36, 64
    s_cbranch_scc1 CL_36
    s_branch m_fin
m_r1:
    s_mov_b32 s7, 2016
m_r1b:
    s_load_dwordx2 s[84:85], s[0:1], 0
    s_waitcnt lgkmcnt(0)
    s_mov_b32 s44, s84
    s_and_b32 s45, s85, 0xffff
    s_mov_b32 s46, 0x200000
    s_mov_b32 s47, 0x20000
    v_and_b32 v61, 15, v60
    v_lshrrev_b32 v62, 4, v60
    v_bfe_u32 v63, v60, 2, 2
    v_and_b32 v64, 3, v60
    s_lshl_b32 s42, s21, 15
    s_add_u32 s42, s42, 32768
    v_mov_b32 v65, 0x3f80
    v_mov_b32 v66, 0x3f800000
    v_subrev_u32 v67, 8, v61
    v_cmp_eq_u32 vcc, 0, v61
    s_nop 1
    v_cndmask_b32 v8, 0, v65, vcc
    v_cmp_eq_u32 vcc, 1, v61
    s_nop 1
    v_cndmask_b32 v8, v8, v66, vcc
    v_cmp_eq_u32 vcc, 2, v61
    s_nop 1
    v_cndmask_b32 v9, 0, v65, vcc
    v_cmp_eq_u32 vcc, 3, v61
    s_nop 1
    v_cndmask_b32 v9, v9, v66, vcc
    v_cmp_eq_u32 vcc, 4, v61
    s_nop 1
    v_cndmask_b32 v10, 0, v65, vcc
    v_cmp_eq_u32 vcc, 5, v61
    s_nop 1
    v_cndmask_b32 v10, v10, v66, vcc
    v_cmp_eq_u32 vcc, 6, v61
    s_nop 1
    v_cndmask_b32 v11, 0, v65, vcc
    v_cmp_eq_u32 vcc, 7, v61
    s_nop 1
    v_cndmask_b32 v11, v11, v66, vcc
    v_cmp_eq_u32 vcc, 0, v67
    s_nop 1
    v_cndmask_b32 v12, 0, v65, vcc
    v_cmp_eq_u32 vcc, 1, v67
    s_nop 1
    v_cndmask_b32 v12, v12, v66, vcc
    v_cmp_eq_u32 vcc, 2, v67
    s_nop 1
    v_cndmask_b32 v13, 0, v65, vcc
    v_cmp_eq_u32 vcc, 3, v67
    s_nop 1
    v_cndmask_b32 v13, v13, v66, vcc
    v_cmp_eq_u32 vcc, 4, v67
    s_nop 1
    v_cndmask_b32 v14, 0, v65, vcc
    v_cmp_eq_u32 vcc, 5, v67
    s_nop 1
    v_cndmask_b32 v14, v14, v66, vcc
    v_cmp_eq_u32 vcc, 6, v67
    s_nop 1
    v_cndmask_b32 v15, 0, v65, vcc
    v_cmp_eq_u32 vcc, 7, v67
    s_nop 1
    v_cndmask_b32 v15, v15, v66, vcc
    v_lshlrev_b32 v65, 15, v62
    v_lshlrev_b32 v66, 4, v61
    s_lshl_b32 s40, s21, 8
    v_add3_u32 v1, v65, v66, s40
    v_lshrrev_b32 v66, 2, v61
    v_lshlrev_b32 v66, 5, v66
    v_and_b32 v67, 1, v62
    v_lshlrev_b32 v67, 4, v67
    v_lshlrev_b32 v68, 2, v64
    v_add3_u32 v65, v66, v67, v68
    v_and_b32 v66, 2, v62
    s_lshl_b32 s40, s21, 7
    v_add3_u32 v65, v65, v66, s40
    v_lshlrev_b32 v2, 1, v65
    v_lshlrev_b32 v65, 2, v65
    s_lshl_b32 s40, s21, 3
    v_mov_b32 v4, s40
    v_mov_b32 v5, 0
    s_lshl_b32 s40, s21, 8
    v_lshlrev_b32 v66, 4, v61
    v_and_b32 v67, 1, v62
    v_lshlrev_b32 v68, 10, v67
    v_add3_u32 v7, v66, v68, s40
    v_mul_u32_u24 v68, 2097152, v67
    v_add3_u32 v3, v66, v68, s40
    s_mov_b32 s40, 69632
    s_mov_b32 s41, 73728
    s_mov_b32 s43, 71680
    buffer_load_dwordx2 v[16:17], v65, s[8:11], s40 offen sc1
    buffer_load_dwordx2 v[24:25], v65, s[8:11], s41 offen sc1
    buffer_load_dwordx2 v[32:33], v65, s[8:11], s43 offen sc1
    s_mov_b32 s36, s5
    s_mov_b32 s54, 0x3b000000
    v_mov_b32 v6, 0x3727c5ac
RL_49:
    s_sub_u32 s40, s36, 1280
    s_cmp_ge_u32 s40, 52
    s_cbranch_scc1 FG_50
    s_cmp_lg_u32 s21, 0
    s_cbranch_scc1 PD_52
    s_mov_b32 s23, 0
PL_51:
    buffer_load_dword v44, off, s[16:19], 0 offset:196 sc1
    s_waitcnt vmcnt(0)
    v_readfirstlane_b32 s40, v44
    s_nop 0
    s_cmp_ge_u32 s40, 1
    s_cbranch_scc1 PD_52
    s_sleep 2
    s_add_u32 s23, s23, 1
    s_cmp_lt_u32 s23, 400000
    s_cbranch_scc1 PL_51
    s_branch m_exit
PD_52:
    s_barrier
FG_50:
    s_lshl_b32 s48, s36, 10
    buffer_load_dword v40, v2, s[44:47], s48 offen
    s_lshr_b32 s49, s36, 5
    s_lshl_b32 s50, s49, 7
    s_add_u32 s50, s50, 8192
    s_lshl_b32 s51, s49, 20
    s_and_b32 s52, s36, 31
    s_lshl_b32 s52, s52, 10
    s_add_u32 s51, s51, s52
    s_add_u32 s51, s51, 100663296
    s_cmp_ge_u32 s36, 1920
    s_cbranch_scc1 RX_53
    s_cmp_lg_u32 s21, 0
    s_cbranch_scc1 PD_57
    s_mov_b32 s23, 0
PL_56:
    buffer_load_dword v44, off, s[8:11], s50 offset:0 sc1
    s_waitcnt vmcnt(0)
    v_readfirstlane_b32 s40, v44
    s_nop 0
    s_cmp_ge_u32 s40, 32
    s_cbranch_scc1 PD_57
    s_sleep 4
    s_add_u32 s23, s23, 1
    s_cmp_lt_u32 s23, 400000
    s_cbranch_scc1 PL_56
    s_branch m_exit
PD_57:
    s_barrier
    s_branch RY_54
RX_53:
    v_and_b32 v45, 31, v60
    v_lshlrev_b32 v45, 15, v45
    s_lshl_b32 s52, s21, 8
    s_add_u32 s52, s52, s51
    s_mov_b32 s23, 0
CY_58:
    buffer_load_dword v44, v45, s[8:11], s52 offen sc1
    s_add_u32 s23, s23, 1
    s_cmp_ge_u32 s23, 400000
    s_cbranch_scc1 m_exit
    s_waitcnt vmcnt(0)
    v_cmp_eq_u32 vcc, -1, v44
    s_cbranch_vccz CZ_59
    s_sleep 1
    s_branch CY_58
CZ_59:
RY_54:
    s_mov_b32 s53, s51
    buffer_load_dwordx4 v[64:67], v1, s[8:11], s53 offen sc1
    s_add_u32 s53, s53, 131072
    buffer_load_dwordx4 v[68:71], v1, s[8:11], s53 offen sc1
    s_add_u32 s53, s53, 131072
    buffer_load_dwordx4 v[72:75], v1, s[8:11], s53 offen sc1
    s_add_u32 s53, s53, 131072
    buffer_load_dwordx4 v[76:79], v1, s[8:11], s53 offen sc1
    s_add_u32 s53, s53, 131072
    buffer_load_dwordx4 v[80:83], v1, s[8:11], s53 offen sc1
    s_add_u32 s53, s53, 131072
    buffer_load_dwordx4 v[84:87], v1, s[8:11], s53 offen sc1
    s_add_u32 s53, s53, 131072
    buffer_load_dwordx4 v[88:91], v1, s[8:11], s53 offen sc1
    s_add_u32 s53, s53, 131072
    buffer_load_dwordx4 v[92:95], v1, s[8:11], s53 offen sc1
    s_cmp_lt_u32 s36, 1920
    s_cbranch_scc1 RZ_55
    s_waitcnt vmcnt(0)
    v_max3_u32 v44, v64, v65, v66
    v_max3_u32 v44, v44, v67, v68
    v_max3_u32 v44, v44, v69, v70
    v_max3_u32 v44, v44, v71, v72
    v_max3_u32 v44, v44, v73, v74
    v_max3_u32 v44, v44, v75, v76
    v_max3_u32 v44, v44, v77, v78
    v_max3_u32 v44, v44, v79, v80
    v_max3_u32 v44, v44, v81, v82
    v_max3_u32 v44, v44, v83, v84
    v_max3_u32 v44, v44, v85, v86
    v_max3_u32 v44, v44, v87, v88
    v_max3_u32 v44, v44, v89, v90
    v_max3_u32 v44, v44, v91, v92
    v_max3_u32 v44, v44, v93, v94
    v_max_u32 v44, v44, v95
    v_cmp_eq_u32 vcc, -1, v44
    s_cbranch_vccnz CY_58
RZ_55:
    s_waitcnt vmcnt(8)
    v_and_b32 v43, 0xffff0000, v40
    v_lshlrev_b32 v42, 16, v40
    s_waitcnt vmcnt(7)
    v_mfma_f32_16x16x32_bf16 v[48:51], v[8:11], v[64:67], 0
    s_waitcnt vmcnt(6)
    v_mfma_f32_16x16x32_bf16 v[48:51], v[12:15], v[68:71], v[48:51]
    s_waitcnt vmcnt(5)
    v_mfma_f32_16x16x32_bf16 v[48:51], v[8:11], v[72:75], v[48:51]
    s_waitcnt vmcnt(4)
    v_mfma_f32_16x16x32_bf16 v[48:51], v[12:15], v[76:79], v[48:51]
    s_waitcnt vmcnt(3)
    v_mfma_f32_16x16x32_bf16 v[48:51], v[8:11], v[80:83], v[48:51]
    s_waitcnt vmcnt(2)
    v_mfma_f32_16x16x32_bf16 v[48:51], v[12:15], v[84:87], v[48:51]
    s_waitcnt vmcnt(1)
    v_mfma_f32_16x16x32_bf16 v[48:51], v[8:11], v[88:91], v[48:51]
    s_waitcnt vmcnt(0)
    v_mfma_f32_16x16x32_bf16 v[48:51], v[12:15], v[92:95], v[48:51]
    s_add_u32 s48, s48, 6291456
    s_nop 6
    v_permlane32_swap_b32 v48, v50
    v_permlane32_swap_b32 v49, v51
    v_add_f32 v48, v48, v50
    v_add_f32 v49, v49, v51
    v_cvt_pk_bf16_f32 v48, v48, v49
    v_and_b32 v49, 0xffff0000, v48
    v_lshlrev_b32 v48, 16, v48
    v_mul_f32 v48, v48, v16
    v_mul_f32 v49, v49, v17
    v_cvt_pk_bf16_f32 v48, v48, v49
    v_and_b32 v49, 0xffff0000, v48
    v_lshlrev_b32 v48, 16, v48
    v_add_f32 v42, v42, v48
    v_add_f32 v43, v43, v49
    v_cvt_pk_bf16_f32 v40, v42, v43
    ds_write_b32 v2, v40 offset:1024
    v_and_b32 v43, 0xffff0000, v40
    v_lshlrev_b32 v42, 16, v40
    v_add_f32 v44, v42, v43
    v_mul_f32 v45, v42, v42
    v_fmac_f32 v45, v43, v43
    v_add_f32_dpp v44, v44, v44 row_ror:1 row_mask:0xf bank_mask:0xf
    s_nop 0
    v_add_f32_dpp v45, v45, v45 row_ror:1 row_mask:0xf bank_mask:0xf
    v_add_f32_dpp v44, v44, v44 row_ror:2 row_mask:0xf bank_mask:0xf
    s_nop 0
    v_add_f32_dpp v45, v45, v45 row_ror:2 row_mask:0xf bank_mask:0xf
    v_add_f32_dpp v44, v44, v44 row_ror:4 row_mask:0xf bank_mask:0xf
    s_nop 0
    v_add_f32_dpp v45, v45, v45 row_ror:4 row_mask:0xf bank_mask:0xf
    v_add_f32_dpp v44, v44, v44 row_ror:8 row_mask:0xf bank_mask:0xf
    s_nop 0
    v_add_f32_dpp v45, v45, v45 row_ror:8 row_mask:0xf bank_mask:0xf
    v_mov_b32 v46, v44
    v_mov_b32 v47, v45
    s_nop 0
    v_permlane16_swap_b32 v44, v46
    v_permlane16_swap_b32 v45, v47
    v_add_f32 v44, v44, v46
    v_add_f32 v45, v45, v47
    v_mov_b32 v46, v44
    v_mov_b32 v47, v45
    s_nop 0
    v_permlane32_swap_b32 v44, v46
    v_permlane32_swap_b32 v45, v47
    v_add_f32 v44, v44, v46
    v_add_f32 v45, v45, v47
    ds_write_b64 v4, v[44:45]
    s_add_u32 s50, s50, 8192
    s_waitcnt lgkmcnt(0)
    s_barrier
    ds_read_b128 v[52:55], v5
    ds_read_b128 v[56:59], v5 offset:16
    s_waitcnt lgkmcnt(0)
    v_pk_add_f32 v[52:53], v[52:53], v[54:55]
    v_pk_add_f32 v[56:57], v[56:57], v[58:59]
    v_pk_add_f32 v[52:53], v[52:53], v[56:57]
    v_mul_f32 v52, s54, v52
    v_mul_f32 v53, s54, v53
    v_fma_f32 v53, -v52, v52, v53
    v_max_f32 v53, 0, v53
    v_cvt_pk_bf16_f32 v52, v52, v53
    v_and_b32 v53, 0xffff0000, v52
    v_lshlrev_b32 v52, 16, v52
    v_add_f32 v53, v53, v6
    v_sub_f32 v42, v42, v52
    v_sub_f32 v43, v43, v52
    v_cvt_pk_bf16_f32 v53, v53, v53
    v_lshlrev_b32 v53, 16, v53
    v_sqrt_f32 v53, v53
    v_cvt_pk_bf16_f32 v42, v42, v43
    v_and_b32 v43, 0xffff0000, v42
    v_lshlrev_b32 v42, 16, v42
    v_cvt_pk_bf16_f32 v53, v53, v53
    v_lshlrev_b32 v53, 16, v53
    v_rcp_f32 v53, v53
    s_nop 0
    v_mul_f32 v42, v42, v53
    v_mul_f32 v43, v43, v53
    v_cvt_pk_bf16_f32 v42, v42, v43
    v_and_b32 v43, 0xffff0000, v42
    v_lshlrev_b32 v42, 16, v42
    v_mul_f32 v42, v42, v24
    v_mul_f32 v43, v43, v25
    v_cvt_pk_bf16_f32 v42, v42, v43
    v_and_b32 v43, 0xffff0000, v42
    v_lshlrev_b32 v42, 16, v42
    v_add_f32 v42, v42, v32
    v_add_f32 v43, v43, v33
    v_cvt_pk_bf16_f32 v44, v42, v43
    ds_write_b32 v2, v44 offset:2048
    s_waitcnt lgkmcnt(0)
    s_mov_b64 exec, 0xffffffff
    ds_read_b128 v[52:55], v7 offset:1024
    s_waitcnt lgkmcnt(0)
    buffer_store_dwordx4 v[52:55], v3, s[8:11], s48 offen sc1
    s_mov_b64 exec, -1
    s_waitcnt vmcnt(0)
    s_barrier
    s_cmp_lg_u32 s21, 0
    s_cbranch_scc1 SG_60
    v_mov_b32 v48, 1
    s_mov_b64 exec, 1
    buffer_atomic_add v48, off, s[8:11], s50 offset:0
    s_mov_b64 exec, -1
SG_60:
    s_add_u32 s36, s36, 52
    s_cmp_lt_u32 s36, s7
    s_cbranch_scc1 RL_49
    s_cmp_eq_u32 s7, 2048
    s_cbranch_scc1 m_dl
    s_branch m_fin
m_ab:
    s_load_dwordx2 s[84:85], s[0:1], 40
    s_waitcnt lgkmcnt(0)
    s_barrier
    s_mov_b32 s44, s84
    s_and_b32 s45, s85, 0xffff
    s_mov_b32 s46, 0x400000
    s_mov_b32 s47, 0x20000
    v_and_b32 v61, 15, v60
    v_lshrrev_b32 v62, 4, v60
    v_bfe_u32 v63, v60, 2, 2
    v_and_b32 v64, 3, v60
    s_lshl_b32 s42, s21, 15
    s_add_u32 s42, s42, 32768
    v_lshlrev_b32 v65, 10, v62
    v_lshlrev_b32 v66, 4, v61
    v_lshlrev_b32 v67, 5, v62
    v_xor_b32 v66, v66, v67
    s_lshl_b32 s40, s20, 17
    s_lshl_b32 s41, s21, 8
    s_add_u32 s40, s40, s41
    v_add3_u32 v65, v65, v66, s40
    v_xor_b32 v66, 128, v65
    s_add_u32 m0, s42, 0
    s_mov_b32 s43, 0
    buffer_load_dwordx4 v65, s[44:47], s43 offen lds
    s_add_u32 m0, s42, 1024
    s_mov_b32 s43, 4096
    buffer_load_dwordx4 v66, s[44:47], s43 offen lds
    s_add_u32 m0, s42, 2048
    s_mov_b32 s43, 8192
    buffer_load_dwordx4 v65, s[44:47], s43 offen lds
    s_add_u32 m0, s42, 3072
    s_mov_b32 s43, 12288
    buffer_load_dwordx4 v66, s[44:47], s43 offen lds
    s_add_u32 m0, s42, 4096
    s_mov_b32 s43, 16384
    buffer_load_dwordx4 v65, s[44:47], s43 offen lds
    s_add_u32 m0, s42, 5120
    s_mov_b32 s43, 20480
    buffer_load_dwordx4 v66, s[44:47], s43 offen lds
    s_add_u32 m0, s42, 6144
    s_mov_b32 s43, 24576
    buffer_load_dwordx4 v65, s[44:47], s43 offen lds
    s_add_u32 m0, s42, 7168
    s_mov_b32 s43, 28672
    buffer_load_dwordx4 v66, s[44:47], s43 offen lds
    s_add_u32 m0, s42, 8192
    s_mov_b32 s43, 32768
    buffer_load_dwordx4 v65, s[44:47], s43 offen lds
    s_add_u32 m0, s42, 9216
    s_mov_b32 s43, 36864
    buffer_load_dwordx4 v66, s[44:47], s43 offen lds
    s_add_u32 m0, s42, 10240
    s_mov_b32 s43, 40960
    buffer_load_dwordx4 v65, s[44:47], s43 offen lds
    s_add_u32 m0, s42, 11264
    s_mov_b32 s43, 45056
    buffer_load_dwordx4 v66, s[44:47], s43 offen lds
    s_add_u32 m0, s42, 12288
    s_mov_b32 s43, 49152
    buffer_load_dwordx4 v65, s[44:47], s43 offen lds
    s_add_u32 m0, s42, 13312
    s_mov_b32 s43, 53248
    buffer_load_dwordx4 v66, s[44:47], s43 offen lds
    s_add_u32 m0, s42, 14336
    s_mov_b32 s43, 57344
    buffer_load_dwordx4 v65, s[44:47], s43 offen lds
    s_add_u32 m0, s42, 15360
    s_mov_b32 s43, 61440
    buffer_load_dwordx4 v66, s[44:47], s43 offen lds
    s_add_u32 m0, s42, 16384
    s_mov_b32 s43, 65536
    buffer_load_dwordx4 v65, s[44:47], s43 offen lds
    s_add_u32 m0, s42, 17408
    s_mov_b32 s43, 69632
    buffer_load_dwordx4 v66, s[44:47], s43 offen lds
    s_add_u32 m0, s42, 18432
    s_mov_b32 s43, 73728
    buffer_load_dwordx4 v65, s[44:47], s43 offen lds
    s_add_u32 m0, s42, 19456
    s_mov_b32 s43, 77824
    buffer_load_dwordx4 v66, s[44:47], s43 offen lds
    s_add_u32 m0, s42, 20480
    s_mov_b32 s43, 81920
    buffer_load_dwordx4 v65, s[44:47], s43 offen lds
    s_add_u32 m0, s42, 21504
    s_mov_b32 s43, 86016
    buffer_load_dwordx4 v66, s[44:47], s43 offen lds
    s_add_u32 m0, s42, 22528
    s_mov_b32 s43, 90112
    buffer_load_dwordx4 v65, s[44:47], s43 offen lds
    s_add_u32 m0, s42, 23552
    s_mov_b32 s43, 94208
    buffer_load_dwordx4 v66, s[44:47], s43 offen lds
    s_add_u32 m0, s42, 24576
    s_mov_b32 s43, 98304
    buffer_load_dwordx4 v65, s[44:47], s43 offen lds
    s_add_u32 m0, s42, 25600
    s_mov_b32 s43, 102400
    buffer_load_dwordx4 v66, s[44:47], s43 offen lds
    s_add_u32 m0, s42, 26624
    s_mov_b32 s43, 106496
    buffer_load_dwordx4 v65, s[44:47], s43 offen lds
    s_add_u32 m0, s42, 27648
    s_mov_b32 s43, 110592
    buffer_load_dwordx4 v66, s[44:47], s43 offen lds
    s_add_u32 m0, s42, 28672
    s_mov_b32 s43, 114688
    buffer_load_dwordx4 v65, s[44:47], s43 offen lds
    s_add_u32 m0, s42, 29696
    s_mov_b32 s43, 118784
    buffer_load_dwordx4 v66, s[44:47], s43 offen lds
    s_add_u32 m0, s42, 30720
    s_mov_b32 s43, 122880
    buffer_load_dwordx4 v65, s[44:47], s43 offen lds
    s_add_u32 m0, s42, 31744
    s_mov_b32 s43, 126976
    buffer_load_dwordx4 v66, s[44:47], s43 offen lds
    v_lshlrev_b32 v67, 2, v62
    v_add_u32 v67, v67, v63
    v_and_b32 v68, 7, v67
    v_lshlrev_b32 v68, 5, v68
    v_lshlrev_b32 v67, 8, v67
    v_lshlrev_b32 v69, 3, v64
    v_add3_u32 v67, v67, v68, v69
    v_add_u32 v67, s42, v67
    s_waitcnt vmcnt(24)
    v_xor_b32 v68, 0, v67
    ds_read_b64_tr_b16 a[0:1], v68 offset:0
    ds_read_b64_tr_b16 a[2:3], v68 offset:4096
    v_xor_b32 v68, 32, v67
    ds_read_b64_tr_b16 a[4:5], v68 offset:0
    ds_read_b64_tr_b16 a[6:7], v68 offset:4096
    v_xor_b32 v68, 64, v67
    ds_read_b64_tr_b16 a[8:9], v68 offset:0
    ds_read_b64_tr_b16 a[10:11], v68 offset:4096
    v_xor_b32 v68, 96, v67
    ds_read_b64_tr_b16 a[12:13], v68 offset:0
    ds_read_b64_tr_b16 a[14:15], v68 offset:4096
    v_xor_b32 v68, 128, v67
    ds_read_b64_tr_b16 a[16:17], v68 offset:0
    ds_read_b64_tr_b16 a[18:19], v68 offset:4096
    v_xor_b32 v68, 160, v67
    ds_read_b64_tr_b16 a[20:21], v68 offset:0
    ds_read_b64_tr_b16 a[22:23], v68 offset:4096
    v_xor_b32 v68, 192, v67
    ds_read_b64_tr_b16 a[24:25], v68 offset:0
    ds_read_b64_tr_b16 a[26:27], v68 offset:4096
    v_xor_b32 v68, 224, v67
    ds_read_b64_tr_b16 a[28:29], v68 offset:0
    ds_read_b64_tr_b16 a[30:31], v68 offset:4096
    s_waitcnt vmcnt(16)
    v_xor_b32 v68, 0, v67
    ds_read_b64_tr_b16 a[32:33], v68 offset:8192
    ds_read_b64_tr_b16 a[34:35], v68 offset:12288
    v_xor_b32 v68, 32, v67
    ds_read_b64_tr_b16 a[36:37], v68 offset:8192
    ds_read_b64_tr_b16 a[38:39], v68 offset:12288
    v_xor_b32 v68, 64, v67
    ds_read_b64_tr_b16 a[40:41], v68 offset:8192
    ds_read_b64_tr_b16 a[42:43], v68 offset:12288
    v_xor_b32 v68, 96, v67
    ds_read_b64_tr_b16 a[44:45], v68 offset:8192
    ds_read_b64_tr_b16 a[46:47], v68 offset:12288
    v_xor_b32 v68, 128, v67
    ds_read_b64_tr_b16 a[48:49], v68 offset:8192
    ds_read_b64_tr_b16 a[50:51], v68 offset:12288
    v_xor_b32 v68, 160, v67
    ds_read_b64_tr_b16 a[52:53], v68 offset:8192
    ds_read_b64_tr_b16 a[54:55], v68 offset:12288
    v_xor_b32 v68, 192, v67
    ds_read_b64_tr_b16 a[56:57], v68 offset:8192
    ds_read_b64_tr_b16 a[58:59], v68 offset:12288
    v_xor_b32 v68, 224, v67
    ds_read_b64_tr_b16 a[60:61], v68 offset:8192
    ds_read_b64_tr_b16 a[62:63], v68 offset:12288
    s_waitcnt vmcnt(8)
    v_xor_b32 v68, 0, v67
    ds_read_b64_tr_b16 a[64:65], v68 offset:16384
    ds_read_b64_tr_b16 a[66:67], v68 offset:20480
    v_xor_b32 v68, 32, v67
    ds_read_b64_tr_b16 a[68:69], v68 offset:16384
    ds_read_b64_tr_b16 a[70:71], v68 offset:20480
    v_xor_b32 v68, 64, v67
    ds_read_b64_tr_b16 a[72:73], v68 offset:16384
    ds_read_b64_tr_b16 a[74:75], v68 offset:20480
    v_xor_b32 v68, 96, v67
    ds_read_b64_tr_b16 a[76:77], v68 offset:16384
    ds_read_b64_tr_b16 a[78:79], v68 offset:20480
    v_xor_b32 v68, 128, v67
    ds_read_b64_tr_b16 a[80:81], v68 offset:16384
    ds_read_b64_tr_b16 a[82:83], v68 offset:20480
    v_xor_b32 v68, 160, v67
    ds_read_b64_tr_b16 a[84:85], v68 offset:16384
    ds_read_b64_tr_b16 a[86:87], v68 offset:20480
    v_xor_b32 v68, 192, v67
    ds_read_b64_tr_b16 a[88:89], v68 offset:16384
    ds_read_b64_tr_b16 a[90:91], v68 offset:20480
    v_xor_b32 v68, 224, v67
    ds_read_b64_tr_b16 a[92:93], v68 offset:16384
    ds_read_b64_tr_b16 a[94:95], v68 offset:20480
    s_waitcnt vmcnt(0)
    v_xor_b32 v68, 0, v67
    ds_read_b64_tr_b16 a[96:97], v68 offset:24576
    ds_read_b64_tr_b16 a[98:99], v68 offset:28672
    v_xor_b32 v68, 32, v67
    ds_read_b64_tr_b16 a[100:101], v68 offset:24576
    ds_read_b64_tr_b16 a[102:103], v68 offset:28672
    v_xor_b32 v68, 64, v67
    ds_read_b64_tr_b16 a[104:105], v68 offset:24576
    ds_read_b64_tr_b16 a[106:107], v68 offset:28672
    v_xor_b32 v68, 96, v67
    ds_read_b64_tr_b16 a[108:109], v68 offset:24576
    ds_read_b64_tr_b16 a[110:111], v68 offset:28672
    v_xor_b32 v68, 128, v67
    ds_read_b64_tr_b16 a[112:113], v68 offset:24576
    ds_read_b64_tr_b16 a[114:115], v68 offset:28672
    v_xor_b32 v68, 160, v67
    ds_read_b64_tr_b16 a[116:117], v68 offset:24576
    ds_read_b64_tr_b16 a[118:119], v68 offset:28672
    v_xor_b32 v68, 192, v67
    ds_read_b64_tr_b16 a[120:121], v68 offset:24576
    ds_read_b64_tr_b16 a[122:123], v68 offset:28672
    v_xor_b32 v68, 224, v67
    ds_read_b64_tr_b16 a[124:125], v68 offset:24576
    ds_read_b64_tr_b16 a[126:127], v68 offset:28672
    v_mov_b32 v0, 0x4444
    v_mov_b32 v63, 0xeeee
    v_and_b32 v64, 2, v61
    v_cmp_ne_u32 vcc, 0, v64
    s_nop 1
    v_cndmask_b32 v0, v0, v63, vcc
    v_lshrrev_b32 v63, 2, v61
    v_cmp_eq_u32 vcc, v63, v62
    v_and_b32 v64, 1, v61
    v_lshlrev_b32 v64, 4, v64
    v_mov_b32 v65, 0x3f80
    v_lshlrev_b32 v64, v64, v65
    v_cndmask_b32 v2, 0, v64, vcc
    v_mov_b32 v3, v2
    v_lshlrev_b32 v1, 4, v60
    s_and_b32 s37, s21, 1
    s_lshr_b32 s38, s21, 1
    s_lshl_b32 s40, s21, 11
    v_add_u32 v4, s40, v1
    v_mul_u32_u24 v65, 272, v61
    v_lshlrev_b32 v66, 4, v62
    s_mul_i32 s40, s21, 8704
    s_add_u32 s40, s40, 24576
    v_add3_u32 v5, v65, v66, s40
    v_lshlrev_b32 v65, 10, v62
    v_lshlrev_b32 v66, 4, v61
    s_lshl_b32 s41, s20, 15
    s_lshl_b32 s42, s21, 8
    s_add_u32 s41, s41, s42
    v_add3_u32 v6, v65, v66, s41
    v_mul_u32_u24 v65, 272, v62
    v_add3_u32 v63, v65, v66, s40
    s_mov_b32 s39, 0x3db504f3
    s_mov_b32 s42, 0x3fb8aa3b
    s_mov_b32 s36, s6
    s_mov_b32 s43, 65536
    v_mov_b32 v56, 0x3f803f80
    v_mov_b32 v57, 0x3f803f80
    v_mov_b32 v58, 0x3f803f80
    v_mov_b32 v59, 0x3f803f80
    v_lshlrev_b32 v65, 2, v62
    v_add_u32 v66, 0, v65
    v_cmp_le_u32 s[48:49], v66, v61
    v_add_u32 v66, 1, v65
    v_cmp_le_u32 s[50:51], v66, v61
    v_add_u32 v66, 2, v65
    v_cmp_le_u32 s[52:53], v66, v61
    v_add_u32 v66, 3, v65
    v_cmp_le_u32 s[54:55], v66, v61
    v_lshrrev_b32 v65, 2, v1
    s_lshl_b32 s41, s20, 8
    s_mov_b32 s23, 0
AF_61:
    buffer_load_dword v66, v65, s[8:11], s41 offen sc1
    s_waitcnt vmcnt(0)
    v_cmp_gt_u32 vcc, 2, v66
    s_cbranch_vccz AFd_62
    s_sleep 8
    s_add_u32 s23, s23, 1
    s_cmp_lt_u32 s23, 400000
    s_cbranch_scc1 AF_61
    s_branch m_exit
AFd_62:
    s_waitcnt lgkmcnt(0)
    s_barrier
    s_lshl_b32 s56, s36, 5
    s_add_u32 s56, s56, s20
    s_lshl_b32 s57, s56, 14
    s_lshl_b32 s56, s56, 13
    s_add_u32 s56, s56, 33554432
    s_add_u32 s57, s57, 50331648
    s_mul_i32 s58, s36, 0
    s_add_u32 s57, s57, s58
    s_lshl_b32 s58, s21, 11
    s_add_u32 s57, s57, s58
    s_add_u32 m0, s43, s58
    s_add_u32 s58, s58, s58
    buffer_load_dwordx4 v4, s[8:11], s56 offen offset:0 sc1 lds
    buffer_load_dwordx4 v4, s[8:11], s56 offen offset:1024 sc1 lds
    s_add_u32 s58, s58, s43
    s_add_u32 m0, s58, 8192
    s_nop 0
    buffer_load_dwordx4 v4, s[8:11], s57 offen offset:0 sc1 lds
    buffer_load_dwordx4 v4, s[8:11], s57 offen offset:1024 sc1 lds
    buffer_load_dwordx4 v4, s[8:11], s57 offen offset:2048 sc1 lds
    buffer_load_dwordx4 v4, s[8:11], s57 offen offset:3072 sc1 lds
    s_waitcnt vmcnt(0)
    s_barrier
AL_63:
    s_sub_u32 s40, s36, 40
    s_cmp_ge_u32 s40, 3
    s_cbranch_scc1 FG_64
    s_cmp_lg_u32 s21, 0
    s_cbranch_scc1 PD_66
    s_mov_b32 s23, 0
PL_65:
    buffer_load_dword v124, off, s[16:19], 0 offset:196 sc1
    s_waitcnt vmcnt(0)
    v_readfirstlane_b32 s40, v124
    s_nop 0
    s_cmp_ge_u32 s40, 1
    s_cbranch_scc1 PD_66
    s_sleep 2
    s_add_u32 s23, s23, 1
    s_cmp_lt_u32 s23, 400000
    s_cbranch_scc1 PL_65
    s_branch m_exit
PD_66:
    s_barrier
FG_64:
    v_add_u32 v7, s43, v1
    s_lshl_b32 s58, s36, 13
    s_add_u32 s58, s58, 131072
    s_mov_b32 s23, 0
    buffer_load_dwordx4 v[64:67], v4, s[8:11], s58 offen sc1
    buffer_load_dwordx4 v[68:71], v4, s[8:11], s58 offen offset:1024 sc1
    s_lshl_b32 s40, s37, 10
    v_add_u32 v124, s40, v7
    ds_read_b128 v[8:11], v124 offset:0
    ds_read_b128 v[24:27], v7 offset:8192
    ds_read_b128 v[40:43], v7 offset:9216
    ds_read_b128 v[12:15], v124 offset:2048
    ds_read_b128 v[28:31], v7 offset:12288
    ds_read_b128 v[44:47], v7 offset:13312
    ds_read_b128 v[16:19], v124 offset:4096
    ds_read_b128 v[32:35], v7 offset:16384
    ds_read_b128 v[48:51], v7 offset:17408
    ds_read_b128 v[20:23], v124 offset:6144
    ds_read_b128 v[36:39], v7 offset:20480
    ds_read_b128 v[52:55], v7 offset:21504
    v_mov_b64 v[96:97], 0
    v_mov_b64 v[98:99], 0
    v_mov_b64 v[100:101], 0
    v_mov_b64 v[102:103], 0
    v_mov_b64 v[104:105], 0
    v_mov_b64 v[106:107], 0
    v_mov_b64 v[108:109], 0
    v_mov_b64 v[110:111], 0
    s_waitcnt lgkmcnt(9)
    v_mfma_f32_16x16x32_bf16 v[116:119], v[24:27], v[8:11], 0
    v_mfma_f32_16x16x32_bf16 v[120:123], v[40:43], v[8:11], 0
    s_waitcnt lgkmcnt(6)
    v_mfma_f32_16x16x32_bf16 v[116:119], v[28:31], v[12:15], v[116:119]
    v_mfma_f32_16x16x32_bf16 v[120:123], v[44:47], v[12:15], v[120:123]
    s_waitcnt lgkmcnt(3)
    v_mfma_f32_16x16x32_bf16 v[116:119], v[32:35], v[16:19], v[116:119]
    v_mfma_f32_16x16x32_bf16 v[120:123], v[48:51], v[16:19], v[120:123]
    s_waitcnt lgkmcnt(0)
    v_mfma_f32_16x16x32_bf16 v[116:119], v[36:39], v[20:23], v[116:119]
    v_mfma_f32_16x16x32_bf16 v[120:123], v[52:55], v[20:23], v[120:123]
    s_lshl_b32 s40, s38, 13
    v_add_u32 v124, s40, v7
    ds_read_b128 v[24:27], v124 offset:10240
    ds_read_b128 v[28:31], v124 offset:11264
    ds_read_b128 v[32:35], v124 offset:14336
    ds_read_b128 v[36:39], v124 offset:15360
    v_mov_b32 v124, 0xff800000
    s_cmp_lg_u32 s37, 0
    s_cbranch_scc1 Q1_69
    v_cndmask_b32 v116, v124, v116, s[48:49]
    v_mov_b32 v120, v124
    v_cndmask_b32 v117, v124, v117, s[50:51]
    v_mov_b32 v121, v124
    v_cndmask_b32 v118, v124, v118, s[52:53]
    v_mov_b32 v122, v124
    v_cndmask_b32 v119, v124, v119, s[54:55]
    v_mov_b32 v123, v124
    s_branch QM_70
Q1_69:
    v_cndmask_b32 v120, v124, v120, s[48:49]
    v_cndmask_b32 v121, v124, v121, s[50:51]
    v_cndmask_b32 v122, v124, v122, s[52:53]
    v_cndmask_b32 v123, v124, v123, s[54:55]
QM_70:
    v_cvt_pk_bf16_f32 v116, v116, v117
    v_cvt_pk_bf16_f32 v118, v118, v119
    v_cvt_pk_bf16_f32 v120, v120, v121
    v_cvt_pk_bf16_f32 v122, v122, v123
    v_and_b32 v117, 0xffff0000, v116
    v_lshlrev_b32 v116, 16, v116
    v_and_b32 v119, 0xffff0000, v118
    v_lshlrev_b32 v118, 16, v118
    v_and_b32 v121, 0xffff0000, v120
    v_lshlrev_b32 v120, 16, v120
    v_and_b32 v123, 0xffff0000, v122
    v_lshlrev_b32 v122, 16, v122
    v_mul_f32 v116, s39, v116
    v_mul_f32 v117, s39, v117
    v_mul_f32 v118, s39, v118
    v_mul_f32 v119, s39, v119
    v_mul_f32 v120, s39, v120
    v_mul_f32 v121, s39, v121
    v_mul_f32 v122, s39, v122
    v_mul_f32 v123, s39, v123
    v_cvt_pk_bf16_f32 v116, v116, v117
    v_cvt_pk_bf16_f32 v118, v118, v119
    v_cvt_pk_bf16_f32 v120, v120, v121
    v_cvt_pk_bf16_f32 v122, v122, v123
    v_and_b32 v117, 0xffff0000, v116
    v_lshlrev_b32 v116, 16, v116
    v_and_b32 v119, 0xffff0000, v118
    v_lshlrev_b32 v118, 16, v118
    v_and_b32 v121, 0xffff0000, v120
    v_lshlrev_b32 v120, 16, v120
    v_and_b32 v123, 0xffff0000, v122
    v_lshlrev_b32 v122, 16, v122
    v_max3_f32 v40, v116, v117, v118
    v_max3_f32 v40, v40, v119, v120
    v_max3_f32 v40, v40, v121, v122
    v_max_f32 v40, v40, v123
    s_branch MD_68x
MP_67:
    s_sleep 2
    buffer_load_dwordx4 v[64:67], v4, s[8:11], s58 offen sc1
    buffer_load_dwordx4 v[68:71], v4, s[8:11], s58 offen offset:1024 sc1
    s_add_u32 s23, s23, 1
    s_cmp_ge_u32 s23, 400000
    s_cbranch_scc1 m_exit
MD_68x:
    s_waitcnt vmcnt(0)
    v_max3_u32 v124, v64, v65, v66
    v_max3_u32 v125, v67, v68, v69
    v_max3_u32 v124, v70, v71, v124
    v_max_u32 v124, v124, v125
    v_cmp_eq_u32 vcc, -1, v124
    ds_write_b128 v4, v[64:67] offset:16384
    ds_write_b128 v4, v[68:71] offset:17408
    s_cbranch_vccnz MP_67
    s_waitcnt lgkmcnt(0)
    s_barrier
    ds_read_b128 v[64:67], v1 offset:16384
    ds_read_b128 v[68:71], v1 offset:17408
    ds_read_b128 v[72:75], v1 offset:18432
    ds_read_b128 v[76:79], v1 offset:19456
    ds_read_b128 v[80:83], v1 offset:20480
    ds_read_b128 v[84:87], v1 offset:21504
    ds_read_b128 v[88:91], v1 offset:22528
    ds_read_b128 v[92:95], v1 offset:23552
    s_waitcnt lgkmcnt(7)
    v_smfmac_f32_16x16x64_bf16 v[96:99], v[64:67], a[128:135], v0
    v_smfmac_f32_16x16x64_bf16 v[100:103], v[64:67], a[136:143], v0
    s_waitcnt lgkmcnt(6)
    v_smfmac_f32_16x16x64_bf16 v[96:99], v[68:71], a[144:151], v0
    v_smfmac_f32_16x16x64_bf16 v[100:103], v[68:71], a[152:159], v0
    s_waitcnt lgkmcnt(5)
    v_smfmac_f32_16x16x64_bf16 v[96:99], v[72:75], a[160:167], v0
    v_smfmac_f32_16x16x64_bf16 v[100:103], v[72:75], a[168:175], v0
    s_waitcnt lgkmcnt(4)
    v_smfmac_f32_16x16x64_bf16 v[96:99], v[76:79], a[176:183], v0
    v_smfmac_f32_16x16x64_bf16 v[100:103], v[76:79], a[184:191], v0
    s_waitcnt lgkmcnt(3)
    v_smfmac_f32_16x16x64_bf16 v[96:99], v[80:83], a[192:199], v0
    v_smfmac_f32_16x16x64_bf16 v[100:103], v[80:83], a[200:207], v0
    s_waitcnt lgkmcnt(2)
    v_smfmac_f32_16x16x64_bf16 v[96:99], v[84:87], a[208:215], v0
    v_smfmac_f32_16x16x64_bf16 v[100:103], v[84:87], a[216:223], v0
    s_waitcnt lgkmcnt(1)
    v_smfmac_f32_16x16x64_bf16 v[96:99], v[88:91], a[224:231], v0
    v_smfmac_f32_16x16x64_bf16 v[100:103], v[88:91], a[232:239], v0
    s_waitcnt lgkmcnt(0)
    v_smfmac_f32_16x16x64_bf16 v[96:99], v[92:95], a[240:247], v0
    v_smfmac_f32_16x16x64_bf16 v[100:103], v[92:95], a[248:255], v0
    v_smfmac_f32_16x16x64_bf16 v[104:107], v[64:67], v[128:135], v0
    v_smfmac_f32_16x16x64_bf16 v[108:111], v[64:67], v[136:143], v0
    v_smfmac_f32_16x16x64_bf16 v[104:107], v[68:71], v[144:151], v0
    s_nop 3
    v_cvt_pk_bf16_f32 v124, v96, v97
    v_cvt_pk_bf16_f32 v125, v98, v99
    v_cvt_pk_bf16_f32 v126, v100, v101
    v_cvt_pk_bf16_f32 v127, v102, v103
    v_mfma_f32_16x16x16_bf16 v[44:47], v[124:125], v[2:3], 0
    s_nop 0
    v_mfma_f32_16x16x16_bf16 v[48:51], v[126:127], v[2:3], 0
    v_smfmac_f32_16x16x64_bf16 v[108:111], v[68:71], v[152:159], v0
    v_smfmac_f32_16x16x64_bf16 v[104:107], v[72:75], v[160:167], v0
    v_smfmac_f32_16x16x64_bf16 v[108:111], v[72:75], v[168:175], v0
    s_lshl_b32 s40, s21, 10
    v_add_u32 v41, s40, v1
    s_nop 0
    v_cvt_pk_bf16_f32 v124, v44, v45
    v_cvt_pk_bf16_f32 v125, v46, v47
    v_cvt_pk_bf16_f32 v126, v48, v49
    v_cvt_pk_bf16_f32 v127, v50, v51
    ds_write_b128 v41, v[124:127] offset:0
    v_smfmac_f32_16x16x64_bf16 v[104:107], v[76:79], v[176:183], v0
    v_smfmac_f32_16x16x64_bf16 v[108:111], v[76:79], v[184:191], v0
    v_smfmac_f32_16x16x64_bf16 v[104:107], v[80:83], v[192:199], v0
    v_smfmac_f32_16x16x64_bf16 v[108:111], v[80:83], v[200:207], v0
    v_smfmac_f32_16x16x64_bf16 v[104:107], v[84:87], v[208:215], v0
    v_smfmac_f32_16x16x64_bf16 v[108:111], v[84:87], v[216:223], v0
    v_smfmac_f32_16x16x64_bf16 v[104:107], v[88:91], v[224:231], v0
    v_smfmac_f32_16x16x64_bf16 v[108:111], v[88:91], v[232:239], v0
    v_smfmac_f32_16x16x64_bf16 v[104:107], v[92:95], v[240:247], v0
    v_smfmac_f32_16x16x64_bf16 v[108:111], v[92:95], v[248:255], v0
    s_add_u32 s59, s36, 3
    s_min_u32 s59, s59, 63
    s_xor_b32 s43, s43, 32768
    s_lshl_b32 s56, s59, 5
    s_add_u32 s56, s56, s20
    s_lshl_b32 s57, s56, 14
    s_lshl_b32 s56, s56, 13
    s_add_u32 s56, s56, 33554432
    s_add_u32 s57, s57, 50331648
    s_mul_i32 s58, s59, 0
    s_add_u32 s57, s57, s58
    s_lshl_b32 s58, s21, 11
    s_add_u32 s57, s57, s58
    s_add_u32 m0, s43, s58
    s_add_u32 s58, s58, s58
    buffer_load_dwordx4 v4, s[8:11], s56 offen offset:0 sc1 lds
    buffer_load_dwordx4 v4, s[8:11], s56 offen offset:1024 sc1 lds
    s_add_u32 s58, s58, s43
    s_add_u32 m0, s58, 8192
    s_nop 0
    buffer_load_dwordx4 v4, s[8:11], s57 offen offset:0 sc1 lds
    buffer_load_dwordx4 v4, s[8:11], s57 offen offset:1024 sc1 lds
    buffer_load_dwordx4 v4, s[8:11], s57 offen offset:2048 sc1 lds
    buffer_load_dwordx4 v4, s[8:11], s57 offen offset:3072 sc1 lds
    v_cvt_pk_bf16_f32 v96, v104, v105
    v_cvt_pk_bf16_f32 v97, v106, v107
    v_cvt_pk_bf16_f32 v98, v108, v109
    v_cvt_pk_bf16_f32 v99, v110, v111
    ds_write_b128 v41, v[96:99] offset:4096
    s_waitcnt lgkmcnt(0)
    s_barrier
    ds_read_b128 v[80:83], v1 offset:0
    ds_read_b128 v[84:87], v1 offset:1024
    ds_read_b128 v[88:91], v1 offset:2048
    ds_read_b128 v[92:95], v1 offset:3072
    s_lshl_b32 s40, s38, 11
    v_add_u32 v124, s40, v1
    ds_read_b128 v[96:99], v124 offset:4096
    ds_read_b128 v[100:103], v124 offset:5120
    s_waitcnt lgkmcnt(5)
    v_mfma_f32_16x16x32_bf16 v[112:115], v[80:83], v[8:11], 0
    s_waitcnt lgkmcnt(4)
    v_mfma_f32_16x16x32_bf16 v[112:115], v[84:87], v[12:15], v[112:115]
    s_waitcnt lgkmcnt(3)
    v_mfma_f32_16x16x32_bf16 v[112:115], v[88:91], v[16:19], v[112:115]
    s_waitcnt lgkmcnt(2)
    v_mfma_f32_16x16x32_bf16 v[112:115], v[92:95], v[20:23], v[112:115]
    s_nop 7
    v_cvt_pk_bf16_f32 v112, v112, v113
    v_and_b32 v113, 0xffff0000, v112
    v_lshlrev_b32 v112, 16, v112
    v_mul_f32 v112, s39, v112
    v_mul_f32 v113, s39, v113
    v_cvt_pk_bf16_f32 v112, v112, v113
    v_and_b32 v113, 0xffff0000, v112
    v_lshlrev_b32 v112, 16, v112
    v_max3_f32 v40, v40, v112, v113
    v_mov_b32 v126, v40
    s_nop 1
    v_permlane16_swap_b32 v40, v126
    v_max_f32 v40, v40, v126
    v_mov_b32 v126, v40
    s_nop 1
    v_permlane32_swap_b32 v40, v126
    v_max_f32 v40, v40, v126
    v_mul_f32 v40, s42, v40
    v_fma_f32 v116, v116, s42, -v40
    v_fma_f32 v117, v117, s42, -v40
    v_fma_f32 v118, v118, s42, -v40
    v_fma_f32 v119, v119, s42, -v40
    v_fma_f32 v120, v120, s42, -v40
    v_fma_f32 v121, v121, s42, -v40
    v_fma_f32 v122, v122, s42, -v40
    v_fma_f32 v123, v123, s42, -v40
    v_fma_f32 v112, v112, s42, -v40
    v_fma_f32 v113, v113, s42, -v40
    v_exp_f32 v116, v116
    v_exp_f32 v117, v117
    v_exp_f32 v118, v118
    v_exp_f32 v119, v119
    v_exp_f32 v120, v120
    v_exp_f32 v121, v121
    v_exp_f32 v122, v122
    v_exp_f32 v123, v123
    v_exp_f32 v112, v112
    v_exp_f32 v113, v113
    v_cvt_pk_bf16_f32 v104, v116, v117
    v_cvt_pk_bf16_f32 v105, v118, v119
    v_cvt_pk_bf16_f32 v106, v120, v121
    v_cvt_pk_bf16_f32 v107, v122, v123
    v_cvt_pk_bf16_f32 v108, v112, v113
    v_cvt_pk_bf16_f32 v109, v112, v113
    s_waitcnt lgkmcnt(0)
    v_mfma_f32_16x16x32_bf16 v[112:115], v[56:59], v[104:107], 0
    v_mfma_f32_16x16x16_bf16 v[116:119], v[56:57], v[108:109], 0
    v_mfma_f32_16x16x32_bf16 v[8:11], v[24:27], v[104:107], 0
    v_mfma_f32_16x16x32_bf16 v[12:15], v[28:31], v[104:107], 0
    v_mfma_f32_16x16x32_bf16 v[16:19], v[32:35], v[104:107], 0
    v_mfma_f32_16x16x32_bf16 v[20:23], v[36:39], v[104:107], 0
    v_mfma_f32_16x16x16_bf16 v[8:11], v[96:97], v[108:109], v[8:11]
    v_mfma_f32_16x16x16_bf16 v[12:15], v[98:99], v[108:109], v[12:15]
    v_mfma_f32_16x16x16_bf16 v[16:19], v[100:101], v[108:109], v[16:19]
    v_mfma_f32_16x16x16_bf16 v[20:23], v[102:103], v[108:109], v[20:23]
    v_fma_f32 v124, v116, 0.5, v112
    v_rcp_f32 v124, v124
    s_lshl_b32 s40, s37, 12
    s_lshl_b32 s41, s38, 11
    s_add_u32 s40, s40, s41
    v_add_u32 v126, s40, v1
    v_pk_mul_f32 v[8:9], v[8:9], v[124:125] op_sel_hi:[1,0]
    v_pk_mul_f32 v[10:11], v[10:11], v[124:125] op_sel_hi:[1,0]
    v_pk_mul_f32 v[12:13], v[12:13], v[124:125] op_sel_hi:[1,0]
    v_pk_mul_f32 v[14:15], v[14:15], v[124:125] op_sel_hi:[1,0]
    v_pk_mul_f32 v[16:17], v[16:17], v[124:125] op_sel_hi:[1,0]
    v_pk_mul_f32 v[18:19], v[18:19], v[124:125] op_sel_hi:[1,0]
    v_pk_mul_f32 v[20:21], v[20:21], v[124:125] op_sel_hi:[1,0]
    v_pk_mul_f32 v[22:23], v[22:23], v[124:125] op_sel_hi:[1,0]
    v_cvt_pk_bf16_f32 v24, v8, v9
    v_cvt_pk_bf16_f32 v25, v10, v11
    v_cvt_pk_bf16_f32 v26, v12, v13
    v_cvt_pk_bf16_f32 v27, v14, v15
    ds_write_b128 v126, v[24:27] offset:8192
    v_cvt_pk_bf16_f32 v28, v16, v17
    v_cvt_pk_bf16_f32 v29, v18, v19
    v_cvt_pk_bf16_f32 v30, v20, v21
    v_cvt_pk_bf16_f32 v31, v22, v23
    ds_write_b128 v126, v[28:31] offset:9216
    s_waitcnt lgkmcnt(0)
    s_barrier
    ds_read_b128 v[24:27], v1 offset:8192
    ds_read_b128 v[32:35], v1 offset:9216
    ds_read_b128 v[40:43], v1 offset:10240
    ds_read_b128 v[48:51], v1 offset:11264
    ds_read_b128 v[28:31], v1 offset:12288
    ds_read_b128 v[36:39], v1 offset:13312
    ds_read_b128 v[44:47], v1 offset:14336
    ds_read_b128 v[52:55], v1 offset:15360
    s_lshl_b32 s56, s36, 20
    s_add_u32 s56, s56, 100663296
    s_waitcnt lgkmcnt(7)
    v_mfma_f32_16x16x32_bf16 v[64:67], a[0:3], v[24:27], 0
    v_mfma_f32_16x16x32_bf16 v[68:71], a[4:7], v[24:27], 0
    v_mfma_f32_16x16x32_bf16 v[72:75], a[8:11], v[24:27], 0
    v_mfma_f32_16x16x32_bf16 v[76:79], a[12:15], v[24:27], 0
    v_mfma_f32_16x16x32_bf16 v[80:83], a[16:19], v[24:27], 0
    v_mfma_f32_16x16x32_bf16 v[84:87], a[20:23], v[24:27], 0
    v_mfma_f32_16x16x32_bf16 v[88:91], a[24:27], v[24:27], 0
    v_mfma_f32_16x16x32_bf16 v[92:95], a[28:31], v[24:27], 0
    s_waitcnt lgkmcnt(6)
    v_mfma_f32_16x16x32_bf16 v[64:67], a[32:35], v[32:35], v[64:67]
    v_mfma_f32_16x16x32_bf16 v[68:71], a[36:39], v[32:35], v[68:71]
    v_mfma_f32_16x16x32_bf16 v[72:75], a[40:43], v[32:35], v[72:75]
    v_mfma_f32_16x16x32_bf16 v[76:79], a[44:47], v[32:35], v[76:79]
    v_mfma_f32_16x16x32_bf16 v[80:83], a[48:51], v[32:35], v[80:83]
    v_mfma_f32_16x16x32_bf16 v[84:87], a[52:55], v[32:35], v[84:87]
    v_mfma_f32_16x16x32_bf16 v[88:91], a[56:59], v[32:35], v[88:91]
    v_mfma_f32_16x16x32_bf16 v[92:95], a[60:63], v[32:35], v[92:95]
    s_waitcnt lgkmcnt(5)
    v_mfma_f32_16x16x32_bf16 v[64:67], a[64:67], v[40:43], v[64:67]
    v_mfma_f32_16x16x32_bf16 v[68:71], a[68:71], v[40:43], v[68:71]
    v_mfma_f32_16x16x32_bf16 v[72:75], a[72:75], v[40:43], v[72:75]
    v_mfma_f32_16x16x32_bf16 v[76:79], a[76:79], v[40:43], v[76:79]
    v_mfma_f32_16x16x32_bf16 v[80:83], a[80:83], v[40:43], v[80:83]
    v_mfma_f32_16x16x32_bf16 v[84:87], a[84:87], v[40:43], v[84:87]
    v_mfma_f32_16x16x32_bf16 v[88:91], a[88:91], v[40:43], v[88:91]
    v_mfma_f32_16x16x32_bf16 v[92:95], a[92:95], v[40:43], v[92:95]
    s_waitcnt lgkmcnt(4)
    v_mfma_f32_16x16x32_bf16 v[64:67], a[96:99], v[48:51], v[64:67]
    v_mfma_f32_16x16x32_bf16 v[68:71], a[100:103], v[48:51], v[68:71]
    v_mfma_f32_16x16x32_bf16 v[72:75], a[104:107], v[48:51], v[72:75]
    v_mfma_f32_16x16x32_bf16 v[76:79], a[108:111], v[48:51], v[76:79]
    v_mfma_f32_16x16x32_bf16 v[80:83], a[112:115], v[48:51], v[80:83]
    v_mfma_f32_16x16x32_bf16 v[84:87], a[116:119], v[48:51], v[84:87]
    v_mfma_f32_16x16x32_bf16 v[88:91], a[120:123], v[48:51], v[88:91]
    v_mfma_f32_16x16x32_bf16 v[92:95], a[124:127], v[48:51], v[92:95]
    s_waitcnt lgkmcnt(0)
    v_mfma_f32_16x16x32_bf16 v[96:99], a[0:3], v[28:31], 0
    v_mfma_f32_16x16x32_bf16 v[100:103], a[4:7], v[28:31], 0
    v_mfma_f32_16x16x32_bf16 v[104:107], a[8:11], v[28:31], 0
    v_mfma_f32_16x16x32_bf16 v[108:111], a[12:15], v[28:31], 0
    v_cvt_pk_bf16_f32 v8, v64, v65
    v_cvt_pk_bf16_f32 v9, v66, v67
    v_mfma_f32_16x16x32_bf16 v[112:115], a[16:19], v[28:31], 0
    v_cvt_pk_bf16_f32 v10, v68, v69
    v_cvt_pk_bf16_f32 v11, v70, v71
    v_mfma_f32_16x16x32_bf16 v[116:119], a[20:23], v[28:31], 0
    ds_write_b128 v5, v[8:11] offset:0
    v_cvt_pk_bf16_f32 v12, v72, v73
    v_mfma_f32_16x16x32_bf16 v[120:123], a[24:27], v[28:31], 0
    v_cvt_pk_bf16_f32 v13, v74, v75
    v_cvt_pk_bf16_f32 v14, v76, v77
    v_mfma_f32_16x16x32_bf16 v[124:127], a[28:31], v[28:31], 0
    v_cvt_pk_bf16_f32 v15, v78, v79
    ds_write_b128 v5, v[12:15] offset:64
    v_mfma_f32_16x16x32_bf16 v[96:99], a[32:35], v[36:39], v[96:99]
    v_cvt_pk_bf16_f32 v16, v80, v81
    v_cvt_pk_bf16_f32 v17, v82, v83
    v_mfma_f32_16x16x32_bf16 v[100:103], a[36:39], v[36:39], v[100:103]
    v_cvt_pk_bf16_f32 v18, v84, v85
    v_cvt_pk_bf16_f32 v19, v86, v87
    v_mfma_f32_16x16x32_bf16 v[104:107], a[40:43], v[36:39], v[104:107]
    ds_write_b128 v5, v[16:19] offset:128
    v_cvt_pk_bf16_f32 v20, v88, v89
    v_mfma_f32_16x16x32_bf16 v[108:111], a[44:47], v[36:39], v[108:111]
    v_cvt_pk_bf16_f32 v21, v90, v91
    v_cvt_pk_bf16_f32 v22, v92, v93
    v_mfma_f32_16x16x32_bf16 v[112:115], a[48:51], v[36:39], v[112:115]
    v_cvt_pk_bf16_f32 v23, v94, v95
    ds_write_b128 v5, v[20:23] offset:192
    v_mfma_f32_16x16x32_bf16 v[116:119], a[52:55], v[36:39], v[116:119]
    s_waitcnt lgkmcnt(0)
    ds_read_b128 v[64:67], v63 offset:0
    v_mfma_f32_16x16x32_bf16 v[120:123], a[56:59], v[36:39], v[120:123]
    ds_read_b128 v[68:71], v63 offset:1088
    ds_read_b128 v[72:75], v63 offset:2176
    v_mfma_f32_16x16x32_bf16 v[124:127], a[60:63], v[36:39], v[124:127]
    ds_read_b128 v[76:79], v63 offset:3264
    s_waitcnt lgkmcnt(3)
    v_mfma_f32_16x16x32_bf16 v[96:99], a[64:67], v[44:47], v[96:99]
    s_add_u32 s57, s56, 0
    buffer_store_dwordx4 v[64:67], v6, s[8:11], s57 offen sc1
    v_mfma_f32_16x16x32_bf16 v[100:103], a[68:71], v[44:47], v[100:103]
    s_waitcnt lgkmcnt(2)
    s_add_u32 s57, s56, 4096
    v_mfma_f32_16x16x32_bf16 v[104:107], a[72:75], v[44:47], v[104:107]
    buffer_store_dwordx4 v[68:71], v6, s[8:11], s57 offen sc1
    s_waitcnt lgkmcnt(1)
    v_mfma_f32_16x16x32_bf16 v[108:111], a[76:79], v[44:47], v[108:111]
    s_add_u32 s57, s56, 8192
    buffer_store_dwordx4 v[72:75], v6, s[8:11], s57 offen sc1
    v_mfma_f32_16x16x32_bf16 v[112:115], a[80:83], v[44:47], v[112:115]
    s_waitcnt lgkmcnt(0)
    s_add_u32 s57, s56, 12288
    v_mfma_f32_16x16x32_bf16 v[116:119], a[84:87], v[44:47], v[116:119]
    buffer_store_dwordx4 v[76:79], v6, s[8:11], s57 offen sc1
    v_mfma_f32_16x16x32_bf16 v[120:123], a[88:91], v[44:47], v[120:123]
    v_mfma_f32_16x16x32_bf16 v[124:127], a[92:95], v[44:47], v[124:127]
    v_mfma_f32_16x16x32_bf16 v[96:99], a[96:99], v[52:55], v[96:99]
    v_mfma_f32_16x16x32_bf16 v[100:103], a[100:103], v[52:55], v[100:103]
    v_mfma_f32_16x16x32_bf16 v[104:107], a[104:107], v[52:55], v[104:107]
    v_mfma_f32_16x16x32_bf16 v[108:111], a[108:111], v[52:55], v[108:111]
    v_mfma_f32_16x16x32_bf16 v[112:115], a[112:115], v[52:55], v[112:115]
    v_mfma_f32_16x16x32_bf16 v[116:119], a[116:119], v[52:55], v[116:119]
    v_mfma_f32_16x16x32_bf16 v[120:123], a[120:123], v[52:55], v[120:123]
    v_mfma_f32_16x16x32_bf16 v[124:127], a[124:127], v[52:55], v[124:127]
    s_nop 0
    v_cvt_pk_bf16_f32 v8, v96, v97
    v_cvt_pk_bf16_f32 v9, v98, v99
    v_cvt_pk_bf16_f32 v10, v100, v101
    v_cvt_pk_bf16_f32 v11, v102, v103
    ds_write_b128 v5, v[8:11] offset:4352
    v_cvt_pk_bf16_f32 v12, v104, v105
    v_cvt_pk_bf16_f32 v13, v106, v107
    v_cvt_pk_bf16_f32 v14, v108, v109
    v_cvt_pk_bf16_f32 v15, v110, v111
    ds_write_b128 v5, v[12:15] offset:4416
    v_cvt_pk_bf16_f32 v16, v112, v113
    v_cvt_pk_bf16_f32 v17, v114, v115
    v_cvt_pk_bf16_f32 v18, v116, v117
    v_cvt_pk_bf16_f32 v19, v118, v119
    ds_write_b128 v5, v[16:19] offset:4480
    v_cvt_pk_bf16_f32 v20, v120, v121
    v_cvt_pk_bf16_f32 v21, v122, v123
    v_cvt_pk_bf16_f32 v22, v124, v125
    v_cvt_pk_bf16_f32 v23, v126, v127
    ds_write_b128 v5, v[20:23] offset:4544
    s_waitcnt lgkmcnt(0)
    ds_read_b128 v[96:99], v63 offset:4352
    ds_read_b128 v[100:103], v63 offset:5440
    ds_read_b128 v[104:107], v63 offset:6528
    ds_read_b128 v[108:111], v63 offset:7616
    s_waitcnt lgkmcnt(3)
    s_add_u32 s57, s56, 16384
    buffer_store_dwordx4 v[96:99], v6, s[8:11], s57 offen sc1
    s_waitcnt lgkmcnt(2)
    s_add_u32 s57, s56, 20480
    buffer_store_dwordx4 v[100:103], v6, s[8:11], s57 offen sc1
    s_waitcnt lgkmcnt(1)
    s_add_u32 s57, s56, 24576
    buffer_store_dwordx4 v[104:107], v6, s[8:11], s57 offen sc1
    s_waitcnt lgkmcnt(0)
    s_add_u32 s57, s56, 28672
    buffer_store_dwordx4 v[108:111], v6, s[8:11], s57 offen sc1
    s_lshl_b32 s40, s36, 7
    s_add_u32 s40, s40, 8192
    s_waitcnt vmcnt(0)
    s_barrier
    s_cmp_lg_u32 s21, 0
    s_cbranch_scc1 SG_71
    v_mov_b32 v124, 1
    s_mov_b64 exec, 1
    buffer_atomic_add v124, off, s[8:11], s40 offset:0
    s_mov_b64 exec, -1
SG_71:
    s_add_u32 s36, s36, 3
    s_cmp_lt_u32 s36, 64
    s_cbranch_scc1 AL_63
m_fin:
    s_branch m_exit
m_team:
    s_mov_b32 s20, s5
    s_load_dwordx4 s[84:87], s[0:1], 8
    s_load_dwordx4 s[88:91], s[0:1], 24
    s_load_dwordx2 s[92:93], s[0:1], 40
    s_waitcnt lgkmcnt(0)
    s_mov_b32 s12, s84
    s_and_b32 s13, s85, 0xffff
    s_mov_b32 s14, 0x2000
    s_mov_b32 s15, 0x20000
    s_cmp_eq_u32 s3, 0
    s_cselect_b32 s38, 1, 0x10001
    s_lshl_b32 s32, s20, 8
    s_mov_b32 s44, s86
    s_and_b32 s45, s87, 0xffff
    s_mov_b32 s46, 0x400000
    s_mov_b32 s47, 0x20000
    s_mov_b32 s48, s88
    s_and_b32 s49, s89, 0xffff
    s_mov_b32 s50, 0x400000
    s_mov_b32 s51, 0x20000
    s_mov_b32 s52, s90
    s_and_b32 s53, s91, 0xffff
    s_mov_b32 s54, 0x400000
    s_mov_b32 s55, 0x20000
    s_mov_b32 s56, s92
    s_and_b32 s57, s93, 0xffff
    s_mov_b32 s58, 0x400000
    s_mov_b32 s59, 0x20000
    v_lshrrev_b32 v61, 4, v60
    v_lshlrev_b32 v62, 13, v61
    v_and_b32 v63, 15, v60
    v_lshlrev_b32 v63, 4, v63
    v_lshlrev_b32 v64, 5, v61
    v_xor_b32 v63, v63, v64
    s_and_b32 s40, s21, 1
    s_lshl_b32 s40, s40, 7
    v_xor_b32 v63, s40, v63
    s_lshl_b32 s40, s20, 8
    s_lshl_b32 s41, s21, 16
    s_add_u32 s40, s40, s41
    v_add3_u32 v62, v62, v63, s40
    s_lshl_b32 s42, s21, 11
    s_add_u32 s42, s42, 32768
    v_lshrrev_b32 v63, 4, v60
    v_bfe_u32 v64, v60, 2, 2
    v_and_b32 v65, 3, v60
    v_lshlrev_b32 v66, 3, v63
    v_add_u32 v66, v66, v64
    v_lshlrev_b32 v66, 8, v66
    v_and_b32 v67, 1, v63
    v_lshlrev_b32 v67, 2, v67
    v_or_b32 v67, v67, v64
    s_lshl_b32 s40, s21, 1
    v_xor_b32 v67, s40, v67
    v_lshlrev_b32 v67, 5, v67
    v_lshlrev_b32 v68, 3, v65
    v_add3_u32 v66, v66, v67, v68
    v_add_u32 v66, 32768, v66
    v_xor_b32 v67, 32, v66
    v_add_u32 v73, 0x10000, v66
    v_add_u32 v74, 0x10000, v67
    v_lshrrev_b32 v68, 4, v60
    v_lshlrev_b32 v69, 10, v68
    v_and_b32 v68, 1, v68
    v_lshlrev_b32 v68, 5, v68
    v_and_b32 v70, 15, v60
    v_lshlrev_b32 v70, 4, v70
    v_xor_b32 v70, v70, v68
    v_add_u32 v69, v69, v70
    s_lshl_b32 s40, s20, 17
    s_lshl_b32 s41, s21, 8
    s_add_u32 s40, s40, s41
    v_add_u32 v69, s40, v69
    v_xor_b32 v70, 64, v69
    v_xor_b32 v71, 128, v69
    v_xor_b32 v72, 192, v69
    s_add_u32 m0, s42, 0
    s_mov_b32 s43, 0
    buffer_load_dwordx4 v62, s[44:47], s43 offen lds
    s_add_u32 m0, s42, 1024
    s_mov_b32 s43, 32768
    buffer_load_dwordx4 v62, s[44:47], s43 offen lds
    s_add_u32 m0, s42, 8192
    s_mov_b32 s43, 262144
    buffer_load_dwordx4 v62, s[44:47], s43 offen lds
    s_add_u32 m0, s42, 9216
    s_mov_b32 s43, 294912
    buffer_load_dwordx4 v62, s[44:47], s43 offen lds
    s_add_u32 m0, s42, 16384
    s_mov_b32 s43, 524288
    buffer_load_dwordx4 v62, s[44:47], s43 offen lds
    s_add_u32 m0, s42, 17408
    s_mov_b32 s43, 557056
    buffer_load_dwordx4 v62, s[44:47], s43 offen lds
    s_add_u32 m0, s42, 24576
    s_mov_b32 s43, 786432
    buffer_load_dwordx4 v62, s[44:47], s43 offen lds
    s_add_u32 m0, s42, 25600
    s_mov_b32 s43, 819200
    buffer_load_dwordx4 v62, s[44:47], s43 offen lds
    s_add_u32 m0, s42, 32768
    s_mov_b32 s43, 1048576
    buffer_load_dwordx4 v62, s[44:47], s43 offen lds
    s_add_u32 m0, s42, 33792
    s_mov_b32 s43, 1081344
    buffer_load_dwordx4 v62, s[44:47], s43 offen lds
    s_add_u32 m0, s42, 40960
    s_mov_b32 s43, 1310720
    buffer_load_dwordx4 v62, s[44:47], s43 offen lds
    s_add_u32 m0, s42, 41984
    s_mov_b32 s43, 1343488
    buffer_load_dwordx4 v62, s[44:47], s43 offen lds
    s_add_u32 m0, s42, 49152
    s_mov_b32 s43, 1572864
    buffer_load_dwordx4 v62, s[44:47], s43 offen lds
    s_add_u32 m0, s42, 50176
    s_mov_b32 s43, 1605632
    buffer_load_dwordx4 v62, s[44:47], s43 offen lds
    s_add_u32 m0, s42, 57344
    s_mov_b32 s43, 1835008
    buffer_load_dwordx4 v62, s[44:47], s43 offen lds
    s_add_u32 m0, s42, 58368
    s_mov_b32 s43, 1867776
    buffer_load_dwordx4 v62, s[44:47], s43 offen lds
    s_add_u32 m0, s42, 65536
    s_mov_b32 s43, 2097152
    buffer_load_dwordx4 v62, s[44:47], s43 offen lds
    s_add_u32 m0, s42, 66560
    s_mov_b32 s43, 2129920
    buffer_load_dwordx4 v62, s[44:47], s43 offen lds
    s_add_u32 m0, s42, 73728
    s_mov_b32 s43, 2359296
    buffer_load_dwordx4 v62, s[44:47], s43 offen lds
    s_add_u32 m0, s42, 74752
    s_mov_b32 s43, 2392064
    buffer_load_dwordx4 v62, s[44:47], s43 offen lds
    s_add_u32 m0, s42, 81920
    s_mov_b32 s43, 2621440
    buffer_load_dwordx4 v62, s[44:47], s43 offen lds
    s_add_u32 m0, s42, 82944
    s_mov_b32 s43, 2654208
    buffer_load_dwordx4 v62, s[44:47], s43 offen lds
    s_add_u32 m0, s42, 90112
    s_mov_b32 s43, 2883584
    buffer_load_dwordx4 v62, s[44:47], s43 offen lds
    s_add_u32 m0, s42, 91136
    s_mov_b32 s43, 2916352
    buffer_load_dwordx4 v62, s[44:47], s43 offen lds
    s_add_u32 m0, s42, 98304
    s_mov_b32 s43, 3145728
    buffer_load_dwordx4 v62, s[44:47], s43 offen lds
    s_add_u32 m0, s42, 99328
    s_mov_b32 s43, 3178496
    buffer_load_dwordx4 v62, s[44:47], s43 offen lds
    s_add_u32 m0, s42, 106496
    s_mov_b32 s43, 3407872
    buffer_load_dwordx4 v62, s[44:47], s43 offen lds
    s_add_u32 m0, s42, 107520
    s_mov_b32 s43, 3440640
    buffer_load_dwordx4 v62, s[44:47], s43 offen lds
    v_and_b32 v101, 15, v60
    v_lshrrev_b32 v102, 4, v60
    v_mov_b32 v0, 0x4444
    v_mov_b32 v103, 0xeeee
    v_and_b32 v104, 2, v101
    v_cmp_ne_u32 vcc, 0, v104
    s_nop 1
    v_cndmask_b32 v0, v0, v103, vcc
    v_lshrrev_b32 v103, 2, v101
    v_cmp_eq_u32 vcc, v103, v102
    v_and_b32 v104, 1, v101
    v_lshlrev_b32 v104, 4, v104
    v_mov_b32 v105, 0x3f80
    v_lshlrev_b32 v104, v104, v105
    v_cndmask_b32 v4, 0, v104, vcc
    v_mov_b32 v5, v4
    v_lshlrev_b32 v1, 4, v60
    s_lshl_b32 s40, s21, 11
    s_add_u32 s40, s40, 32768
    v_add_u32 v2, s40, v1
    v_add_u32 v18, 0x10000, v2
    v_lshrrev_b32 v103, 3, v60
    v_lshlrev_b32 v106, 8, v103
    s_lshl_b32 s41, s20, 6
    s_and_b32 s40, s21, 1
    s_lshl_b32 s40, s40, 7
    s_xor_b32 s41, s41, s40
    v_xor_b32 v106, s41, v106
    v_mul_u32_u24 v103, 8704, v103
    v_and_b32 v104, 7, v60
    v_lshlrev_b32 v104, 3, v104
    s_mul_i32 s40, s21, 69632
    v_add3_u32 v103, v103, v104, v106
    v_add_u32 v3, s40, v103
    s_lshl_b32 s40, s20, 2
    s_add_u32 s40, s40, s21
    s_mul_i32 s40, s40, 2176
    v_add_u32 v6, s40, v1
    v_and_b32 v103, 1, v101
    v_bfe_u32 v104, v101, 1, 1
    v_lshrrev_b32 v105, 1, v102
    v_and_b32 v106, 1, v102
    v_lshlrev_b32 v107, 4, v103
    v_lshlrev_b32 v108, 5, v104
    v_lshlrev_b32 v109, 2, v105
    v_add3_u32 v107, v107, v108, v109
    v_lshlrev_b32 v108, 3, v106
    s_lshl_b32 s40, s21, 11
    s_lshr_b32 s41, s20, 3
    s_lshl_b32 s41, s41, 9
    s_add_u32 s40, s40, s41
    s_and_b32 s41, s20, 6
    s_lshl_b32 s41, s41, 5
    s_add_u32 s40, s40, s41
    s_and_b32 s41, s20, 1
    s_lshl_b32 s41, s41, 8
    s_add_u32 s40, s40, s41
    v_add3_u32 v7, v107, v108, s40
    v_and_b32 v107, 4, v101
    v_cmp_ne_u32 vcc, 0, v107
    v_mov_b32 v107, 0x7ff00000
    s_nop 0
    v_cndmask_b32 v7, v7, v107, vcc
    v_lshlrev_b32 v107, 10, v103
    v_lshlrev_b32 v108, 2, v104
    v_lshlrev_b32 v109, 3, v105
    v_add3_u32 v59, v107, v108, v109
    v_lshlrev_b32 v108, 4, v106
    s_lshr_b32 s40, s20, 3
    s_lshl_b32 s40, s40, 8
    s_lshl_b32 s41, s21, 6
    s_add_u32 s40, s40, s41
    s_and_b32 s41, s20, 1
    s_lshl_b32 s41, s41, 5
    s_add_u32 s40, s40, s41
    s_and_b32 s41, s20, 6
    s_lshl_b32 s41, s41, 10
    s_add_u32 s40, s40, s41
    v_add3_u32 v59, v59, v108, s40
    s_mul_i32 s40, s21, 4096
    s_mul_i32 s41, s20, 16384
    s_add_u32 s34, s41, s40
    v_add_u32 v16, s34, v1
    v_bfe_u32 v105, v101, 1, 1
    s_lshr_b32 s40, s21, 1
    s_lshl_b32 s40, s40, 10
    s_and_b32 s41, s21, 1
    s_lshl_b32 s41, s41, 5
    s_add_u32 s40, s40, s41
    s_add_u32 s40, s40, 16384
    v_add_u32 v19, s40, v1
    v_add_u32 v107, 18432, v1
    v_cmp_ne_u32 vcc, 0, v105
    s_nop 1
    v_cndmask_b32 v19, v19, v107, vcc
    v_and_b32 v103, 7, v101
    v_mov_b32 v105, 0x3f80
    v_mov_b32 v106, 0x3f800000
    v_cmp_eq_u32 vcc, 0, v103
    s_nop 1
    v_cndmask_b32 v8, 0, v105, vcc
    v_cmp_eq_u32 vcc, 1, v103
    s_nop 1
    v_cndmask_b32 v8, v8, v106, vcc
    v_mov_b32 v12, 0x3f803f80
    v_cmp_eq_u32 vcc, 2, v103
    s_nop 1
    v_cndmask_b32 v9, 0, v105, vcc
    v_cmp_eq_u32 vcc, 3, v103
    s_nop 1
    v_cndmask_b32 v9, v9, v106, vcc
    v_mov_b32 v13, 0x3f803f80
    v_cmp_eq_u32 vcc, 4, v103
    s_nop 1
    v_cndmask_b32 v10, 0, v105, vcc
    v_cmp_eq_u32 vcc, 5, v103
    s_nop 1
    v_cndmask_b32 v10, v10, v106, vcc
    v_mov_b32 v14, 0x3f803f80
    v_cmp_eq_u32 vcc, 6, v103
    s_nop 1
    v_cndmask_b32 v11, 0, v105, vcc
    v_cmp_eq_u32 vcc, 7, v103
    s_nop 1
    v_cndmask_b32 v11, v11, v106, vcc
    v_mov_b32 v15, 0x3f803f80
    v_lshrrev_b32 v53, 2, v1
    v_mov_b64 v[56:57], -1
    v_mov_b64 v[54:55], -1
    s_mov_b32 s40, 1048576
    buffer_store_dword v54, v7, s[8:11], s40 offen sc1
    s_mov_b32 s40, 1056768
    buffer_store_dword v54, v7, s[8:11], s40 offen sc1
    s_mov_b32 s40, 1064960
    buffer_store_dword v54, v7, s[8:11], s40 offen sc1
    s_mov_b32 s40, 1073152
    buffer_store_dword v54, v7, s[8:11], s40 offen sc1
    s_mov_b32 s40, 2097152
    buffer_store_dwordx4 v[54:57], v6, s[8:11], s40 offen offset:0 sc1
    buffer_store_dwordx4 v[54:57], v6, s[8:11], s40 offen offset:1024 sc1
    s_mov_b32 s40, 2621440
    buffer_store_dwordx4 v[54:57], v6, s[8:11], s40 offen offset:0 sc1
    buffer_store_dwordx4 v[54:57], v6, s[8:11], s40 offen offset:1024 sc1
    buffer_load_dword v58, v59, s[12:15], 0 offen
    v_bfe_u32 v48, v60, 2, 2
    v_lshlrev_b32 v48, 11, v48
    v_and_b32 v49, 1, v60
    v_lshlrev_b32 v49, 10, v49
    v_bfe_u32 v50, v60, 1, 1
    v_lshlrev_b32 v50, 2, v50
    v_add3_u32 v48, v48, v49, v50
    v_lshrrev_b32 v49, 5, v60
    v_lshlrev_b32 v49, 8, v49
    v_bfe_u32 v50, v60, 4, 1
    v_lshlrev_b32 v50, 5, v50
    v_add3_u32 v48, v48, v49, v50
    s_lshl_b32 s40, s21, 6
    buffer_load_dword v40, v48, s[12:15], s40 offen offset:0
    buffer_load_dword v41, v48, s[12:15], s40 offen offset:8
    buffer_load_dword v42, v48, s[12:15], s40 offen offset:16
    buffer_load_dword v43, v48, s[12:15], s40 offen offset:24
    buffer_load_dword v78, v48, s[12:15], s40 offen offset:512
    buffer_load_dword v79, v48, s[12:15], s40 offen offset:520
    buffer_load_dword v54, v48, s[12:15], s40 offen offset:528
    buffer_load_dword v55, v48, s[12:15], s40 offen offset:536
    s_waitcnt vmcnt(41) lgkmcnt(0)
    s_barrier
    s_add_u32 m0, s42, 114688
    s_mov_b32 s43, 3670016
    buffer_load_dwordx4 v62, s[44:47], s43 offen lds
    s_add_u32 m0, s42, 115712
    s_mov_b32 s43, 3702784
    buffer_load_dwordx4 v62, s[44:47], s43 offen lds
    s_add_u32 m0, s42, 122880
    s_mov_b32 s43, 3932160
    buffer_load_dwordx4 v62, s[44:47], s43 offen lds
    s_add_u32 m0, s42, 123904
    s_mov_b32 s43, 3964928
    buffer_load_dwordx4 v62, s[44:47], s43 offen lds
    ds_read_b64_tr_b16 a[0:1], v66 offset:0
    ds_read_b64_tr_b16 a[2:3], v66 offset:1024
    ds_read_b64_tr_b16 a[8:9], v67 offset:0
    ds_read_b64_tr_b16 a[10:11], v67 offset:1024
    ds_read_b64_tr_b16 a[32:33], v66 offset:8192
    ds_read_b64_tr_b16 a[34:35], v66 offset:9216
    ds_read_b64_tr_b16 a[40:41], v67 offset:8192
    ds_read_b64_tr_b16 a[42:43], v67 offset:9216
    s_waitcnt vmcnt(41) lgkmcnt(0)
    s_barrier
    s_add_u32 m0, s42, 0
    s_mov_b32 s43, 0
    buffer_load_dwordx4 v62, s[48:51], s43 offen lds
    s_add_u32 m0, s42, 1024
    s_mov_b32 s43, 32768
    buffer_load_dwordx4 v62, s[48:51], s43 offen lds
    s_add_u32 m0, s42, 8192
    s_mov_b32 s43, 262144
    buffer_load_dwordx4 v62, s[48:51], s43 offen lds
    s_add_u32 m0, s42, 9216
    s_mov_b32 s43, 294912
    buffer_load_dwordx4 v62, s[48:51], s43 offen lds
    ds_read_b64_tr_b16 a[64:65], v66 offset:16384
    ds_read_b64_tr_b16 a[66:67], v66 offset:17408
    ds_read_b64_tr_b16 a[72:73], v67 offset:16384
    ds_read_b64_tr_b16 a[74:75], v67 offset:17408
    ds_read_b64_tr_b16 a[96:97], v66 offset:24576
    ds_read_b64_tr_b16 a[98:99], v66 offset:25600
    ds_read_b64_tr_b16 a[104:105], v67 offset:24576
    ds_read_b64_tr_b16 a[106:107], v67 offset:25600
    s_waitcnt vmcnt(41) lgkmcnt(0)
    s_barrier
    s_add_u32 m0, s42, 16384
    s_mov_b32 s43, 524288
    buffer_load_dwordx4 v62, s[48:51], s43 offen lds
    s_add_u32 m0, s42, 17408
    s_mov_b32 s43, 557056
    buffer_load_dwordx4 v62, s[48:51], s43 offen lds
    s_add_u32 m0, s42, 24576
    s_mov_b32 s43, 786432
    buffer_load_dwordx4 v62, s[48:51], s43 offen lds
    s_add_u32 m0, s42, 25600
    s_mov_b32 s43, 819200
    buffer_load_dwordx4 v62, s[48:51], s43 offen lds
    ds_read_b64_tr_b16 a[4:5], v66 offset:32768
    ds_read_b64_tr_b16 a[6:7], v66 offset:33792
    ds_read_b64_tr_b16 a[12:13], v67 offset:32768
    ds_read_b64_tr_b16 a[14:15], v67 offset:33792
    ds_read_b64_tr_b16 a[36:37], v66 offset:40960
    ds_read_b64_tr_b16 a[38:39], v66 offset:41984
    ds_read_b64_tr_b16 a[44:45], v67 offset:40960
    ds_read_b64_tr_b16 a[46:47], v67 offset:41984
    s_waitcnt vmcnt(41) lgkmcnt(0)
    s_barrier
    s_add_u32 m0, s42, 32768
    s_mov_b32 s43, 1048576
    buffer_load_dwordx4 v62, s[48:51], s43 offen lds
    s_add_u32 m0, s42, 33792
    s_mov_b32 s43, 1081344
    buffer_load_dwordx4 v62, s[48:51], s43 offen lds
    s_add_u32 m0, s42, 40960
    s_mov_b32 s43, 1310720
    buffer_load_dwordx4 v62, s[48:51], s43 offen lds
    s_add_u32 m0, s42, 41984
    s_mov_b32 s43, 1343488
    buffer_load_dwordx4 v62, s[48:51], s43 offen lds
    ds_read_b64_tr_b16 a[68:69], v66 offset:49152
    ds_read_b64_tr_b16 a[70:71], v66 offset:50176
    ds_read_b64_tr_b16 a[76:77], v67 offset:49152
    ds_read_b64_tr_b16 a[78:79], v67 offset:50176
    ds_read_b64_tr_b16 a[100:101], v66 offset:57344
    ds_read_b64_tr_b16 a[102:103], v66 offset:58368
    ds_read_b64_tr_b16 a[108:109], v67 offset:57344
    ds_read_b64_tr_b16 a[110:111], v67 offset:58368
    s_waitcnt vmcnt(41) lgkmcnt(0)
    s_barrier
    s_add_u32 m0, s42, 49152
    s_mov_b32 s43, 1572864
    buffer_load_dwordx4 v62, s[48:51], s43 offen lds
    s_add_u32 m0, s42, 50176
    s_mov_b32 s43, 1605632
    buffer_load_dwordx4 v62, s[48:51], s43 offen lds
    s_add_u32 m0, s42, 57344
    s_mov_b32 s43, 1835008
    buffer_load_dwordx4 v62, s[48:51], s43 offen lds
    s_add_u32 m0, s42, 58368
    s_mov_b32 s43, 1867776
    buffer_load_dwordx4 v62, s[48:51], s43 offen lds
    ds_read_b64_tr_b16 a[16:17], v73 offset:0
    ds_read_b64_tr_b16 a[18:19], v73 offset:1024
    ds_read_b64_tr_b16 a[24:25], v74 offset:0
    ds_read_b64_tr_b16 a[26:27], v74 offset:1024
    ds_read_b64_tr_b16 a[48:49], v73 offset:8192
    ds_read_b64_tr_b16 a[50:51], v73 offset:9216
    ds_read_b64_tr_b16 a[56:57], v74 offset:8192
    ds_read_b64_tr_b16 a[58:59], v74 offset:9216
    s_getpc_b64 s[60:61]
m_t_pc:
    s_sub_u32 s60, s60, m_t_pc-KSTART
    s_subb_u32 s61, s61, 0
    s_and_b32 s61, s61, 0xffff
    s_mov_b32 s62, KEND-KSTART
    s_mov_b32 s63, 0x20000
    s_lshl_b32 s40, s21, 12
    s_add_u32 s40, s40, m_t_code-KSTART
    buffer_load_dwordx4 v[44:47], v1, s[60:63], s40 offen offset:0
    buffer_load_dwordx4 v[44:47], v1, s[60:63], s40 offen offset:1024
    buffer_load_dwordx4 v[44:47], v1, s[60:63], s40 offen offset:2048
    buffer_load_dwordx4 v[44:47], v1, s[60:63], s40 offen offset:3072
    s_add_u32 s40, s40, 16384
    buffer_load_dwordx4 v[44:47], v1, s[60:63], s40 offen
    s_waitcnt vmcnt(41) lgkmcnt(0)
    s_barrier
    s_add_u32 m0, s42, 65536
    s_mov_b32 s43, 2097152
    buffer_load_dwordx4 v62, s[48:51], s43 offen lds
    s_add_u32 m0, s42, 66560
    s_mov_b32 s43, 2129920
    buffer_load_dwordx4 v62, s[48:51], s43 offen lds
    s_add_u32 m0, s42, 73728
    s_mov_b32 s43, 2359296
    buffer_load_dwordx4 v62, s[48:51], s43 offen lds
    s_add_u32 m0, s42, 74752
    s_mov_b32 s43, 2392064
    buffer_load_dwordx4 v62, s[48:51], s43 offen lds
    ds_read_b64_tr_b16 a[80:81], v73 offset:16384
    ds_read_b64_tr_b16 a[82:83], v73 offset:17408
    ds_read_b64_tr_b16 a[88:89], v74 offset:16384
    ds_read_b64_tr_b16 a[90:91], v74 offset:17408
    ds_read_b64_tr_b16 a[112:113], v73 offset:24576
    ds_read_b64_tr_b16 a[114:115], v73 offset:25600
    ds_read_b64_tr_b16 a[120:121], v74 offset:24576
    ds_read_b64_tr_b16 a[122:123], v74 offset:25600
    s_waitcnt vmcnt(41) lgkmcnt(0)
    s_barrier
    s_add_u32 m0, s42, 81920
    s_mov_b32 s43, 2621440
    buffer_load_dwordx4 v62, s[48:51], s43 offen lds
    s_add_u32 m0, s42, 82944
    s_mov_b32 s43, 2654208
    buffer_load_dwordx4 v62, s[48:51], s43 offen lds
    s_add_u32 m0, s42, 90112
    s_mov_b32 s43, 2883584
    buffer_load_dwordx4 v62, s[48:51], s43 offen lds
    s_add_u32 m0, s42, 91136
    s_mov_b32 s43, 2916352
    buffer_load_dwordx4 v62, s[48:51], s43 offen lds
    ds_read_b64_tr_b16 a[20:21], v73 offset:32768
    ds_read_b64_tr_b16 a[22:23], v73 offset:33792
    ds_read_b64_tr_b16 a[28:29], v74 offset:32768
    ds_read_b64_tr_b16 a[30:31], v74 offset:33792
    ds_read_b64_tr_b16 a[52:53], v73 offset:40960
    ds_read_b64_tr_b16 a[54:55], v73 offset:41984
    ds_read_b64_tr_b16 a[60:61], v74 offset:40960
    ds_read_b64_tr_b16 a[62:63], v74 offset:41984
    s_waitcnt vmcnt(24) lgkmcnt(0)
    s_barrier
    s_add_u32 m0, s42, 98304
    s_mov_b32 s43, 3145728
    buffer_load_dwordx4 v62, s[48:51], s43 offen lds
    s_add_u32 m0, s42, 99328
    s_mov_b32 s43, 3178496
    buffer_load_dwordx4 v62, s[48:51], s43 offen lds
    s_add_u32 m0, s42, 106496
    s_mov_b32 s43, 3407872
    buffer_load_dwordx4 v62, s[48:51], s43 offen lds
    s_add_u32 m0, s42, 107520
    s_mov_b32 s43, 3440640
    buffer_load_dwordx4 v62, s[48:51], s43 offen lds
    ds_read_b64_tr_b16 a[84:85], v73 offset:49152
    ds_read_b64_tr_b16 a[86:87], v73 offset:50176
    ds_read_b64_tr_b16 a[92:93], v74 offset:49152
    ds_read_b64_tr_b16 a[94:95], v74 offset:50176
    ds_read_b64_tr_b16 a[116:117], v73 offset:57344
    ds_read_b64_tr_b16 a[118:119], v73 offset:58368
    ds_read_b64_tr_b16 a[124:125], v74 offset:57344
    ds_read_b64_tr_b16 a[126:127], v74 offset:58368
    s_waitcnt vmcnt(24) lgkmcnt(0)
    s_barrier
    s_add_u32 m0, s42, 114688
    s_mov_b32 s43, 3670016
    buffer_load_dwordx4 v62, s[48:51], s43 offen lds
    s_add_u32 m0, s42, 115712
    s_mov_b32 s43, 3702784
    buffer_load_dwordx4 v62, s[48:51], s43 offen lds
    s_add_u32 m0, s42, 122880
    s_mov_b32 s43, 3932160
    buffer_load_dwordx4 v62, s[48:51], s43 offen lds
    s_add_u32 m0, s42, 123904
    s_mov_b32 s43, 3964928
    buffer_load_dwordx4 v62, s[48:51], s43 offen lds
    ds_read_b64_tr_b16 a[128:129], v66 offset:0
    ds_read_b64_tr_b16 a[130:131], v66 offset:1024
    ds_read_b64_tr_b16 a[136:137], v67 offset:0
    ds_read_b64_tr_b16 a[138:139], v67 offset:1024
    ds_read_b64_tr_b16 a[160:161], v66 offset:8192
    ds_read_b64_tr_b16 a[162:163], v66 offset:9216
    ds_read_b64_tr_b16 a[168:169], v67 offset:8192
    ds_read_b64_tr_b16 a[170:171], v67 offset:9216
    s_cmp_lg_u32 s21, 0
    s_cbranch_scc1 TA_72
    v_mov_b32 v56, s38
    s_mov_b64 exec, 1
    buffer_atomic_add v56, off, s[16:19], 0 offset:4 sc0
    s_mov_b64 exec, -1
TA_72:
    s_waitcnt vmcnt(24) lgkmcnt(0)
    s_barrier
    s_add_u32 m0, s42, 0
    s_mov_b32 s43, 0
    buffer_load_dwordx4 v62, s[52:55], s43 offen lds
    s_add_u32 m0, s42, 1024
    s_mov_b32 s43, 32768
    buffer_load_dwordx4 v62, s[52:55], s43 offen lds
    s_add_u32 m0, s42, 8192
    s_mov_b32 s43, 262144
    buffer_load_dwordx4 v62, s[52:55], s43 offen lds
    s_add_u32 m0, s42, 9216
    s_mov_b32 s43, 294912
    buffer_load_dwordx4 v62, s[52:55], s43 offen lds
    ds_read_b64_tr_b16 a[192:193], v66 offset:16384
    ds_read_b64_tr_b16 a[194:195], v66 offset:17408
    ds_read_b64_tr_b16 a[200:201], v67 offset:16384
    ds_read_b64_tr_b16 a[202:203], v67 offset:17408
    ds_read_b64_tr_b16 a[224:225], v66 offset:24576
    ds_read_b64_tr_b16 a[226:227], v66 offset:25600
    ds_read_b64_tr_b16 a[232:233], v67 offset:24576
    ds_read_b64_tr_b16 a[234:235], v67 offset:25600
    s_waitcnt vmcnt(24) lgkmcnt(0)
    s_barrier
    s_add_u32 m0, s42, 16384
    s_mov_b32 s43, 524288
    buffer_load_dwordx4 v62, s[52:55], s43 offen lds
    s_add_u32 m0, s42, 17408
    s_mov_b32 s43, 557056
    buffer_load_dwordx4 v62, s[52:55], s43 offen lds
    s_add_u32 m0, s42, 24576
    s_mov_b32 s43, 786432
    buffer_load_dwordx4 v62, s[52:55], s43 offen lds
    s_add_u32 m0, s42, 25600
    s_mov_b32 s43, 819200
    buffer_load_dwordx4 v62, s[52:55], s43 offen lds
    ds_read_b64_tr_b16 a[132:133], v66 offset:32768
    ds_read_b64_tr_b16 a[134:135], v66 offset:33792
    ds_read_b64_tr_b16 a[140:141], v67 offset:32768
    ds_read_b64_tr_b16 a[142:143], v67 offset:33792
    ds_read_b64_tr_b16 a[164:165], v66 offset:40960
    ds_read_b64_tr_b16 a[166:167], v66 offset:41984
    ds_read_b64_tr_b16 a[172:173], v67 offset:40960
    ds_read_b64_tr_b16 a[174:175], v67 offset:41984
    s_cmp_lg_u32 s21, 0
    s_cbranch_scc1 TA_73
    v_mov_b32 v57, 1
    s_mov_b64 exec, 1
    buffer_atomic_add v57, off, s[16:19], 0 offset:8 sc0
    s_mov_b64 exec, -1
TA_73:
    s_waitcnt vmcnt(24) lgkmcnt(0)
    s_barrier
    s_add_u32 m0, s42, 32768
    s_mov_b32 s43, 1048576
    buffer_load_dwordx4 v62, s[52:55], s43 offen lds
    s_add_u32 m0, s42, 33792
    s_mov_b32 s43, 1081344
    buffer_load_dwordx4 v62, s[52:55], s43 offen lds
    s_add_u32 m0, s42, 40960
    s_mov_b32 s43, 1310720
    buffer_load_dwordx4 v62, s[52:55], s43 offen lds
    s_add_u32 m0, s42, 41984
    s_mov_b32 s43, 1343488
    buffer_load_dwordx4 v62, s[52:55], s43 offen lds
    ds_read_b64_tr_b16 a[196:197], v66 offset:49152
    ds_read_b64_tr_b16 a[198:199], v66 offset:50176
    ds_read_b64_tr_b16 a[204:205], v67 offset:49152
    ds_read_b64_tr_b16 a[206:207], v67 offset:50176
    ds_read_b64_tr_b16 a[228:229], v66 offset:57344
    ds_read_b64_tr_b16 a[230:231], v66 offset:58368
    ds_read_b64_tr_b16 a[236:237], v67 offset:57344
    ds_read_b64_tr_b16 a[238:239], v67 offset:58368
    s_waitcnt vmcnt(24) lgkmcnt(0)
    s_barrier
    s_add_u32 m0, s42, 49152
    s_mov_b32 s43, 1572864
    buffer_load_dwordx4 v62, s[52:55], s43 offen lds
    s_add_u32 m0, s42, 50176
    s_mov_b32 s43, 1605632
    buffer_load_dwordx4 v62, s[52:55], s43 offen lds
    s_add_u32 m0, s42, 57344
    s_mov_b32 s43, 1835008
    buffer_load_dwordx4 v62, s[52:55], s43 offen lds
    s_add_u32 m0, s42, 58368
    s_mov_b32 s43, 1867776
    buffer_load_dwordx4 v62, s[52:55], s43 offen lds
    ds_read_b64_tr_b16 a[144:145], v73 offset:0
    ds_read_b64_tr_b16 a[146:147], v73 offset:1024
    ds_read_b64_tr_b16 a[152:153], v74 offset:0
    ds_read_b64_tr_b16 a[154:155], v74 offset:1024
    ds_read_b64_tr_b16 a[176:177], v73 offset:8192
    ds_read_b64_tr_b16 a[178:179], v73 offset:9216
    ds_read_b64_tr_b16 a[184:185], v74 offset:8192
    ds_read_b64_tr_b16 a[186:187], v74 offset:9216
    buffer_load_dword v52, v53, s[16:19], 0 offen offset:128 sc1
    s_waitcnt vmcnt(24) lgkmcnt(0)
    s_barrier
    s_add_u32 m0, s42, 65536
    s_mov_b32 s43, 2097152
    buffer_load_dwordx4 v62, s[52:55], s43 offen lds
    s_add_u32 m0, s42, 66560
    s_mov_b32 s43, 2129920
    buffer_load_dwordx4 v62, s[52:55], s43 offen lds
    s_add_u32 m0, s42, 73728
    s_mov_b32 s43, 2359296
    buffer_load_dwordx4 v62, s[52:55], s43 offen lds
    s_add_u32 m0, s42, 74752
    s_mov_b32 s43, 2392064
    buffer_load_dwordx4 v62, s[52:55], s43 offen lds
    ds_read_b64_tr_b16 a[208:209], v73 offset:16384
    ds_read_b64_tr_b16 a[210:211], v73 offset:17408
    ds_read_b64_tr_b16 a[216:217], v74 offset:16384
    ds_read_b64_tr_b16 a[218:219], v74 offset:17408
    ds_read_b64_tr_b16 a[240:241], v73 offset:24576
    ds_read_b64_tr_b16 a[242:243], v73 offset:25600
    ds_read_b64_tr_b16 a[248:249], v74 offset:24576
    ds_read_b64_tr_b16 a[250:251], v74 offset:25600
    s_waitcnt vmcnt(24) lgkmcnt(0)
    s_barrier
    s_add_u32 m0, s42, 81920
    s_mov_b32 s43, 2621440
    buffer_load_dwordx4 v62, s[52:55], s43 offen lds
    s_add_u32 m0, s42, 82944
    s_mov_b32 s43, 2654208
    buffer_load_dwordx4 v62, s[52:55], s43 offen lds
    s_add_u32 m0, s42, 90112
    s_mov_b32 s43, 2883584
    buffer_load_dwordx4 v62, s[52:55], s43 offen lds
    s_add_u32 m0, s42, 91136
    s_mov_b32 s43, 2916352
    buffer_load_dwordx4 v62, s[52:55], s43 offen lds
    ds_read_b64_tr_b16 a[148:149], v73 offset:32768
    ds_read_b64_tr_b16 a[150:151], v73 offset:33792
    ds_read_b64_tr_b16 a[156:157], v74 offset:32768
    ds_read_b64_tr_b16 a[158:159], v74 offset:33792
    ds_read_b64_tr_b16 a[180:181], v73 offset:40960
    ds_read_b64_tr_b16 a[182:183], v73 offset:41984
    ds_read_b64_tr_b16 a[188:189], v74 offset:40960
    ds_read_b64_tr_b16 a[190:191], v74 offset:41984
    s_waitcnt vmcnt(24) lgkmcnt(0)
    s_barrier
    s_add_u32 m0, s42, 98304
    s_mov_b32 s43, 3145728
    buffer_load_dwordx4 v62, s[52:55], s43 offen lds
    s_add_u32 m0, s42, 99328
    s_mov_b32 s43, 3178496
    buffer_load_dwordx4 v62, s[52:55], s43 offen lds
    s_add_u32 m0, s42, 106496
    s_mov_b32 s43, 3407872
    buffer_load_dwordx4 v62, s[52:55], s43 offen lds
    s_add_u32 m0, s42, 107520
    s_mov_b32 s43, 3440640
    buffer_load_dwordx4 v62, s[52:55], s43 offen lds
    ds_read_b64_tr_b16 a[212:213], v73 offset:49152
    ds_read_b64_tr_b16 a[214:215], v73 offset:50176
    ds_read_b64_tr_b16 a[220:221], v74 offset:49152
    ds_read_b64_tr_b16 a[222:223], v74 offset:50176
    ds_read_b64_tr_b16 a[244:245], v73 offset:57344
    ds_read_b64_tr_b16 a[246:247], v73 offset:58368
    ds_read_b64_tr_b16 a[252:253], v74 offset:57344
    ds_read_b64_tr_b16 a[254:255], v74 offset:58368
    s_waitcnt vmcnt(24) lgkmcnt(0)
    s_barrier
    s_add_u32 m0, s42, 114688
    s_mov_b32 s43, 3670016
    buffer_load_dwordx4 v62, s[52:55], s43 offen lds
    s_add_u32 m0, s42, 115712
    s_mov_b32 s43, 3702784
    buffer_load_dwordx4 v62, s[52:55], s43 offen lds
    s_add_u32 m0, s42, 122880
    s_mov_b32 s43, 3932160
    buffer_load_dwordx4 v62, s[52:55], s43 offen lds
    s_add_u32 m0, s42, 123904
    s_mov_b32 s43, 3964928
    buffer_load_dwordx4 v62, s[52:55], s43 offen lds
    ds_read_b64_tr_b16 v[128:129], v66 offset:0
    ds_read_b64_tr_b16 v[130:131], v66 offset:1024
    ds_read_b64_tr_b16 v[136:137], v67 offset:0
    ds_read_b64_tr_b16 v[138:139], v67 offset:1024
    ds_read_b64_tr_b16 v[160:161], v66 offset:8192
    ds_read_b64_tr_b16 v[162:163], v66 offset:9216
    ds_read_b64_tr_b16 v[168:169], v67 offset:8192
    ds_read_b64_tr_b16 v[170:171], v67 offset:9216
    s_cmp_lg_u32 s21, 0
    s_cbranch_scc1 TR_74
    v_readfirstlane_b32 s41, v56
    s_nop 0
    s_add_u32 s41, s41, s38
    s_and_b32 s40, s41, 0xffff
    v_mov_b32 v56, s41
    s_cmp_lg_u32 s40, 32
    s_cbranch_scc1 TR_74
    buffer_store_dword v56, off, s[16:19], 0 offset:132 sc1
TR_74:
    s_waitcnt vmcnt(24) lgkmcnt(0)
    s_barrier
    s_add_u32 m0, s42, 0
    s_mov_b32 s43, 0
    buffer_load_dwordx4 v69, s[56:59], s43 offen lds
    s_add_u32 m0, s42, 1024
    s_mov_b32 s43, 4096
    buffer_load_dwordx4 v69, s[56:59], s43 offen lds
    s_add_u32 m0, s42, 8192
    s_mov_b32 s43, 8192
    buffer_load_dwordx4 v69, s[56:59], s43 offen lds
    s_add_u32 m0, s42, 9216
    s_mov_b32 s43, 12288
    buffer_load_dwordx4 v69, s[56:59], s43 offen lds
    ds_read_b64_tr_b16 v[192:193], v66 offset:16384
    ds_read_b64_tr_b16 v[194:195], v66 offset:17408
    ds_read_b64_tr_b16 v[200:201], v67 offset:16384
    ds_read_b64_tr_b16 v[202:203], v67 offset:17408
    ds_read_b64_tr_b16 v[224:225], v66 offset:24576
    ds_read_b64_tr_b16 v[226:227], v66 offset:25600
    ds_read_b64_tr_b16 v[232:233], v67 offset:24576
    ds_read_b64_tr_b16 v[234:235], v67 offset:25600
    s_waitcnt vmcnt(24) lgkmcnt(0)
    s_barrier
    s_add_u32 m0, s42, 16384
    s_mov_b32 s43, 16384
    buffer_load_dwordx4 v70, s[56:59], s43 offen lds
    s_add_u32 m0, s42, 17408
    s_mov_b32 s43, 20480
    buffer_load_dwordx4 v70, s[56:59], s43 offen lds
    s_add_u32 m0, s42, 24576
    s_mov_b32 s43, 24576
    buffer_load_dwordx4 v70, s[56:59], s43 offen lds
    s_add_u32 m0, s42, 25600
    s_mov_b32 s43, 28672
    buffer_load_dwordx4 v70, s[56:59], s43 offen lds
    ds_read_b64_tr_b16 v[132:133], v66 offset:32768
    ds_read_b64_tr_b16 v[134:135], v66 offset:33792
    ds_read_b64_tr_b16 v[140:141], v67 offset:32768
    ds_read_b64_tr_b16 v[142:143], v67 offset:33792
    ds_read_b64_tr_b16 v[164:165], v66 offset:40960
    ds_read_b64_tr_b16 v[166:167], v66 offset:41984
    ds_read_b64_tr_b16 v[172:173], v67 offset:40960
    ds_read_b64_tr_b16 v[174:175], v67 offset:41984
    s_cmp_lg_u32 s21, 0
    s_cbranch_scc1 TR_75
    v_readfirstlane_b32 s41, v57
    s_nop 0
    s_add_u32 s41, s41, 1
    s_and_b32 s40, s41, 0xffff
    v_mov_b32 v57, s41
    s_cmp_lg_u32 s40, 16
    s_cbranch_scc1 TR_75
    buffer_store_dword v57, off, s[16:19], 0 offset:136 sc1
TR_75:
    s_waitcnt vmcnt(24) lgkmcnt(0)
    s_barrier
    s_add_u32 m0, s42, 32768
    s_mov_b32 s43, 32768
    buffer_load_dwordx4 v71, s[56:59], s43 offen lds
    s_add_u32 m0, s42, 33792
    s_mov_b32 s43, 36864
    buffer_load_dwordx4 v71, s[56:59], s43 offen lds
    s_add_u32 m0, s42, 40960
    s_mov_b32 s43, 40960
    buffer_load_dwordx4 v71, s[56:59], s43 offen lds
    s_add_u32 m0, s42, 41984
    s_mov_b32 s43, 45056
    buffer_load_dwordx4 v71, s[56:59], s43 offen lds
    ds_read_b64_tr_b16 v[196:197], v66 offset:49152
    ds_read_b64_tr_b16 v[198:199], v66 offset:50176
    ds_read_b64_tr_b16 v[204:205], v67 offset:49152
    ds_read_b64_tr_b16 v[206:207], v67 offset:50176
    ds_read_b64_tr_b16 v[228:229], v66 offset:57344
    ds_read_b64_tr_b16 v[230:231], v66 offset:58368
    ds_read_b64_tr_b16 v[236:237], v67 offset:57344
    ds_read_b64_tr_b16 v[238:239], v67 offset:58368
    s_waitcnt vmcnt(24) lgkmcnt(0)
    s_barrier
    s_add_u32 m0, s42, 49152
    s_mov_b32 s43, 49152
    buffer_load_dwordx4 v72, s[56:59], s43 offen lds
    s_add_u32 m0, s42, 50176
    s_mov_b32 s43, 53248
    buffer_load_dwordx4 v72, s[56:59], s43 offen lds
    s_add_u32 m0, s42, 57344
    s_mov_b32 s43, 57344
    buffer_load_dwordx4 v72, s[56:59], s43 offen lds
    s_add_u32 m0, s42, 58368
    s_mov_b32 s43, 61440
    buffer_load_dwordx4 v72, s[56:59], s43 offen lds
    ds_read_b64_tr_b16 v[144:145], v73 offset:0
    ds_read_b64_tr_b16 v[146:147], v73 offset:1024
    ds_read_b64_tr_b16 v[152:153], v74 offset:0
    ds_read_b64_tr_b16 v[154:155], v74 offset:1024
    ds_read_b64_tr_b16 v[176:177], v73 offset:8192
    ds_read_b64_tr_b16 v[178:179], v73 offset:9216
    ds_read_b64_tr_b16 v[184:185], v74 offset:8192
    ds_read_b64_tr_b16 v[186:187], v74 offset:9216
    s_waitcnt vmcnt(24) lgkmcnt(0)
    s_barrier
    s_add_u32 m0, s42, 65536
    s_mov_b32 s43, 65536
    buffer_load_dwordx4 v69, s[56:59], s43 offen lds
    s_add_u32 m0, s42, 66560
    s_mov_b32 s43, 69632
    buffer_load_dwordx4 v69, s[56:59], s43 offen lds
    s_add_u32 m0, s42, 73728
    s_mov_b32 s43, 73728
    buffer_load_dwordx4 v69, s[56:59], s43 offen lds
    s_add_u32 m0, s42, 74752
    s_mov_b32 s43, 77824
    buffer_load_dwordx4 v69, s[56:59], s43 offen lds
    ds_read_b64_tr_b16 v[208:209], v73 offset:16384
    ds_read_b64_tr_b16 v[210:211], v73 offset:17408
    ds_read_b64_tr_b16 v[216:217], v74 offset:16384
    ds_read_b64_tr_b16 v[218:219], v74 offset:17408
    ds_read_b64_tr_b16 v[240:241], v73 offset:24576
    ds_read_b64_tr_b16 v[242:243], v73 offset:25600
    ds_read_b64_tr_b16 v[248:249], v74 offset:24576
    ds_read_b64_tr_b16 v[250:251], v74 offset:25600
    s_waitcnt vmcnt(24) lgkmcnt(0)
    s_barrier
    s_add_u32 m0, s42, 81920
    s_mov_b32 s43, 81920
    buffer_load_dwordx4 v70, s[56:59], s43 offen lds
    s_add_u32 m0, s42, 82944
    s_mov_b32 s43, 86016
    buffer_load_dwordx4 v70, s[56:59], s43 offen lds
    s_add_u32 m0, s42, 90112
    s_mov_b32 s43, 90112
    buffer_load_dwordx4 v70, s[56:59], s43 offen lds
    s_add_u32 m0, s42, 91136
    s_mov_b32 s43, 94208
    buffer_load_dwordx4 v70, s[56:59], s43 offen lds
    ds_read_b64_tr_b16 v[148:149], v73 offset:32768
    ds_read_b64_tr_b16 v[150:151], v73 offset:33792
    ds_read_b64_tr_b16 v[156:157], v74 offset:32768
    ds_read_b64_tr_b16 v[158:159], v74 offset:33792
    ds_read_b64_tr_b16 v[180:181], v73 offset:40960
    ds_read_b64_tr_b16 v[182:183], v73 offset:41984
    ds_read_b64_tr_b16 v[188:189], v74 offset:40960
    ds_read_b64_tr_b16 v[190:191], v74 offset:41984
    s_waitcnt vmcnt(24) lgkmcnt(0)
    s_barrier
    s_add_u32 m0, s42, 98304
    s_mov_b32 s43, 98304
    buffer_load_dwordx4 v71, s[56:59], s43 offen lds
    s_add_u32 m0, s42, 99328
    s_mov_b32 s43, 102400
    buffer_load_dwordx4 v71, s[56:59], s43 offen lds
    s_add_u32 m0, s42, 106496
    s_mov_b32 s43, 106496
    buffer_load_dwordx4 v71, s[56:59], s43 offen lds
    s_add_u32 m0, s42, 107520
    s_mov_b32 s43, 110592
    buffer_load_dwordx4 v71, s[56:59], s43 offen lds
    ds_read_b64_tr_b16 v[212:213], v73 offset:49152
    ds_read_b64_tr_b16 v[214:215], v73 offset:50176
    ds_read_b64_tr_b16 v[220:221], v74 offset:49152
    ds_read_b64_tr_b16 v[222:223], v74 offset:50176
    ds_read_b64_tr_b16 v[244:245], v73 offset:57344
    ds_read_b64_tr_b16 v[246:247], v73 offset:58368
    ds_read_b64_tr_b16 v[252:253], v74 offset:57344
    ds_read_b64_tr_b16 v[254:255], v74 offset:58368
    s_waitcnt lgkmcnt(0)
    s_barrier
    s_add_u32 m0, s42, 114688
    s_mov_b32 s43, 114688
    buffer_load_dwordx4 v72, s[56:59], s43 offen lds
    s_add_u32 m0, s42, 115712
    s_mov_b32 s43, 118784
    buffer_load_dwordx4 v72, s[56:59], s43 offen lds
    s_add_u32 m0, s42, 122880
    s_mov_b32 s43, 122880
    buffer_load_dwordx4 v72, s[56:59], s43 offen lds
    s_add_u32 m0, s42, 123904
    s_mov_b32 s43, 126976
    buffer_load_dwordx4 v72, s[56:59], s43 offen lds
    s_mov_b32 s40, 2097152
    buffer_load_dwordx4 v[44:47], v6, s[8:11], s40 offen offset:0 sc1
    buffer_load_dwordx4 v[44:47], v6, s[8:11], s40 offen offset:1024 sc1
    s_mov_b32 s40, 2621440
    buffer_load_dwordx4 v[44:47], v6, s[8:11], s40 offen offset:0 sc1
    buffer_load_dwordx4 v[44:47], v6, s[8:11], s40 offen offset:1024 sc1
    s_mov_b32 s40, 1048576
    buffer_load_dword v44, v7, s[8:11], s40 offen sc1
    s_mov_b32 s40, 1056768
    buffer_load_dword v44, v7, s[8:11], s40 offen sc1
    s_mov_b32 s40, 1064960
    buffer_load_dword v44, v7, s[8:11], s40 offen sc1
    s_mov_b32 s40, 1073152
    buffer_load_dword v44, v7, s[8:11], s40 offen sc1
    buffer_load_dword v50, v53, s[16:19], 0 offen offset:128 sc1
    buffer_load_dword v51, v53, s[8:11], s32 offen sc1
    v_lshrrev_b32 v63, 4, v60
    v_bfe_u32 v64, v60, 2, 2
    v_and_b32 v65, 3, v60
    v_and_b32 v73, 1, v63
    v_lshlrev_b32 v74, 14, v73
    v_lshrrev_b32 v75, 1, v63
    v_lshlrev_b32 v75, 10, v75
    v_add_u32 v74, v74, v75
    v_and_b32 v75, 1, v64
    v_lshlrev_b32 v77, 8, v75
    v_add_u32 v74, v74, v77
    v_lshrrev_b32 v76, 1, v64
    v_lshlrev_b32 v77, 15, v76
    v_add_u32 v74, v74, v77
    v_lshlrev_b32 v73, 1, v73
    v_lshlrev_b32 v76, 2, v76
    v_or3_b32 v75, v75, v73, v76
    v_lshlrev_b32 v75, 5, v75
    v_lshlrev_b32 v65, 3, v65
    v_add3_u32 v74, v74, v75, v65
    v_add_u32 v74, s42, v74
    v_bfe_u32 v76, v60, 1, 1
    v_lshlrev_b32 v76, 13, v76
    v_lshlrev_b32 v77, 8, v63
    v_bfe_u32 v73, v60, 2, 2
    v_lshlrev_b32 v73, 5, v73
    v_add3_u32 v76, v76, v77, v73
    v_and_b32 v77, 1, v60
    v_lshlrev_b32 v77, 4, v77
    v_add3_u32 v76, v76, v77, s42
    s_waitcnt vmcnt(26)
    v_xor_b32 v75, 0, v74
    ds_read_b64_tr_b16 v[80:81], v75 offset:0
    ds_read_b64_tr_b16 v[82:83], v75 offset:512
    ds_read_b64_tr_b16 v[84:85], v75 offset:8192
    ds_read_b64_tr_b16 v[86:87], v75 offset:8704
    v_xor_b32 v75, 32, v74
    ds_read_b64_tr_b16 v[88:89], v75 offset:0
    ds_read_b64_tr_b16 v[90:91], v75 offset:512
    ds_read_b64_tr_b16 v[92:93], v75 offset:8192
    ds_read_b64_tr_b16 v[94:95], v75 offset:8704
    v_xor_b32 v75, 64, v74
    ds_read_b64_tr_b16 v[96:97], v75 offset:0
    ds_read_b64_tr_b16 v[98:99], v75 offset:512
    ds_read_b64_tr_b16 v[100:101], v75 offset:8192
    ds_read_b64_tr_b16 v[102:103], v75 offset:8704
    v_xor_b32 v75, 96, v74
    ds_read_b64_tr_b16 v[104:105], v75 offset:0
    ds_read_b64_tr_b16 v[106:107], v75 offset:512
    ds_read_b64_tr_b16 v[108:109], v75 offset:8192
    ds_read_b64_tr_b16 v[110:111], v75 offset:8704
    v_xor_b32 v75, 128, v74
    ds_read_b64_tr_b16 v[112:113], v75 offset:0
    ds_read_b64_tr_b16 v[114:115], v75 offset:512
    ds_read_b64_tr_b16 v[116:117], v75 offset:8192
    ds_read_b64_tr_b16 v[118:119], v75 offset:8704
    v_xor_b32 v75, 160, v74
    ds_read_b64_tr_b16 v[120:121], v75 offset:0
    ds_read_b64_tr_b16 v[122:123], v75 offset:512
    ds_read_b64_tr_b16 v[124:125], v75 offset:8192
    ds_read_b64_tr_b16 v[126:127], v75 offset:8704
    v_xor_b32 v75, 192, v74
    ds_read_b64_tr_b16 v[24:25], v75 offset:0
    ds_read_b64_tr_b16 v[26:27], v75 offset:512
    ds_read_b64_tr_b16 v[28:29], v75 offset:8192
    ds_read_b64_tr_b16 v[30:31], v75 offset:8704
    v_xor_b32 v75, 224, v74
    ds_read_b64_tr_b16 v[32:33], v75 offset:0
    ds_read_b64_tr_b16 v[34:35], v75 offset:512
    ds_read_b64_tr_b16 v[36:37], v75 offset:8192
    ds_read_b64_tr_b16 v[38:39], v75 offset:8704
    s_waitcnt lgkmcnt(0)
    ds_write_b128 v76, v[80:83] offset:0
    ds_write_b128 v76, v[84:87] offset:1024
    ds_write_b128 v76, v[88:91] offset:128
    ds_write_b128 v76, v[92:95] offset:1152
    ds_write_b128 v76, v[96:99] offset:16384
    ds_write_b128 v76, v[100:103] offset:17408
    ds_write_b128 v76, v[104:107] offset:16512
    ds_write_b128 v76, v[108:111] offset:17536
    ds_write_b128 v76, v[112:115] offset:32768
    ds_write_b128 v76, v[116:119] offset:33792
    ds_write_b128 v76, v[120:123] offset:32896
    ds_write_b128 v76, v[124:127] offset:33920
    ds_write_b128 v76, v[24:27] offset:49152
    ds_write_b128 v76, v[28:31] offset:50176
    ds_write_b128 v76, v[32:35] offset:49280
    ds_write_b128 v76, v[36:39] offset:50304
    s_waitcnt lgkmcnt(0)
    s_waitcnt vmcnt(10)
    v_add_u32 v74, 0x10000, v74
    v_add_u32 v76, 0x10000, v76
    v_xor_b32 v75, 0, v74
    ds_read_b64_tr_b16 v[80:81], v75 offset:0
    ds_read_b64_tr_b16 v[82:83], v75 offset:512
    ds_read_b64_tr_b16 v[84:85], v75 offset:8192
    ds_read_b64_tr_b16 v[86:87], v75 offset:8704
    v_xor_b32 v75, 32, v74
    ds_read_b64_tr_b16 v[88:89], v75 offset:0
    ds_read_b64_tr_b16 v[90:91], v75 offset:512
    ds_read_b64_tr_b16 v[92:93], v75 offset:8192
    ds_read_b64_tr_b16 v[94:95], v75 offset:8704
    v_xor_b32 v75, 64, v74
    ds_read_b64_tr_b16 v[96:97], v75 offset:0
    ds_read_b64_tr_b16 v[98:99], v75 offset:512
    ds_read_b64_tr_b16 v[100:101], v75 offset:8192
    ds_read_b64_tr_b16 v[102:103], v75 offset:8704
    v_xor_b32 v75, 96, v74
    ds_read_b64_tr_b16 v[104:105], v75 offset:0
    ds_read_b64_tr_b16 v[106:107], v75 offset:512
    ds_read_b64_tr_b16 v[108:109], v75 offset:8192
    ds_read_b64_tr_b16 v[110:111], v75 offset:8704
    v_xor_b32 v75, 128, v74
    ds_read_b64_tr_b16 v[112:113], v75 offset:0
    ds_read_b64_tr_b16 v[114:115], v75 offset:512
    ds_read_b64_tr_b16 v[116:117], v75 offset:8192
    ds_read_b64_tr_b16 v[118:119], v75 offset:8704
    v_xor_b32 v75, 160, v74
    ds_read_b64_tr_b16 v[120:121], v75 offset:0
    ds_read_b64_tr_b16 v[122:123], v75 offset:512
    ds_read_b64_tr_b16 v[124:125], v75 offset:8192
    ds_read_b64_tr_b16 v[126:127], v75 offset:8704
    v_xor_b32 v75, 192, v74
    ds_read_b64_tr_b16 v[24:25], v75 offset:0
    ds_read_b64_tr_b16 v[26:27], v75 offset:512
    ds_read_b64_tr_b16 v[28:29], v75 offset:8192
    ds_read_b64_tr_b16 v[30:31], v75 offset:8704
    v_xor_b32 v75, 224, v74
    ds_read_b64_tr_b16 v[32:33], v75 offset:0
    ds_read_b64_tr_b16 v[34:35], v75 offset:512
    ds_read_b64_tr_b16 v[36:37], v75 offset:8192
    ds_read_b64_tr_b16 v[38:39], v75 offset:8704
    s_waitcnt lgkmcnt(0)
    ds_write_b128 v76, v[80:83] offset:0
    ds_write_b128 v76, v[84:87] offset:1024
    ds_write_b128 v76, v[88:91] offset:128
    ds_write_b128 v76, v[92:95] offset:1152
    ds_write_b128 v76, v[96:99] offset:16384
    ds_write_b128 v76, v[100:103] offset:17408
    ds_write_b128 v76, v[104:107] offset:16512
    ds_write_b128 v76, v[108:111] offset:17536
    ds_write_b128 v76, v[112:115] offset:32768
    ds_write_b128 v76, v[116:119] offset:33792
    ds_write_b128 v76, v[120:123] offset:32896
    ds_write_b128 v76, v[124:127] offset:33920
    ds_write_b128 v76, v[24:27] offset:49152
    ds_write_b128 v76, v[28:31] offset:50176
    ds_write_b128 v76, v[32:35] offset:49280
    ds_write_b128 v76, v[36:39] offset:50304
    s_waitcnt lgkmcnt(0)
    v_readlane_b32 s40, v52, 9
    s_mov_b32 s23, 0
    s_cmp_lg_u32 s40, 0
    s_cbranch_scc1 TC_77
TB_76:
    s_add_u32 s23, s23, 1
    s_cmp_ge_u32 s23, 400000
    s_cbranch_scc1 m_exit
    buffer_load_dword v50, v53, s[16:19], 0 offen offset:128 sc1
    s_waitcnt vmcnt(0)
    buffer_load_dword v51, v53, s[8:11], s32 offen sc1
TC_77:
    s_waitcnt vmcnt(0)
    v_readlane_b32 s41, v50, 1
    v_readlane_b32 s40, v50, 5
    v_readlane_b32 s42, v51, 0
    s_cmp_eq_u32 s41, 0
    s_cbranch_scc1 TB_76
    s_lshr_b32 s7, s41, 16
    s_mov_b32 s30, 0
    s_cmp_eq_u32 s40, 0
    s_cbranch_scc1 TB_76
    s_cmp_eq_u32 s42, 0
    s_cbranch_scc1 TB_76
    s_lshl_b32 s40, s21, 8
    v_add_u32 v53, s40, v53
    ds_write_b32 v53, v51 offset:27648
    v_readlane_b32 s42, v51, 1
    v_lshl_add_u32 v21, v1, 2, s34
    s_mov_b32 m0, 18432
    s_mov_b32 s40, 50855936
    s_cmp_eq_u32 s42, 0
    s_cbranch_scc1 m_t_nw
    buffer_load_dword v21, s[8:11], s40 offen sc1 lds
m_t_nw:
    s_waitcnt lgkmcnt(0)
    s_mov_b32 s25, 1048576
    s_lshl_b32 s26, s21, 11
    s_add_u32 s26, s26, 1048576
    s_mov_b32 s27, 2097152
    s_mov_b32 s28, 2101504
    s_mov_b32 s31, 50331648
    s_mov_b32 s33, 50855936
    s_mov_b32 s24, 0x3e0293ee
    s_mov_b32 s22, 0
    s_lshl_b32 s40, s20, 1
    s_mov_b32 s36, 2621440
    s_mov_b32 s38, 0xcccccccc
    s_mov_b32 s39, 0xcccccccc
    v_mov_b32 v120, v58
    v_lshl_add_u32 v21, v1, 2, s34
    s_add_u32 s33, s33, 524288
    v_mov_b64 v[80:81], 0
    v_mov_b64 v[82:83], 0
    v_mov_b64 v[84:85], 0
    v_mov_b64 v[86:87], 0
    v_mov_b64 v[88:89], 0
    v_mov_b64 v[90:91], 0
    v_mov_b64 v[92:93], 0
    v_mov_b64 v[94:95], 0
    v_mov_b64 v[96:97], 0
    v_mov_b64 v[98:99], 0
    v_mov_b64 v[100:101], 0
    v_mov_b64 v[102:103], 0
    s_cmp_lg_u32 s7, 0
    s_cbranch_scc1 m_t_xsel
    s_cmp_eq_u32 s21, 0
    s_cbranch_scc1 m_t_ent0
    s_cmp_eq_u32 s21, 1
    s_cbranch_scc1 m_t_ent1
    s_cmp_eq_u32 s21, 2
    s_cbranch_scc1 m_t_ent2
    s_branch m_t_ent3
m_t_xsel:
    s_cmp_eq_u32 s21, 0
    s_cbranch_scc1 m_tx_ent0
    s_cmp_eq_u32 s21, 1
    s_cbranch_scc1 m_tx_ent1
    s_cmp_eq_u32 s21, 2
    s_cbranch_scc1 m_tx_ent2
    s_branch m_tx_ent3
m_t_code:
.p2align 8
m_t_loop0:
    v_smfmac_f32_16x16x64_bf16 v[88:91], v[72:75], a[224:231], v0
    v_lshl_add_u32 v21, v1, 3, s34
    v_smfmac_f32_16x16x64_bf16 v[88:91], v[76:79], a[240:247], v0
    s_waitcnt vmcnt(4)
    v_smfmac_f32_16x16x64_bf16 v[92:95], v[72:75], a[232:239], v0
    buffer_store_dwordx4 v[40:43], v6, s[8:11], s36 offen offset:0
    v_cvt_pk_bf16_f32 v120, v80, v81
    v_smfmac_f32_16x16x64_bf16 v[92:95], v[76:79], a[248:255], v0
    v_cvt_pk_bf16_f32 v121, v82, v83
    v_cvt_pk_bf16_f32 v122, v84, v85
    v_cvt_pk_bf16_f32 v123, v86, v87
    v_mfma_f32_16x16x16_bf16 v[104:107], v[120:121], v[4:5], 0
    v_cvt_pk_bf16_f32 v124, v88, v89
    v_cvt_pk_bf16_f32 v125, v90, v91
    v_mfma_f32_16x16x16_bf16 v[108:111], v[122:123], v[4:5], 0
    s_nop 0
    v_cvt_pk_bf16_f32 v126, v92, v93
    v_cvt_pk_bf16_f32 v127, v94, v95
    v_mfma_f32_16x16x16_bf16 v[112:115], v[124:125], v[4:5], 0
    s_mov_b32 m0, 18432
    v_mfma_f32_16x16x16_bf16 v[116:119], v[126:127], v[4:5], 0
    v_cvt_pk_bf16_f32 v120, v104, v105
    v_cvt_pk_bf16_f32 v121, v106, v107
    v_cvt_pk_bf16_f32 v122, v108, v109
    v_cvt_pk_bf16_f32 v123, v110, v111
    s_waitcnt vmcnt(1)
    s_nop 0
    v_mfma_f32_16x16x32_bf16 v[104:107], v[24:27], v[120:123], 0
    v_mfma_f32_16x16x32_bf16 v[108:111], v[28:31], v[120:123], 0
    v_cvt_pk_bf16_f32 v40, v112, v113
    v_cvt_pk_bf16_f32 v41, v114, v115
    v_cvt_pk_bf16_f32 v42, v116, v117
    v_cvt_pk_bf16_f32 v43, v118, v119
    s_nop 1
    v_mfma_f32_16x16x32_bf16 v[112:115], v[40:43], v[120:123], 0
    s_nop 0
    v_cndmask_b32 v104, v104, v108, s[38:39]
    v_cndmask_b32 v105, v105, v109, s[38:39]
    v_cndmask_b32 v106, v106, v110, s[38:39]
    v_cndmask_b32 v107, v107, v111, s[38:39]
    ds_write_b128 v1, v[104:107] offset:0
    v_mov_b64 v[40:41], -1
    v_mov_b64 v[42:43], -1
    ds_write_b64 v1, v[112:113] offset:2048
    v_smfmac_f32_16x16x64_bf16 v[100:103], v[52:55], v[152:159], v0
    buffer_store_dwordx4 v[40:43], v6, s[8:11], s36 offen offset:1024
    s_lshl_b32 s29, s22, 13
    s_add_u32 s29, s29, 131072
    buffer_store_dword v23, v7, s[8:11], s29 offen sc1
    s_cmp_ge_i32 s22, s30
    v_smfmac_f32_16x16x64_bf16 v[96:99], v[56:59], v[160:167], v0
    s_cbranch_scc1 SL_78
SB_79:
    s_mov_b32 exec_hi, 0
    buffer_load_dword v21, s[8:11], s33 offen sc1 lds
    s_mov_b32 exec_hi, -1
    v_smfmac_f32_16x16x64_bf16 v[100:103], v[56:59], v[168:175], v0
    v_smfmac_f32_16x16x64_bf16 v[96:99], v[60:63], v[176:183], v0
    s_waitcnt lgkmcnt(0)
    s_barrier
    ds_read_b128 v[80:83], v1 offset:4096
    ds_read_b128 v[84:87], v1 offset:8192
    ds_read_b128 v[108:111], v1 offset:12288
    v_smfmac_f32_16x16x64_bf16 v[100:103], v[60:63], v[184:191], v0
    ds_read_b64 v[114:115], v1 offset:6144
    ds_read_b64 v[116:117], v1 offset:10240
    ds_read_b64 v[118:119], v1 offset:14336
    v_smfmac_f32_16x16x64_bf16 v[96:99], v[64:67], v[192:199], v0
    ds_read_b128 v[88:91], v18 offset:0
    v_smfmac_f32_16x16x64_bf16 v[100:103], v[64:67], v[200:207], v0
    ds_read_b128 v[92:95], v18 offset:1024
    v_smfmac_f32_16x16x64_bf16 v[96:99], v[68:71], v[208:215], v0
    ds_read_b128 v[24:27], v18 offset:8192
    s_add_u32 s33, s33, 524288
    s_waitcnt lgkmcnt(7)
    v_pk_add_f32 v[80:81], v[80:81], v[84:85]
    v_pk_add_f32 v[82:83], v[82:83], v[86:87]
    s_waitcnt lgkmcnt(6)
    v_pk_add_f32 v[104:105], v[104:105], v[108:109]
    v_pk_add_f32 v[106:107], v[106:107], v[110:111]
    v_pk_add_f32 v[80:81], v[80:81], v[104:105]
    v_pk_add_f32 v[82:83], v[82:83], v[106:107]
    s_waitcnt lgkmcnt(3)
    v_pk_add_f32 v[112:113], v[112:113], v[114:115]
    v_pk_add_f32 v[116:117], v[116:117], v[118:119]
    v_max3_f32 v22, v80, v81, v82
    v_pk_add_f32 v[112:113], v[112:113], v[116:117]
    v_max3_f32 v22, v22, v83, v112
    v_max_f32 v22, v22, v113
    v_smfmac_f32_16x16x64_bf16 v[100:103], v[68:71], v[216:223], v0
    ds_read_b128 v[28:31], v18 offset:9216
    v_max_f32_dpp v22, v22, v22 quad_perm:[2,3,0,1] row_mask:0xf bank_mask:0xf
    v_mov_b32 v20, v22
    v_smfmac_f32_16x16x64_bf16 v[96:99], v[72:75], v[224:231], v0
    ds_read_b128 v[120:123], v2 offset:16384
    v_permlane16_swap_b32 v22, v20
    v_max_f32 v22, v22, v20
    v_mov_b32 v20, v22
    v_smfmac_f32_16x16x64_bf16 v[100:103], v[72:75], v[232:239], v0
    ds_read_b128 v[124:127], v2 offset:17408
    v_permlane32_swap_b32 v22, v20
    v_max_f32 v22, v22, v20
    v_mul_f32 v23, s24, v22
    v_smfmac_f32_16x16x64_bf16 v[96:99], v[76:79], v[240:247], v0
    v_fma_f32 v80, v80, s24, -v23
    v_smfmac_f32_16x16x64_bf16 v[100:103], v[76:79], v[248:255], v0
    v_fma_f32 v81, v81, s24, -v23
    v_fma_f32 v82, v82, s24, -v23
    v_fma_f32 v83, v83, s24, -v23
    v_fma_f32 v112, v112, s24, -v23
    v_fma_f32 v113, v113, s24, -v23
    v_exp_f32 v80, v80
    v_exp_f32 v81, v81
    v_exp_f32 v82, v82
    v_exp_f32 v83, v83
    v_exp_f32 v112, v112
    v_exp_f32 v113, v113
    v_cvt_pk_bf16_f32 v84, v80, v81
    v_cvt_pk_bf16_f32 v85, v82, v83
    v_cvt_pk_bf16_f32 v114, v112, v113
    v_mov_b32_dpp v86, v84 quad_perm:[2,3,0,1] row_mask:0xf bank_mask:0xf
    v_mov_b32_dpp v87, v85 quad_perm:[2,3,0,1] row_mask:0xf bank_mask:0xf
    v_cvt_pk_bf16_f32 v115, v112, v113
    v_cvt_pk_bf16_f32 v116, v112, v113
    v_mfma_f32_16x16x32_bf16 v[40:43], v[12:15], v[84:87], 0
    v_mov_b32 v117, 0
    v_cvt_pk_bf16_f32 v44, v96, v97
    v_mfma_f32_16x16x32_bf16 v[104:107], v[32:35], v[84:87], 0
    v_cvt_pk_bf16_f32 v45, v98, v99
    v_cvt_pk_bf16_f32 v46, v100, v101
    v_mfma_f32_16x16x16_bf16 v[40:43], v[12:13], v[116:117], v[40:43]
    v_cvt_pk_bf16_f32 v47, v102, v103
    ds_read_b128 v[64:67], v2 offset:0
    v_mfma_f32_16x16x32_bf16 v[108:111], v[36:39], v[84:87], 0
    ds_read_b128 v[68:71], v2 offset:1024
    ds_read_b128 v[72:75], v2 offset:8192
    v_mfma_f32_16x16x16_bf16 v[104:107], v[44:45], v[114:115], v[104:107]
    ds_read_b128 v[76:79], v2 offset:9216
    ds_read_b128 v[96:99], v2 offset:24576
    v_mfma_f32_16x16x16_bf16 v[108:111], v[46:47], v[114:115], v[108:111]
    v_rcp_f32 v20, v40
    ds_read_b128 v[100:103], v2 offset:25600
    v_mov_b64 v[62:63], 0
    v_mov_b64 v[60:61], 0
    v_mov_b64 v[58:59], 0
    v_mov_b64 v[56:57], 0
    v_mov_b64 v[54:55], 0
    v_mov_b64 v[52:53], 0
    v_mov_b64 v[50:51], 0
    v_mov_b64 v[48:49], 0
    v_mov_b64 v[40:41], -1
    v_mov_b64 v[42:43], -1
    v_pk_mul_f32 v[104:105], v[104:105], v[20:21] op_sel_hi:[1,0]
    v_pk_mul_f32 v[106:107], v[106:107], v[20:21] op_sel_hi:[1,0]
    v_pk_mul_f32 v[108:109], v[108:109], v[20:21] op_sel_hi:[1,0]
    v_pk_mul_f32 v[110:111], v[110:111], v[20:21] op_sel_hi:[1,0]
    v_cvt_pk_bf16_f32 v116, v104, v105
    v_cvt_pk_bf16_f32 v117, v106, v107
    v_cvt_pk_bf16_f32 v118, v108, v109
    v_cvt_pk_bf16_f32 v119, v110, v111
    ds_write_b128 v19, v[116:119]
    ds_read_b128 v[80:83], v18 offset:16384
    ds_read_b128 v[84:87], v18 offset:17408
    ds_read_b128 v[32:35], v18 offset:24576
    ds_read_b128 v[36:39], v18 offset:25600
    s_add_u32 s29, s25, 24576
    s_and_b32 s29, s29, 1073152
    buffer_store_dword v40, v7, s[8:11], s29 offen
    s_min_u32 s33, s33, 83361792
    s_add_u32 s31, s31, 524288
    s_waitcnt lgkmcnt(4)
    s_barrier
    ds_read_b128 v[104:107], v1 offset:16384
    ds_read_b128 v[108:111], v1 offset:17408
    ds_read_b128 v[112:115], v2 offset:32768
    ds_read_b128 v[116:119], v2 offset:33792
    s_waitcnt lgkmcnt(3)
    v_smfmac_f32_16x16x64_bf16 v[48:51], v[104:107], v[64:71], v0
    v_smfmac_f32_16x16x64_bf16 v[52:55], v[104:107], v[72:79], v0
    v_mov_b64 v[64:65], 0
    v_mov_b64 v[66:67], 0
    s_waitcnt lgkmcnt(2)
    v_smfmac_f32_16x16x64_bf16 v[48:51], v[108:111], v[88:95], v0
    ds_read_b128 v[88:91], v2 offset:40960
    ds_read_b128 v[92:95], v2 offset:41984
    v_mov_b64 v[68:69], 0
    v_smfmac_f32_16x16x64_bf16 v[52:55], v[108:111], v[24:31], v0
    ds_read_b128 v[24:27], v18 offset:32768
    ds_read_b128 v[28:31], v18 offset:33792
    v_mov_b64 v[70:71], 0
    v_smfmac_f32_16x16x64_bf16 v[56:59], v[104:107], v[120:127], v0
    ds_read_b128 v[120:123], v18 offset:40960
    v_mov_b64 v[72:73], 0
    v_smfmac_f32_16x16x64_bf16 v[60:63], v[104:107], v[96:103], v0
    ds_read_b128 v[124:127], v18 offset:41984
    v_add_f32 v48, v48, v50
    v_add_f32 v49, v49, v51
    v_cvt_pk_bf16_f32 v48, v48, v49
    v_smfmac_f32_16x16x64_bf16 v[56:59], v[108:111], v[80:87], v0
    ds_read_b128 v[96:99], v2 offset:49152
    v_add_f32 v52, v52, v54
    v_add_f32 v53, v53, v55
    v_cvt_pk_bf16_f32 v49, v52, v53
    v_smfmac_f32_16x16x64_bf16 v[60:63], v[108:111], v[32:39], v0
    ds_read_b128 v[100:103], v2 offset:50176
    buffer_store_dwordx2 v[48:49], v3, s[8:11], s27 offen offset:0
    v_mov_b64 v[74:75], 0
    v_mov_b64 v[76:77], 0
    v_mov_b64 v[78:79], 0
    s_waitcnt lgkmcnt(8)
    v_smfmac_f32_16x16x64_bf16 v[64:67], v[104:107], v[112:119], v0
    ds_read_b128 v[80:83], v2 offset:57344
    s_waitcnt lgkmcnt(7)
    v_smfmac_f32_16x16x64_bf16 v[68:71], v[104:107], v[88:95], v0
    ds_read_b128 v[84:87], v2 offset:58368
    v_add_f32 v56, v56, v58
    v_add_f32 v57, v57, v59
    v_cvt_pk_bf16_f32 v56, v56, v57
    s_waitcnt lgkmcnt(6)
    v_smfmac_f32_16x16x64_bf16 v[64:67], v[108:111], v[24:31], v0
    ds_read_b128 v[32:35], v18 offset:49152
    v_add_f32 v60, v60, v62
    v_add_f32 v61, v61, v63
    v_cvt_pk_bf16_f32 v57, v60, v61
    s_waitcnt lgkmcnt(5)
    v_smfmac_f32_16x16x64_bf16 v[68:71], v[108:111], v[120:127], v0
    ds_read_b128 v[36:39], v18 offset:50176
    buffer_store_dwordx2 v[56:57], v3, s[8:11], s27 offen offset:2176
    s_waitcnt lgkmcnt(4)
    v_smfmac_f32_16x16x64_bf16 v[72:75], v[104:107], v[96:103], v0
    ds_read_b128 v[112:115], v18 offset:57344
    s_waitcnt lgkmcnt(3)
    v_smfmac_f32_16x16x64_bf16 v[76:79], v[104:107], v[80:87], v0
    ds_read_b128 v[116:119], v18 offset:58368
    v_add_f32 v64, v64, v66
    v_add_f32 v65, v65, v67
    v_cvt_pk_bf16_f32 v64, v64, v65
    s_waitcnt lgkmcnt(2)
    v_smfmac_f32_16x16x64_bf16 v[72:75], v[108:111], v[32:39], v0
    v_add_f32 v68, v68, v70
    v_add_f32 v69, v69, v71
    v_cvt_pk_bf16_f32 v65, v68, v69
    s_waitcnt lgkmcnt(0)
    v_smfmac_f32_16x16x64_bf16 v[76:79], v[108:111], v[112:119], v0
    buffer_store_dwordx2 v[64:65], v3, s[8:11], s28 offen offset:0
    s_nop 1
    v_add_f32 v72, v72, v74
    v_add_f32 v73, v73, v75
    v_cvt_pk_bf16_f32 v72, v72, v73
    s_nop 1
    v_add_f32 v76, v76, v78
    v_add_f32 v77, v77, v79
    v_cvt_pk_bf16_f32 v73, v76, v77
    buffer_store_dwordx2 v[72:73], v3, s[8:11], s28 offen offset:2176
    s_mov_b32 s23, 0
    v_mov_b64 v[80:81], 0
    v_mov_b64 v[82:83], 0
    v_mov_b64 v[84:85], 0
    v_mov_b64 v[86:87], 0
    v_mov_b64 v[88:89], 0
    v_mov_b64 v[90:91], 0
    v_mov_b64 v[92:93], 0
    v_mov_b64 v[94:95], 0
    v_mov_b64 v[96:97], 0
    v_mov_b64 v[98:99], 0
    v_mov_b64 v[100:101], 0
    v_mov_b64 v[102:103], 0
    s_nop 7
    s_nop 7
    buffer_load_dwordx4 v[104:107], v6, s[8:11], s27 offen sc1
    buffer_load_dwordx4 v[108:111], v6, s[8:11], s27 offen offset:1024 sc1
    s_nop 7
    s_nop 7
    s_nop 7
    s_nop 7
    buffer_load_dwordx4 v[104:107], v6, s[8:11], s27 offen sc1
    buffer_load_dwordx4 v[108:111], v6, s[8:11], s27 offen offset:1024 sc1
    s_add_u32 s25, s25, 8192
    s_and_b32 s25, s25, 1073152
    s_add_u32 s26, s25, 0
    s_xor_b32 s29, s27, 524288
    s_add_u32 s28, s29, 4352
    s_add_u32 s22, s22, 1
PA_82:
    s_waitcnt vmcnt(2)
    v_max3_u32 v20, v104, v105, v106
    v_max3_u32 v21, v107, v108, v109
    v_max3_u32 v20, v110, v111, v20
    v_max_u32 v20, v20, v21
    v_cmp_eq_u32 vcc, -1, v20
    v_mfma_f32_16x16x32_bf16 v[120:123], v[104:107], v[8:11], 0
    v_mfma_f32_16x16x32_bf16 v[120:123], v[108:111], v[8:11], v[120:123]
    s_cbranch_vccz PAd_83
    s_mov_b64 exec, vcc
    buffer_load_dwordx4 v[104:107], v6, s[8:11], s27 offen sc1
    buffer_load_dwordx4 v[108:111], v6, s[8:11], s27 offen offset:1024 sc1
    s_mov_b64 exec, -1
    s_waitcnt vmcnt(2)
    v_max3_u32 v20, v104, v105, v106
    v_max3_u32 v21, v107, v108, v109
    v_max3_u32 v20, v110, v111, v20
    v_max_u32 v20, v20, v21
    v_cmp_eq_u32 vcc, -1, v20
    v_mfma_f32_16x16x32_bf16 v[120:123], v[104:107], v[8:11], 0
    v_mfma_f32_16x16x32_bf16 v[120:123], v[108:111], v[8:11], v[120:123]
    s_cbranch_vccz PAd_83
    s_mov_b64 exec, vcc
    buffer_load_dwordx4 v[104:107], v6, s[8:11], s27 offen sc1
    buffer_load_dwordx4 v[108:111], v6, s[8:11], s27 offen offset:1024 sc1
    s_mov_b64 exec, -1
    s_add_u32 s23, s23, 1
    s_cmp_lt_u32 s23, 400000
    s_cbranch_scc1 PA_82
    s_branch m_exit
PAd_83:
    s_cmp_eq_u32 s22, 63
    s_nop 5
    v_permlane32_swap_b32 v120, v121
    v_permlane32_swap_b32 v122, v123
    v_add_f32 v120, v120, v121
    v_add_f32 v122, v122, v123
    s_cbranch_scc1 FN_84
    s_nop 0
    v_permlane16_swap_b32 v120, v122
    v_add_f32 v120, v120, v122
    s_nop 1
    v_mov_b32_dpp v121, v120 row_shl:4 row_mask:0xf bank_mask:0xf
    v_cvt_pk_bf16_f32 v120, v120, v121
    buffer_store_dword v120, v7, s[8:11], s25 offen
    s_mov_b32 s36, s27
    s_mov_b32 s27, s29
    s_nop 7
    s_nop 7
    s_nop 7
    s_nop 7
    s_nop 7
    s_nop 7
    buffer_load_dwordx4 v[48:51], v1, s[8:11], s26 offen offset:0 sc1
    buffer_load_dwordx4 v[52:55], v1, s[8:11], s26 offen offset:1024 sc1
    s_nop 7
    s_nop 7
    s_nop 7
    s_nop 7
    buffer_load_dwordx4 v[48:51], v1, s[8:11], s26 offen offset:0 sc1
    buffer_load_dwordx4 v[52:55], v1, s[8:11], s26 offen offset:1024 sc1
m_t_ent0b:
    s_mov_b32 s23, 0
RL_89:
    s_waitcnt vmcnt(2)
    v_max3_u32 v20, v48, v49, v50
    v_max3_u32 v21, v51, v52, v53
    v_max3_u32 v20, v54, v55, v20
    v_max_u32 v20, v20, v21
    v_cmp_eq_u32 vcc, -1, v20
    ds_write_b128 v1, v[48:51] offset:19456
    ds_write_b128 v1, v[52:55] offset:20480
    s_cbranch_vccz RB_87
    s_mov_b64 exec, vcc
    buffer_load_dwordx4 v[48:51], v1, s[8:11], s26 offen offset:0 sc1
    buffer_load_dwordx4 v[52:55], v1, s[8:11], s26 offen offset:1024 sc1
    s_mov_b64 exec, -1
    s_waitcnt vmcnt(2)
    v_max3_u32 v20, v48, v49, v50
    v_max3_u32 v21, v51, v52, v53
    v_max3_u32 v20, v54, v55, v20
    v_max_u32 v20, v20, v21
    v_cmp_eq_u32 vcc, -1, v20
    ds_write_b128 v1, v[48:51] offset:19456
    ds_write_b128 v1, v[52:55] offset:20480
    s_cbranch_vccz RB_87
    s_mov_b64 exec, vcc
    buffer_load_dwordx4 v[48:51], v1, s[8:11], s26 offen offset:0 sc1
    buffer_load_dwordx4 v[52:55], v1, s[8:11], s26 offen offset:1024 sc1
    s_mov_b64 exec, -1
    s_add_u32 s23, s23, 1
    s_cmp_lt_u32 s23, 400000
    s_cbranch_scc1 RL_89
    s_branch m_exit
RB_87:
    s_waitcnt lgkmcnt(0)
    s_barrier
    ds_read_b128 v[56:59], v1 offset:21504
    ds_read_b128 v[60:63], v1 offset:22528
    v_smfmac_f32_16x16x64_bf16 v[80:83], v[48:51], a[0:7], v0
    v_smfmac_f32_16x16x64_bf16 v[84:87], v[48:51], a[8:15], v0
    v_smfmac_f32_16x16x64_bf16 v[88:91], v[48:51], a[128:135], v0
    v_smfmac_f32_16x16x64_bf16 v[92:95], v[48:51], a[136:143], v0
    v_smfmac_f32_16x16x64_bf16 v[80:83], v[52:55], a[16:23], v0
    v_smfmac_f32_16x16x64_bf16 v[84:87], v[52:55], a[24:31], v0
    v_smfmac_f32_16x16x64_bf16 v[88:91], v[52:55], a[144:151], v0
    v_smfmac_f32_16x16x64_bf16 v[92:95], v[52:55], a[152:159], v0
    s_waitcnt lgkmcnt(0)
    v_smfmac_f32_16x16x64_bf16 v[80:83], v[56:59], a[32:39], v0
    v_smfmac_f32_16x16x64_bf16 v[84:87], v[56:59], a[40:47], v0
    buffer_load_dwordx4 v[24:27], v16, s[8:11], s31 offen offset:0 sc1
    v_smfmac_f32_16x16x64_bf16 v[88:91], v[56:59], a[160:167], v0
    v_smfmac_f32_16x16x64_bf16 v[92:95], v[56:59], a[168:175], v0
    buffer_load_dwordx4 v[28:31], v16, s[8:11], s31 offen offset:1024 sc1
    v_smfmac_f32_16x16x64_bf16 v[80:83], v[60:63], a[48:55], v0
    v_smfmac_f32_16x16x64_bf16 v[84:87], v[60:63], a[56:63], v0
    buffer_load_dwordx4 v[32:35], v16, s[8:11], s31 offen offset:2048 sc1
    v_smfmac_f32_16x16x64_bf16 v[88:91], v[60:63], a[176:183], v0
    v_smfmac_f32_16x16x64_bf16 v[92:95], v[60:63], a[184:191], v0
    buffer_load_dwordx4 v[36:39], v16, s[8:11], s31 offen offset:3072 sc1
JY_91:
    s_barrier
    ds_read_b128 v[64:67], v1 offset:23552
    ds_read_b128 v[68:71], v1 offset:24576
    ds_read_b128 v[72:75], v1 offset:25600
    ds_read_b128 v[76:79], v1 offset:26624
    v_smfmac_f32_16x16x64_bf16 v[96:99], v[48:51], v[128:135], v0
    v_smfmac_f32_16x16x64_bf16 v[100:103], v[48:51], v[136:143], v0
    v_smfmac_f32_16x16x64_bf16 v[96:99], v[52:55], v[144:151], v0
    s_waitcnt lgkmcnt(2)
    v_smfmac_f32_16x16x64_bf16 v[80:83], v[64:67], a[64:71], v0
    v_smfmac_f32_16x16x64_bf16 v[84:87], v[64:67], a[72:79], v0
    v_smfmac_f32_16x16x64_bf16 v[80:83], v[68:71], a[80:87], v0
    v_smfmac_f32_16x16x64_bf16 v[84:87], v[68:71], a[88:95], v0
    v_smfmac_f32_16x16x64_bf16 v[88:91], v[64:67], a[192:199], v0
    v_smfmac_f32_16x16x64_bf16 v[92:95], v[64:67], a[200:207], v0
    v_smfmac_f32_16x16x64_bf16 v[88:91], v[68:71], a[208:215], v0
    v_smfmac_f32_16x16x64_bf16 v[92:95], v[68:71], a[216:223], v0
    v_mov_b32 v23, v120
    s_waitcnt lgkmcnt(0)
    v_smfmac_f32_16x16x64_bf16 v[80:83], v[72:75], a[96:103], v0
    v_smfmac_f32_16x16x64_bf16 v[84:87], v[72:75], a[104:111], v0
    v_smfmac_f32_16x16x64_bf16 v[80:83], v[76:79], a[112:119], v0
    v_smfmac_f32_16x16x64_bf16 v[84:87], v[76:79], a[120:127], v0
    s_branch m_t_loop0
.p2align 8
m_t_loop1:
    v_smfmac_f32_16x16x64_bf16 v[88:91], v[72:75], a[224:231], v0
    v_lshl_add_u32 v21, v1, 3, s34
    v_smfmac_f32_16x16x64_bf16 v[88:91], v[76:79], a[240:247], v0
    s_waitcnt vmcnt(4)
    v_smfmac_f32_16x16x64_bf16 v[92:95], v[72:75], a[232:239], v0
    buffer_store_dwordx4 v[40:43], v6, s[8:11], s36 offen offset:0
    v_cvt_pk_bf16_f32 v120, v80, v81
    v_smfmac_f32_16x16x64_bf16 v[92:95], v[76:79], a[248:255], v0
    v_cvt_pk_bf16_f32 v121, v82, v83
    v_cvt_pk_bf16_f32 v122, v84, v85
    v_cvt_pk_bf16_f32 v123, v86, v87
    v_mfma_f32_16x16x16_bf16 v[104:107], v[120:121], v[4:5], 0
    v_cvt_pk_bf16_f32 v124, v88, v89
    v_cvt_pk_bf16_f32 v125, v90, v91
    v_mfma_f32_16x16x16_bf16 v[108:111], v[122:123], v[4:5], 0
    s_nop 0
    v_cvt_pk_bf16_f32 v126, v92, v93
    v_cvt_pk_bf16_f32 v127, v94, v95
    v_mfma_f32_16x16x16_bf16 v[112:115], v[124:125], v[4:5], 0
    s_mov_b32 m0, 18432
    v_mfma_f32_16x16x16_bf16 v[116:119], v[126:127], v[4:5], 0
    v_cvt_pk_bf16_f32 v120, v104, v105
    v_cvt_pk_bf16_f32 v121, v106, v107
    v_cvt_pk_bf16_f32 v122, v108, v109
    v_cvt_pk_bf16_f32 v123, v110, v111
    s_waitcnt vmcnt(1)
    s_nop 0
    v_mfma_f32_16x16x32_bf16 v[104:107], v[24:27], v[120:123], 0
    v_mfma_f32_16x16x32_bf16 v[108:111], v[28:31], v[120:123], 0
    v_cvt_pk_bf16_f32 v40, v112, v113
    v_cvt_pk_bf16_f32 v41, v114, v115
    v_cvt_pk_bf16_f32 v42, v116, v117
    v_cvt_pk_bf16_f32 v43, v118, v119
    s_nop 1
    v_mfma_f32_16x16x32_bf16 v[112:115], v[40:43], v[120:123], 0
    s_nop 0
    v_cndmask_b32 v104, v104, v108, s[38:39]
    v_cndmask_b32 v105, v105, v109, s[38:39]
    v_cndmask_b32 v106, v106, v110, s[38:39]
    v_cndmask_b32 v107, v107, v111, s[38:39]
    ds_write_b128 v1, v[104:107] offset:4096
    v_mov_b64 v[40:41], -1
    v_mov_b64 v[42:43], -1
    ds_write_b64 v1, v[112:113] offset:6144
    v_smfmac_f32_16x16x64_bf16 v[100:103], v[52:55], v[152:159], v0
    buffer_store_dwordx4 v[40:43], v6, s[8:11], s36 offen offset:1024
    s_lshl_b32 s29, s22, 13
    s_add_u32 s29, s29, 131072
    buffer_store_dword v23, v7, s[8:11], s29 offen sc1
    s_cmp_ge_i32 s22, s30
    v_smfmac_f32_16x16x64_bf16 v[96:99], v[56:59], v[160:167], v0
    s_cbranch_scc1 SL_92
SB_93:
    s_mov_b32 exec_hi, 0
    buffer_load_dword v21, s[8:11], s33 offen sc1 lds
    s_mov_b32 exec_hi, -1
    v_smfmac_f32_16x16x64_bf16 v[100:103], v[56:59], v[168:175], v0
    v_smfmac_f32_16x16x64_bf16 v[96:99], v[60:63], v[176:183], v0
    s_waitcnt lgkmcnt(0)
    s_barrier
    ds_read_b128 v[80:83], v1 offset:0
    ds_read_b128 v[84:87], v1 offset:8192
    ds_read_b128 v[108:111], v1 offset:12288
    v_smfmac_f32_16x16x64_bf16 v[100:103], v[60:63], v[184:191], v0
    ds_read_b64 v[114:115], v1 offset:2048
    ds_read_b64 v[116:117], v1 offset:10240
    ds_read_b64 v[118:119], v1 offset:14336
    v_smfmac_f32_16x16x64_bf16 v[96:99], v[64:67], v[192:199], v0
    ds_read_b128 v[88:91], v18 offset:0
    v_smfmac_f32_16x16x64_bf16 v[100:103], v[64:67], v[200:207], v0
    ds_read_b128 v[92:95], v18 offset:1024
    v_smfmac_f32_16x16x64_bf16 v[96:99], v[68:71], v[208:215], v0
    ds_read_b128 v[24:27], v18 offset:8192
    s_add_u32 s33, s33, 524288
    s_waitcnt lgkmcnt(7)
    v_pk_add_f32 v[80:81], v[80:81], v[84:85]
    v_pk_add_f32 v[82:83], v[82:83], v[86:87]
    s_waitcnt lgkmcnt(6)
    v_pk_add_f32 v[104:105], v[104:105], v[108:109]
    v_pk_add_f32 v[106:107], v[106:107], v[110:111]
    v_pk_add_f32 v[80:81], v[80:81], v[104:105]
    v_pk_add_f32 v[82:83], v[82:83], v[106:107]
    s_waitcnt lgkmcnt(3)
    v_pk_add_f32 v[112:113], v[112:113], v[114:115]
    v_pk_add_f32 v[116:117], v[116:117], v[118:119]
    v_max3_f32 v22, v80, v81, v82
    v_pk_add_f32 v[112:113], v[112:113], v[116:117]
    v_max3_f32 v22, v22, v83, v112
    v_max_f32 v22, v22, v113
    v_smfmac_f32_16x16x64_bf16 v[100:103], v[68:71], v[216:223], v0
    ds_read_b128 v[28:31], v18 offset:9216
    v_max_f32_dpp v22, v22, v22 quad_perm:[2,3,0,1] row_mask:0xf bank_mask:0xf
    v_mov_b32 v20, v22
    v_smfmac_f32_16x16x64_bf16 v[96:99], v[72:75], v[224:231], v0
    ds_read_b128 v[120:123], v2 offset:16384
    v_permlane16_swap_b32 v22, v20
    v_max_f32 v22, v22, v20
    v_mov_b32 v20, v22
    v_smfmac_f32_16x16x64_bf16 v[100:103], v[72:75], v[232:239], v0
    ds_read_b128 v[124:127], v2 offset:17408
    v_permlane32_swap_b32 v22, v20
    v_max_f32 v22, v22, v20
    v_mul_f32 v23, s24, v22
    v_smfmac_f32_16x16x64_bf16 v[96:99], v[76:79], v[240:247], v0
    v_fma_f32 v80, v80, s24, -v23
    v_smfmac_f32_16x16x64_bf16 v[100:103], v[76:79], v[248:255], v0
    v_fma_f32 v81, v81, s24, -v23
    v_fma_f32 v82, v82, s24, -v23
    v_fma_f32 v83, v83, s24, -v23
    v_fma_f32 v112, v112, s24, -v23
    v_fma_f32 v113, v113, s24, -v23
    v_exp_f32 v80, v80
    v_exp_f32 v81, v81
    v_exp_f32 v82, v82
    v_exp_f32 v83, v83
    v_exp_f32 v112, v112
    v_exp_f32 v113, v113
    v_cvt_pk_bf16_f32 v84, v80, v81
    v_cvt_pk_bf16_f32 v85, v82, v83
    v_cvt_pk_bf16_f32 v114, v112, v113
    v_mov_b32_dpp v86, v84 quad_perm:[2,3,0,1] row_mask:0xf bank_mask:0xf
    v_mov_b32_dpp v87, v85 quad_perm:[2,3,0,1] row_mask:0xf bank_mask:0xf
    v_cvt_pk_bf16_f32 v115, v112, v113
    v_cvt_pk_bf16_f32 v116, v112, v113
    v_mfma_f32_16x16x32_bf16 v[40:43], v[12:15], v[84:87], 0
    v_mov_b32 v117, 0
    v_cvt_pk_bf16_f32 v44, v96, v97
    v_mfma_f32_16x16x32_bf16 v[104:107], v[32:35], v[84:87], 0
    v_cvt_pk_bf16_f32 v45, v98, v99
    v_cvt_pk_bf16_f32 v46, v100, v101
    v_mfma_f32_16x16x16_bf16 v[40:43], v[12:13], v[116:117], v[40:43]
    v_cvt_pk_bf16_f32 v47, v102, v103
    ds_read_b128 v[64:67], v2 offset:0
    v_mfma_f32_16x16x32_bf16 v[108:111], v[36:39], v[84:87], 0
    ds_read_b128 v[68:71], v2 offset:1024
    ds_read_b128 v[72:75], v2 offset:8192
    v_mfma_f32_16x16x16_bf16 v[104:107], v[44:45], v[114:115], v[104:107]
    ds_read_b128 v[76:79], v2 offset:9216
    ds_read_b128 v[96:99], v2 offset:24576
    v_mfma_f32_16x16x16_bf16 v[108:111], v[46:47], v[114:115], v[108:111]
    v_rcp_f32 v20, v40
    ds_read_b128 v[100:103], v2 offset:25600
    v_mov_b64 v[62:63], 0
    v_mov_b64 v[60:61], 0
    v_mov_b64 v[58:59], 0
    v_mov_b64 v[56:57], 0
    v_mov_b64 v[54:55], 0
    v_mov_b64 v[52:53], 0
    v_mov_b64 v[50:51], 0
    v_mov_b64 v[48:49], 0
    v_mov_b64 v[40:41], -1
    v_mov_b64 v[42:43], -1
    v_pk_mul_f32 v[104:105], v[104:105], v[20:21] op_sel_hi:[1,0]
    v_pk_mul_f32 v[106:107], v[106:107], v[20:21] op_sel_hi:[1,0]
    v_pk_mul_f32 v[108:109], v[108:109], v[20:21] op_sel_hi:[1,0]
    v_pk_mul_f32 v[110:111], v[110:111], v[20:21] op_sel_hi:[1,0]
    v_cvt_pk_bf16_f32 v116, v104, v105
    v_cvt_pk_bf16_f32 v117, v106, v107
    v_cvt_pk_bf16_f32 v118, v108, v109
    v_cvt_pk_bf16_f32 v119, v110, v111
    ds_write_b128 v19, v[116:119]
    ds_read_b128 v[80:83], v18 offset:16384
    ds_read_b128 v[84:87], v18 offset:17408
    ds_read_b128 v[32:35], v18 offset:24576
    ds_read_b128 v[36:39], v18 offset:25600
    s_add_u32 s29, s25, 24576
    s_and_b32 s29, s29, 1073152
    buffer_store_dword v40, v7, s[8:11], s29 offen
    s_min_u32 s33, s33, 83361792
    s_add_u32 s31, s31, 524288
    s_waitcnt lgkmcnt(4)
    s_barrier
    ds_read_b128 v[104:107], v1 offset:16384
    ds_read_b128 v[108:111], v1 offset:17408
    ds_read_b128 v[112:115], v2 offset:32768
    ds_read_b128 v[116:119], v2 offset:33792
    s_waitcnt lgkmcnt(3)
    v_smfmac_f32_16x16x64_bf16 v[48:51], v[104:107], v[64:71], v0
    v_smfmac_f32_16x16x64_bf16 v[52:55], v[104:107], v[72:79], v0
    v_mov_b64 v[64:65], 0
    v_mov_b64 v[66:67], 0
    s_waitcnt lgkmcnt(2)
    v_smfmac_f32_16x16x64_bf16 v[48:51], v[108:111], v[88:95], v0
    ds_read_b128 v[88:91], v2 offset:40960
    ds_read_b128 v[92:95], v2 offset:41984
    v_mov_b64 v[68:69], 0
    v_smfmac_f32_16x16x64_bf16 v[52:55], v[108:111], v[24:31], v0
    ds_read_b128 v[24:27], v18 offset:32768
    ds_read_b128 v[28:31], v18 offset:33792
    v_mov_b64 v[70:71], 0
    v_smfmac_f32_16x16x64_bf16 v[56:59], v[104:107], v[120:127], v0
    ds_read_b128 v[120:123], v18 offset:40960
    v_mov_b64 v[72:73], 0
    v_smfmac_f32_16x16x64_bf16 v[60:63], v[104:107], v[96:103], v0
    ds_read_b128 v[124:127], v18 offset:41984
    v_add_f32 v48, v48, v50
    v_add_f32 v49, v49, v51
    v_cvt_pk_bf16_f32 v48, v48, v49
    v_smfmac_f32_16x16x64_bf16 v[56:59], v[108:111], v[80:87], v0
    ds_read_b128 v[96:99], v2 offset:49152
    v_add_f32 v52, v52, v54
    v_add_f32 v53, v53, v55
    v_cvt_pk_bf16_f32 v49, v52, v53
    v_smfmac_f32_16x16x64_bf16 v[60:63], v[108:111], v[32:39], v0
    ds_read_b128 v[100:103], v2 offset:50176
    buffer_store_dwordx2 v[48:49], v3, s[8:11], s27 offen offset:0
    v_mov_b64 v[74:75], 0
    v_mov_b64 v[76:77], 0
    v_mov_b64 v[78:79], 0
    s_waitcnt lgkmcnt(8)
    v_smfmac_f32_16x16x64_bf16 v[64:67], v[104:107], v[112:119], v0
    ds_read_b128 v[80:83], v2 offset:57344
    s_waitcnt lgkmcnt(7)
    v_smfmac_f32_16x16x64_bf16 v[68:71], v[104:107], v[88:95], v0
    ds_read_b128 v[84:87], v2 offset:58368
    v_add_f32 v56, v56, v58
    v_add_f32 v57, v57, v59
    v_cvt_pk_bf16_f32 v56, v56, v57
    s_waitcnt lgkmcnt(6)
    v_smfmac_f32_16x16x64_bf16 v[64:67], v[108:111], v[24:31], v0
    ds_read_b128 v[32:35], v18 offset:49152
    v_add_f32 v60, v60, v62
    v_add_f32 v61, v61, v63
    v_cvt_pk_bf16_f32 v57, v60, v61
    s_waitcnt lgkmcnt(5)
    v_smfmac_f32_16x16x64_bf16 v[68:71], v[108:111], v[120:127], v0
    ds_read_b128 v[36:39], v18 offset:50176
    buffer_store_dwordx2 v[56:57], v3, s[8:11], s27 offen offset:2176
    s_waitcnt lgkmcnt(4)
    v_smfmac_f32_16x16x64_bf16 v[72:75], v[104:107], v[96:103], v0
    ds_read_b128 v[112:115], v18 offset:57344
    s_waitcnt lgkmcnt(3)
    v_smfmac_f32_16x16x64_bf16 v[76:79], v[104:107], v[80:87], v0
    ds_read_b128 v[116:119], v18 offset:58368
    v_add_f32 v64, v64, v66
    v_add_f32 v65, v65, v67
    v_cvt_pk_bf16_f32 v64, v64, v65
    s_waitcnt lgkmcnt(2)
    v_smfmac_f32_16x16x64_bf16 v[72:75], v[108:111], v[32:39], v0
    v_add_f32 v68, v68, v70
    v_add_f32 v69, v69, v71
    v_cvt_pk_bf16_f32 v65, v68, v69
    s_waitcnt lgkmcnt(0)
    v_smfmac_f32_16x16x64_bf16 v[76:79], v[108:111], v[112:119], v0
    buffer_store_dwordx2 v[64:65], v3, s[8:11], s28 offen offset:0
    s_nop 1
    v_add_f32 v72, v72, v74
    v_add_f32 v73, v73, v75
    v_cvt_pk_bf16_f32 v72, v72, v73
    s_nop 1
    v_add_f32 v76, v76, v78
    v_add_f32 v77, v77, v79
    v_cvt_pk_bf16_f32 v73, v76, v77
    buffer_store_dwordx2 v[72:73], v3, s[8:11], s28 offen offset:2176
    s_mov_b32 s23, 0
    v_mov_b64 v[80:81], 0
    v_mov_b64 v[82:83], 0
    v_mov_b64 v[84:85], 0
    v_mov_b64 v[86:87], 0
    v_mov_b64 v[88:89], 0
    v_mov_b64 v[90:91], 0
    v_mov_b64 v[92:93], 0
    v_mov_b64 v[94:95], 0
    v_mov_b64 v[96:97], 0
    v_mov_b64 v[98:99], 0
    v_mov_b64 v[100:101], 0
    v_mov_b64 v[102:103], 0
    s_nop 7
    s_nop 7
    s_nop 7
    buffer_load_dwordx4 v[104:107], v6, s[8:11], s27 offen sc1
    buffer_load_dwordx4 v[108:111], v6, s[8:11], s27 offen offset:1024 sc1
    s_nop 7
    s_nop 7
    s_nop 7
    s_nop 7
    buffer_load_dwordx4 v[104:107], v6, s[8:11], s27 offen sc1
    buffer_load_dwordx4 v[108:111], v6, s[8:11], s27 offen offset:1024 sc1
    s_add_u32 s25, s25, 8192
    s_and_b32 s25, s25, 1073152
    s_add_u32 s26, s25, 2048
    s_xor_b32 s29, s27, 524288
    s_add_u32 s28, s29, 4352
    s_add_u32 s22, s22, 1
PA_96:
    s_waitcnt vmcnt(2)
    v_max3_u32 v20, v104, v105, v106
    v_max3_u32 v21, v107, v108, v109
    v_max3_u32 v20, v110, v111, v20
    v_max_u32 v20, v20, v21
    v_cmp_eq_u32 vcc, -1, v20
    v_mfma_f32_16x16x32_bf16 v[120:123], v[104:107], v[8:11], 0
    v_mfma_f32_16x16x32_bf16 v[120:123], v[108:111], v[8:11], v[120:123]
    s_cbranch_vccz PAd_97
    s_mov_b64 exec, vcc
    buffer_load_dwordx4 v[104:107], v6, s[8:11], s27 offen sc1
    buffer_load_dwordx4 v[108:111], v6, s[8:11], s27 offen offset:1024 sc1
    s_mov_b64 exec, -1
    s_waitcnt vmcnt(2)
    v_max3_u32 v20, v104, v105, v106
    v_max3_u32 v21, v107, v108, v109
    v_max3_u32 v20, v110, v111, v20
    v_max_u32 v20, v20, v21
    v_cmp_eq_u32 vcc, -1, v20
    v_mfma_f32_16x16x32_bf16 v[120:123], v[104:107], v[8:11], 0
    v_mfma_f32_16x16x32_bf16 v[120:123], v[108:111], v[8:11], v[120:123]
    s_cbranch_vccz PAd_97
    s_mov_b64 exec, vcc
    buffer_load_dwordx4 v[104:107], v6, s[8:11], s27 offen sc1
    buffer_load_dwordx4 v[108:111], v6, s[8:11], s27 offen offset:1024 sc1
    s_mov_b64 exec, -1
    s_add_u32 s23, s23, 1
    s_cmp_lt_u32 s23, 400000
    s_cbranch_scc1 PA_96
    s_branch m_exit
PAd_97:
    s_cmp_eq_u32 s22, 63
    s_nop 5
    v_permlane32_swap_b32 v120, v121
    v_permlane32_swap_b32 v122, v123
    v_add_f32 v120, v120, v121
    v_add_f32 v122, v122, v123
    s_cbranch_scc1 FN_98
    s_nop 0
    v_permlane16_swap_b32 v120, v122
    v_add_f32 v120, v120, v122
    s_nop 1
    v_mov_b32_dpp v121, v120 row_shl:4 row_mask:0xf bank_mask:0xf
    v_cvt_pk_bf16_f32 v120, v120, v121
    buffer_store_dword v120, v7, s[8:11], s25 offen
    s_mov_b32 s36, s27
    s_mov_b32 s27, s29
    s_nop 7
    s_nop 7
    s_nop 7
    s_nop 7
    s_nop 7
    s_nop 7
    buffer_load_dwordx4 v[56:59], v1, s[8:11], s26 offen offset:0 sc1
    buffer_load_dwordx4 v[60:63], v1, s[8:11], s26 offen offset:1024 sc1
    s_nop 7
    s_nop 7
    s_nop 7
    s_nop 7
    buffer_load_dwordx4 v[56:59], v1, s[8:11], s26 offen offset:0 sc1
    buffer_load_dwordx4 v[60:63], v1, s[8:11], s26 offen offset:1024 sc1
m_t_ent1b:
    s_mov_b32 s23, 0
RL_103:
    s_waitcnt vmcnt(2)
    v_max3_u32 v20, v56, v57, v58
    v_max3_u32 v21, v59, v60, v61
    v_max3_u32 v20, v62, v63, v20
    v_max_u32 v20, v20, v21
    v_cmp_eq_u32 vcc, -1, v20
    ds_write_b128 v1, v[56:59] offset:21504
    ds_write_b128 v1, v[60:63] offset:22528
    s_cbranch_vccz RB_101
    s_mov_b64 exec, vcc
    buffer_load_dwordx4 v[56:59], v1, s[8:11], s26 offen offset:0 sc1
    buffer_load_dwordx4 v[60:63], v1, s[8:11], s26 offen offset:1024 sc1
    s_mov_b64 exec, -1
    s_waitcnt vmcnt(2)
    v_max3_u32 v20, v56, v57, v58
    v_max3_u32 v21, v59, v60, v61
    v_max3_u32 v20, v62, v63, v20
    v_max_u32 v20, v20, v21
    v_cmp_eq_u32 vcc, -1, v20
    ds_write_b128 v1, v[56:59] offset:21504
    ds_write_b128 v1, v[60:63] offset:22528
    s_cbranch_vccz RB_101
    s_mov_b64 exec, vcc
    buffer_load_dwordx4 v[56:59], v1, s[8:11], s26 offen offset:0 sc1
    buffer_load_dwordx4 v[60:63], v1, s[8:11], s26 offen offset:1024 sc1
    s_mov_b64 exec, -1
    s_add_u32 s23, s23, 1
    s_cmp_lt_u32 s23, 400000
    s_cbranch_scc1 RL_103
    s_branch m_exit
RB_101:
    s_waitcnt lgkmcnt(0)
    s_barrier
    ds_read_b128 v[48:51], v1 offset:19456
    ds_read_b128 v[52:55], v1 offset:20480
    v_smfmac_f32_16x16x64_bf16 v[80:83], v[56:59], a[32:39], v0
    v_smfmac_f32_16x16x64_bf16 v[84:87], v[56:59], a[40:47], v0
    v_smfmac_f32_16x16x64_bf16 v[88:91], v[56:59], a[160:167], v0
    v_smfmac_f32_16x16x64_bf16 v[92:95], v[56:59], a[168:175], v0
    v_smfmac_f32_16x16x64_bf16 v[80:83], v[60:63], a[48:55], v0
    v_smfmac_f32_16x16x64_bf16 v[84:87], v[60:63], a[56:63], v0
    v_smfmac_f32_16x16x64_bf16 v[88:91], v[60:63], a[176:183], v0
    v_smfmac_f32_16x16x64_bf16 v[92:95], v[60:63], a[184:191], v0
    s_waitcnt lgkmcnt(0)
    v_smfmac_f32_16x16x64_bf16 v[80:83], v[48:51], a[0:7], v0
    v_smfmac_f32_16x16x64_bf16 v[84:87], v[48:51], a[8:15], v0
    buffer_load_dwordx4 v[24:27], v16, s[8:11], s31 offen offset:0 sc1
    v_smfmac_f32_16x16x64_bf16 v[88:91], v[48:51], a[128:135], v0
    v_smfmac_f32_16x16x64_bf16 v[92:95], v[48:51], a[136:143], v0
    buffer_load_dwordx4 v[28:31], v16, s[8:11], s31 offen offset:1024 sc1
    v_smfmac_f32_16x16x64_bf16 v[80:83], v[52:55], a[16:23], v0
    v_smfmac_f32_16x16x64_bf16 v[84:87], v[52:55], a[24:31], v0
    buffer_load_dwordx4 v[32:35], v16, s[8:11], s31 offen offset:2048 sc1
    v_smfmac_f32_16x16x64_bf16 v[88:91], v[52:55], a[144:151], v0
    v_smfmac_f32_16x16x64_bf16 v[92:95], v[52:55], a[152:159], v0
    buffer_load_dwordx4 v[36:39], v16, s[8:11], s31 offen offset:3072 sc1
JY_105:
    s_barrier
    ds_read_b128 v[64:67], v1 offset:23552
    ds_read_b128 v[68:71], v1 offset:24576
    ds_read_b128 v[72:75], v1 offset:25600
    ds_read_b128 v[76:79], v1 offset:26624
    v_smfmac_f32_16x16x64_bf16 v[96:99], v[48:51], v[128:135], v0
    v_smfmac_f32_16x16x64_bf16 v[100:103], v[48:51], v[136:143], v0
    v_smfmac_f32_16x16x64_bf16 v[96:99], v[52:55], v[144:151], v0
    s_waitcnt lgkmcnt(2)
    v_smfmac_f32_16x16x64_bf16 v[80:83], v[64:67], a[64:71], v0
    v_smfmac_f32_16x16x64_bf16 v[84:87], v[64:67], a[72:79], v0
    v_smfmac_f32_16x16x64_bf16 v[80:83], v[68:71], a[80:87], v0
    v_smfmac_f32_16x16x64_bf16 v[84:87], v[68:71], a[88:95], v0
    v_smfmac_f32_16x16x64_bf16 v[88:91], v[64:67], a[192:199], v0
    v_smfmac_f32_16x16x64_bf16 v[92:95], v[64:67], a[200:207], v0
    v_smfmac_f32_16x16x64_bf16 v[88:91], v[68:71], a[208:215], v0
    v_smfmac_f32_16x16x64_bf16 v[92:95], v[68:71], a[216:223], v0
    v_mov_b32 v23, v120
    s_waitcnt lgkmcnt(0)
    v_smfmac_f32_16x16x64_bf16 v[80:83], v[72:75], a[96:103], v0
    v_smfmac_f32_16x16x64_bf16 v[84:87], v[72:75], a[104:111], v0
    v_smfmac_f32_16x16x64_bf16 v[80:83], v[76:79], a[112:119], v0
    v_smfmac_f32_16x16x64_bf16 v[84:87], v[76:79], a[120:127], v0
    s_branch m_t_loop1
.p2align 8
m_t_loop2:
    v_smfmac_f32_16x16x64_bf16 v[88:91], v[72:75], a[224:231], v0
    v_lshl_add_u32 v21, v1, 3, s34
    v_smfmac_f32_16x16x64_bf16 v[88:91], v[76:79], a[240:247], v0
    s_waitcnt vmcnt(4)
    v_smfmac_f32_16x16x64_bf16 v[92:95], v[72:75], a[232:239], v0
    buffer_store_dwordx4 v[40:43], v6, s[8:11], s36 offen offset:0
    v_cvt_pk_bf16_f32 v120, v80, v81
    v_smfmac_f32_16x16x64_bf16 v[92:95], v[76:79], a[248:255], v0
    v_cvt_pk_bf16_f32 v121, v82, v83
    v_cvt_pk_bf16_f32 v122, v84, v85
    v_cvt_pk_bf16_f32 v123, v86, v87
    v_mfma_f32_16x16x16_bf16 v[104:107], v[120:121], v[4:5], 0
    v_cvt_pk_bf16_f32 v124, v88, v89
    v_cvt_pk_bf16_f32 v125, v90, v91
    v_mfma_f32_16x16x16_bf16 v[108:111], v[122:123], v[4:5], 0
    s_nop 0
    v_cvt_pk_bf16_f32 v126, v92, v93
    v_cvt_pk_bf16_f32 v127, v94, v95
    v_mfma_f32_16x16x16_bf16 v[112:115], v[124:125], v[4:5], 0
    s_mov_b32 m0, 18432
    v_mfma_f32_16x16x16_bf16 v[116:119], v[126:127], v[4:5], 0
    v_cvt_pk_bf16_f32 v120, v104, v105
    v_cvt_pk_bf16_f32 v121, v106, v107
    v_cvt_pk_bf16_f32 v122, v108, v109
    v_cvt_pk_bf16_f32 v123, v110, v111
    s_waitcnt vmcnt(1)
    s_nop 0
    v_mfma_f32_16x16x32_bf16 v[104:107], v[24:27], v[120:123], 0
    v_mfma_f32_16x16x32_bf16 v[108:111], v[28:31], v[120:123], 0
    v_cvt_pk_bf16_f32 v40, v112, v113
    v_cvt_pk_bf16_f32 v41, v114, v115
    v_cvt_pk_bf16_f32 v42, v116, v117
    v_cvt_pk_bf16_f32 v43, v118, v119
    s_nop 1
    v_mfma_f32_16x16x32_bf16 v[112:115], v[40:43], v[120:123], 0
    s_nop 0
    v_cndmask_b32 v104, v104, v108, s[38:39]
    v_cndmask_b32 v105, v105, v109, s[38:39]
    v_cndmask_b32 v106, v106, v110, s[38:39]
    v_cndmask_b32 v107, v107, v111, s[38:39]
    ds_write_b128 v1, v[104:107] offset:8192
    v_mov_b64 v[40:41], -1
    v_mov_b64 v[42:43], -1
    ds_write_b64 v1, v[112:113] offset:10240
    v_smfmac_f32_16x16x64_bf16 v[96:99], v[48:51], v[128:135], v0
    buffer_store_dwordx4 v[40:43], v6, s[8:11], s36 offen offset:1024
    s_lshl_b32 s29, s22, 13
    s_add_u32 s29, s29, 131072
    buffer_store_dword v23, v7, s[8:11], s29 offen sc1
    s_cmp_ge_i32 s22, s30
    v_smfmac_f32_16x16x64_bf16 v[100:103], v[48:51], v[136:143], v0
    s_cbranch_scc1 SL_106
SB_107:
    s_mov_b32 exec_hi, 0
    buffer_load_dword v21, s[8:11], s33 offen sc1 lds
    s_mov_b32 exec_hi, -1
    v_smfmac_f32_16x16x64_bf16 v[96:99], v[52:55], v[144:151], v0
    v_smfmac_f32_16x16x64_bf16 v[100:103], v[52:55], v[152:159], v0
    s_waitcnt lgkmcnt(0)
    s_barrier
    ds_read_b128 v[80:83], v1 offset:0
    ds_read_b128 v[84:87], v1 offset:4096
    ds_read_b128 v[108:111], v1 offset:12288
    v_smfmac_f32_16x16x64_bf16 v[96:99], v[56:59], v[160:167], v0
    ds_read_b64 v[114:115], v1 offset:2048
    ds_read_b64 v[116:117], v1 offset:6144
    ds_read_b64 v[118:119], v1 offset:14336
    v_smfmac_f32_16x16x64_bf16 v[100:103], v[56:59], v[168:175], v0
    ds_read_b128 v[88:91], v18 offset:0
    v_smfmac_f32_16x16x64_bf16 v[96:99], v[60:63], v[176:183], v0
    ds_read_b128 v[92:95], v18 offset:1024
    v_smfmac_f32_16x16x64_bf16 v[100:103], v[60:63], v[184:191], v0
    ds_read_b128 v[24:27], v18 offset:8192
    s_add_u32 s33, s33, 524288
    s_waitcnt lgkmcnt(7)
    v_pk_add_f32 v[80:81], v[80:81], v[84:85]
    v_pk_add_f32 v[82:83], v[82:83], v[86:87]
    s_waitcnt lgkmcnt(6)
    v_pk_add_f32 v[104:105], v[104:105], v[108:109]
    v_pk_add_f32 v[106:107], v[106:107], v[110:111]
    v_pk_add_f32 v[80:81], v[80:81], v[104:105]
    v_pk_add_f32 v[82:83], v[82:83], v[106:107]
    s_waitcnt lgkmcnt(3)
    v_pk_add_f32 v[112:113], v[112:113], v[114:115]
    v_pk_add_f32 v[116:117], v[116:117], v[118:119]
    v_max3_f32 v22, v80, v81, v82
    v_pk_add_f32 v[112:113], v[112:113], v[116:117]
    v_max3_f32 v22, v22, v83, v112
    v_max_f32 v22, v22, v113
    v_smfmac_f32_16x16x64_bf16 v[96:99], v[64:67], v[192:199], v0
    ds_read_b128 v[28:31], v18 offset:9216
    v_max_f32_dpp v22, v22, v22 quad_perm:[2,3,0,1] row_mask:0xf bank_mask:0xf
    v_mov_b32 v20, v22
    v_smfmac_f32_16x16x64_bf16 v[100:103], v[64:67], v[200:207], v0
    ds_read_b128 v[120:123], v2 offset:16384
    v_permlane16_swap_b32 v22, v20
    v_max_f32 v22, v22, v20
    v_mov_b32 v20, v22
    v_smfmac_f32_16x16x64_bf16 v[96:99], v[68:71], v[208:215], v0
    ds_read_b128 v[124:127], v2 offset:17408
    v_permlane32_swap_b32 v22, v20
    v_max_f32 v22, v22, v20
    v_mul_f32 v23, s24, v22
    v_smfmac_f32_16x16x64_bf16 v[100:103], v[68:71], v[216:223], v0
    v_fma_f32 v80, v80, s24, -v23
    v_smfmac_f32_16x16x64_bf16 v[96:99], v[72:75], v[224:231], v0
    v_fma_f32 v81, v81, s24, -v23
    v_smfmac_f32_16x16x64_bf16 v[100:103], v[72:75], v[232:239], v0
    v_fma_f32 v82, v82, s24, -v23
    v_smfmac_f32_16x16x64_bf16 v[96:99], v[76:79], v[240:247], v0
    v_fma_f32 v83, v83, s24, -v23
    v_smfmac_f32_16x16x64_bf16 v[100:103], v[76:79], v[248:255], v0
    v_fma_f32 v112, v112, s24, -v23
    v_fma_f32 v113, v113, s24, -v23
    v_exp_f32 v80, v80
    v_exp_f32 v81, v81
    v_exp_f32 v82, v82
    v_exp_f32 v83, v83
    v_exp_f32 v112, v112
    v_exp_f32 v113, v113
    v_cvt_pk_bf16_f32 v84, v80, v81
    v_cvt_pk_bf16_f32 v85, v82, v83
    v_cvt_pk_bf16_f32 v114, v112, v113
    v_mov_b32_dpp v86, v84 quad_perm:[2,3,0,1] row_mask:0xf bank_mask:0xf
    v_mov_b32_dpp v87, v85 quad_perm:[2,3,0,1] row_mask:0xf bank_mask:0xf
    v_cvt_pk_bf16_f32 v115, v112, v113
    v_cvt_pk_bf16_f32 v116, v112, v113
    v_mfma_f32_16x16x32_bf16 v[40:43], v[12:15], v[84:87], 0
    v_mov_b32 v117, 0
    v_cvt_pk_bf16_f32 v44, v96, v97
    v_mfma_f32_16x16x32_bf16 v[104:107], v[32:35], v[84:87], 0
    v_cvt_pk_bf16_f32 v45, v98, v99
    v_cvt_pk_bf16_f32 v46, v100, v101
    v_mfma_f32_16x16x16_bf16 v[40:43], v[12:13], v[116:117], v[40:43]
    v_cvt_pk_bf16_f32 v47, v102, v103
    ds_read_b128 v[64:67], v2 offset:0
    v_mfma_f32_16x16x32_bf16 v[108:111], v[36:39], v[84:87], 0
    ds_read_b128 v[68:71], v2 offset:1024
    ds_read_b128 v[72:75], v2 offset:8192
    v_mfma_f32_16x16x16_bf16 v[104:107], v[44:45], v[114:115], v[104:107]
    ds_read_b128 v[76:79], v2 offset:9216
    ds_read_b128 v[96:99], v2 offset:24576
    v_mfma_f32_16x16x16_bf16 v[108:111], v[46:47], v[114:115], v[108:111]
    v_rcp_f32 v20, v40
    ds_read_b128 v[100:103], v2 offset:25600
    v_mov_b64 v[62:63], 0
    v_mov_b64 v[60:61], 0
    v_mov_b64 v[58:59], 0
    v_mov_b64 v[56:57], 0
    v_mov_b64 v[54:55], 0
    v_mov_b64 v[52:53], 0
    v_mov_b64 v[50:51], 0
    v_mov_b64 v[48:49], 0
    v_mov_b64 v[40:41], -1
    v_mov_b64 v[42:43], -1
    v_pk_mul_f32 v[104:105], v[104:105], v[20:21] op_sel_hi:[1,0]
    v_pk_mul_f32 v[106:107], v[106:107], v[20:21] op_sel_hi:[1,0]
    v_pk_mul_f32 v[108:109], v[108:109], v[20:21] op_sel_hi:[1,0]
    v_pk_mul_f32 v[110:111], v[110:111], v[20:21] op_sel_hi:[1,0]
    v_cvt_pk_bf16_f32 v116, v104, v105
    v_cvt_pk_bf16_f32 v117, v106, v107
    v_cvt_pk_bf16_f32 v118, v108, v109
    v_cvt_pk_bf16_f32 v119, v110, v111
    ds_write_b128 v19, v[116:119]
    ds_read_b128 v[80:83], v18 offset:16384
    ds_read_b128 v[84:87], v18 offset:17408
    ds_read_b128 v[32:35], v18 offset:24576
    ds_read_b128 v[36:39], v18 offset:25600
    s_add_u32 s29, s25, 24576
    s_and_b32 s29, s29, 1073152
    buffer_store_dword v40, v7, s[8:11], s29 offen
    s_min_u32 s33, s33, 83361792
    s_add_u32 s31, s31, 524288
    s_waitcnt lgkmcnt(4)
    s_barrier
    ds_read_b128 v[104:107], v1 offset:16384
    ds_read_b128 v[108:111], v1 offset:17408
    ds_read_b128 v[112:115], v2 offset:32768
    ds_read_b128 v[116:119], v2 offset:33792
    s_waitcnt lgkmcnt(3)
    v_smfmac_f32_16x16x64_bf16 v[48:51], v[104:107], v[64:71], v0
    v_smfmac_f32_16x16x64_bf16 v[52:55], v[104:107], v[72:79], v0
    v_mov_b64 v[64:65], 0
    v_mov_b64 v[66:67], 0
    s_waitcnt lgkmcnt(2)
    v_smfmac_f32_16x16x64_bf16 v[48:51], v[108:111], v[88:95], v0
    ds_read_b128 v[88:91], v2 offset:40960
    ds_read_b128 v[92:95], v2 offset:41984
    v_mov_b64 v[68:69], 0
    v_smfmac_f32_16x16x64_bf16 v[52:55], v[108:111], v[24:31], v0
    ds_read_b128 v[24:27], v18 offset:32768
    ds_read_b128 v[28:31], v18 offset:33792
    v_mov_b64 v[70:71], 0
    v_smfmac_f32_16x16x64_bf16 v[56:59], v[104:107], v[120:127], v0
    ds_read_b128 v[120:123], v18 offset:40960
    v_mov_b64 v[72:73], 0
    v_smfmac_f32_16x16x64_bf16 v[60:63], v[104:107], v[96:103], v0
    ds_read_b128 v[124:127], v18 offset:41984
    v_add_f32 v48, v48, v50
    v_add_f32 v49, v49, v51
    v_cvt_pk_bf16_f32 v48, v48, v49
    v_smfmac_f32_16x16x64_bf16 v[56:59], v[108:111], v[80:87], v0
    ds_read_b128 v[96:99], v2 offset:49152
    v_add_f32 v52, v52, v54
    v_add_f32 v53, v53, v55
    v_cvt_pk_bf16_f32 v49, v52, v53
    v_smfmac_f32_16x16x64_bf16 v[60:63], v[108:111], v[32:39], v0
    ds_read_b128 v[100:103], v2 offset:50176
    buffer_store_dwordx2 v[48:49], v3, s[8:11], s27 offen offset:0
    v_mov_b64 v[74:75], 0
    v_mov_b64 v[76:77], 0
    v_mov_b64 v[78:79], 0
    s_waitcnt lgkmcnt(8)
    v_smfmac_f32_16x16x64_bf16 v[64:67], v[104:107], v[112:119], v0
    ds_read_b128 v[80:83], v2 offset:57344
    s_waitcnt lgkmcnt(7)
    v_smfmac_f32_16x16x64_bf16 v[68:71], v[104:107], v[88:95], v0
    ds_read_b128 v[84:87], v2 offset:58368
    v_add_f32 v56, v56, v58
    v_add_f32 v57, v57, v59
    v_cvt_pk_bf16_f32 v56, v56, v57
    s_waitcnt lgkmcnt(6)
    v_smfmac_f32_16x16x64_bf16 v[64:67], v[108:111], v[24:31], v0
    ds_read_b128 v[32:35], v18 offset:49152
    v_add_f32 v60, v60, v62
    v_add_f32 v61, v61, v63
    v_cvt_pk_bf16_f32 v57, v60, v61
    s_waitcnt lgkmcnt(5)
    v_smfmac_f32_16x16x64_bf16 v[68:71], v[108:111], v[120:127], v0
    ds_read_b128 v[36:39], v18 offset:50176
    buffer_store_dwordx2 v[56:57], v3, s[8:11], s27 offen offset:2176
    s_waitcnt lgkmcnt(4)
    v_smfmac_f32_16x16x64_bf16 v[72:75], v[104:107], v[96:103], v0
    ds_read_b128 v[112:115], v18 offset:57344
    s_waitcnt lgkmcnt(3)
    v_smfmac_f32_16x16x64_bf16 v[76:79], v[104:107], v[80:87], v0
    ds_read_b128 v[116:119], v18 offset:58368
    v_add_f32 v64, v64, v66
    v_add_f32 v65, v65, v67
    v_cvt_pk_bf16_f32 v64, v64, v65
    s_waitcnt lgkmcnt(2)
    v_smfmac_f32_16x16x64_bf16 v[72:75], v[108:111], v[32:39], v0
    v_add_f32 v68, v68, v70
    v_add_f32 v69, v69, v71
    v_cvt_pk_bf16_f32 v65, v68, v69
    s_waitcnt lgkmcnt(0)
    v_smfmac_f32_16x16x64_bf16 v[76:79], v[108:111], v[112:119], v0
    buffer_store_dwordx2 v[64:65], v3, s[8:11], s28 offen offset:0
    s_nop 1
    v_add_f32 v72, v72, v74
    v_add_f32 v73, v73, v75
    v_cvt_pk_bf16_f32 v72, v72, v73
    s_nop 1
    v_add_f32 v76, v76, v78
    v_add_f32 v77, v77, v79
    v_cvt_pk_bf16_f32 v73, v76, v77
    buffer_store_dwordx2 v[72:73], v3, s[8:11], s28 offen offset:2176
    s_mov_b32 s23, 0
    v_mov_b64 v[80:81], 0
    v_mov_b64 v[82:83], 0
    v_mov_b64 v[84:85], 0
    v_mov_b64 v[86:87], 0
    v_mov_b64 v[88:89], 0
    v_mov_b64 v[90:91], 0
    v_mov_b64 v[92:93], 0
    v_mov_b64 v[94:95], 0
    v_mov_b64 v[96:97], 0
    v_mov_b64 v[98:99], 0
    v_mov_b64 v[100:101], 0
    v_mov_b64 v[102:103], 0
    s_nop 7
    s_nop 7
    s_nop 7
    s_nop 7
    s_nop 7
    buffer_load_dwordx4 v[104:107], v6, s[8:11], s27 offen sc1
    buffer_load_dwordx4 v[108:111], v6, s[8:11], s27 offen offset:1024 sc1
    s_nop 7
    s_nop 7
    s_nop 7
    s_nop 7
    buffer_load_dwordx4 v[104:107], v6, s[8:11], s27 offen sc1
    buffer_load_dwordx4 v[108:111], v6, s[8:11], s27 offen offset:1024 sc1
    s_add_u32 s25, s25, 8192
    s_and_b32 s25, s25, 1073152
    s_add_u32 s26, s25, 4096
    s_xor_b32 s29, s27, 524288
    s_add_u32 s28, s29, 4352
    s_add_u32 s22, s22, 1
PA_110:
    s_waitcnt vmcnt(2)
    v_max3_u32 v20, v104, v105, v106
    v_max3_u32 v21, v107, v108, v109
    v_max3_u32 v20, v110, v111, v20
    v_max_u32 v20, v20, v21
    v_cmp_eq_u32 vcc, -1, v20
    v_mfma_f32_16x16x32_bf16 v[120:123], v[104:107], v[8:11], 0
    v_mfma_f32_16x16x32_bf16 v[120:123], v[108:111], v[8:11], v[120:123]
    s_cbranch_vccz PAd_111
    s_mov_b64 exec, vcc
    buffer_load_dwordx4 v[104:107], v6, s[8:11], s27 offen sc1
    buffer_load_dwordx4 v[108:111], v6, s[8:11], s27 offen offset:1024 sc1
    s_mov_b64 exec, -1
    s_waitcnt vmcnt(2)
    v_max3_u32 v20, v104, v105, v106
    v_max3_u32 v21, v107, v108, v109
    v_max3_u32 v20, v110, v111, v20
    v_max_u32 v20, v20, v21
    v_cmp_eq_u32 vcc, -1, v20
    v_mfma_f32_16x16x32_bf16 v[120:123], v[104:107], v[8:11], 0
    v_mfma_f32_16x16x32_bf16 v[120:123], v[108:111], v[8:11], v[120:123]
    s_cbranch_vccz PAd_111
    s_mov_b64 exec, vcc
    buffer_load_dwordx4 v[104:107], v6, s[8:11], s27 offen sc1
    buffer_load_dwordx4 v[108:111], v6, s[8:11], s27 offen offset:1024 sc1
    s_mov_b64 exec, -1
    s_add_u32 s23, s23, 1
    s_cmp_lt_u32 s23, 400000
    s_cbranch_scc1 PA_110
    s_branch m_exit
PAd_111:
    s_cmp_eq_u32 s22, 63
    s_nop 5
    v_permlane32_swap_b32 v120, v121
    v_permlane32_swap_b32 v122, v123
    v_add_f32 v120, v120, v121
    v_add_f32 v122, v122, v123
    s_cbranch_scc1 FN_112
    s_nop 0
    v_permlane16_swap_b32 v120, v122
    v_add_f32 v120, v120, v122
    s_nop 1
    v_mov_b32_dpp v121, v120 row_shl:4 row_mask:0xf bank_mask:0xf
    v_cvt_pk_bf16_f32 v120, v120, v121
    buffer_store_dword v120, v7, s[8:11], s25 offen
    s_mov_b32 s36, s27
    s_mov_b32 s27, s29
    s_nop 7
    s_nop 7
    s_nop 7
    s_nop 7
    s_nop 7
    s_nop 7
    buffer_load_dwordx4 v[64:67], v1, s[8:11], s26 offen offset:0 sc1
    buffer_load_dwordx4 v[68:71], v1, s[8:11], s26 offen offset:1024 sc1
    s_nop 7
    s_nop 7
    s_nop 7
    s_nop 7
    buffer_load_dwordx4 v[64:67], v1, s[8:11], s26 offen offset:0 sc1
    buffer_load_dwordx4 v[68:71], v1, s[8:11], s26 offen offset:1024 sc1
m_t_ent2b:
    s_barrier
    ds_read_b128 v[48:51], v1 offset:19456
    ds_read_b128 v[52:55], v1 offset:20480
    ds_read_b128 v[56:59], v1 offset:21504
    ds_read_b128 v[60:63], v1 offset:22528
    s_waitcnt lgkmcnt(3)
    v_smfmac_f32_16x16x64_bf16 v[80:83], v[48:51], a[0:7], v0
    v_smfmac_f32_16x16x64_bf16 v[84:87], v[48:51], a[8:15], v0
    v_smfmac_f32_16x16x64_bf16 v[88:91], v[48:51], a[128:135], v0
    v_smfmac_f32_16x16x64_bf16 v[92:95], v[48:51], a[136:143], v0
    s_waitcnt lgkmcnt(2)
    s_waitcnt lgkmcnt(0)
    s_waitcnt vmcnt(0)
    v_max3_u32 v20, v64, v65, v66
    v_smfmac_f32_16x16x64_bf16 v[80:83], v[52:55], a[16:23], v0
    v_max3_u32 v21, v67, v68, v69
    v_smfmac_f32_16x16x64_bf16 v[84:87], v[52:55], a[24:31], v0
    v_max3_u32 v20, v70, v71, v20
    v_smfmac_f32_16x16x64_bf16 v[88:91], v[52:55], a[144:151], v0
    v_max_u32 v20, v20, v21
    v_smfmac_f32_16x16x64_bf16 v[92:95], v[52:55], a[152:159], v0
    v_cmp_eq_u32 vcc, -1, v20
    v_smfmac_f32_16x16x64_bf16 v[80:83], v[56:59], a[32:39], v0
    ds_write_b128 v1, v[64:67] offset:23552
    v_smfmac_f32_16x16x64_bf16 v[84:87], v[56:59], a[40:47], v0
    ds_write_b128 v1, v[68:71] offset:24576
    s_cbranch_vccnz RT_116
RB_117:
    v_smfmac_f32_16x16x64_bf16 v[88:91], v[56:59], a[160:167], v0
    v_smfmac_f32_16x16x64_bf16 v[92:95], v[56:59], a[168:175], v0
    v_smfmac_f32_16x16x64_bf16 v[80:83], v[60:63], a[48:55], v0
    v_smfmac_f32_16x16x64_bf16 v[84:87], v[60:63], a[56:63], v0
    v_smfmac_f32_16x16x64_bf16 v[88:91], v[60:63], a[176:183], v0
    v_smfmac_f32_16x16x64_bf16 v[92:95], v[60:63], a[184:191], v0
    s_waitcnt lgkmcnt(0)
JY_115:
    s_barrier
    ds_read_b128 v[72:75], v1 offset:25600
    ds_read_b128 v[76:79], v1 offset:26624
    v_smfmac_f32_16x16x64_bf16 v[80:83], v[64:67], a[64:71], v0
    buffer_load_dwordx4 v[24:27], v16, s[8:11], s31 offen offset:0 sc1
    v_smfmac_f32_16x16x64_bf16 v[84:87], v[64:67], a[72:79], v0
    v_smfmac_f32_16x16x64_bf16 v[80:83], v[68:71], a[80:87], v0
    buffer_load_dwordx4 v[28:31], v16, s[8:11], s31 offen offset:1024 sc1
    v_smfmac_f32_16x16x64_bf16 v[84:87], v[68:71], a[88:95], v0
    v_smfmac_f32_16x16x64_bf16 v[88:91], v[64:67], a[192:199], v0
    buffer_load_dwordx4 v[32:35], v16, s[8:11], s31 offen offset:2048 sc1
    v_smfmac_f32_16x16x64_bf16 v[92:95], v[64:67], a[200:207], v0
    v_smfmac_f32_16x16x64_bf16 v[88:91], v[68:71], a[208:215], v0
    buffer_load_dwordx4 v[36:39], v16, s[8:11], s31 offen offset:3072 sc1
    v_smfmac_f32_16x16x64_bf16 v[92:95], v[68:71], a[216:223], v0
    v_mov_b32 v23, v120
    s_waitcnt lgkmcnt(0)
    v_smfmac_f32_16x16x64_bf16 v[80:83], v[72:75], a[96:103], v0
    v_smfmac_f32_16x16x64_bf16 v[84:87], v[72:75], a[104:111], v0
    v_smfmac_f32_16x16x64_bf16 v[80:83], v[76:79], a[112:119], v0
    v_smfmac_f32_16x16x64_bf16 v[84:87], v[76:79], a[120:127], v0
    s_branch m_t_loop2
.p2align 8
m_t_loop3:
    v_smfmac_f32_16x16x64_bf16 v[88:91], v[64:67], a[192:199], v0
    v_lshl_add_u32 v21, v1, 3, s34
    v_smfmac_f32_16x16x64_bf16 v[88:91], v[68:71], a[208:215], v0
    s_waitcnt vmcnt(4)
    v_smfmac_f32_16x16x64_bf16 v[92:95], v[64:67], a[200:207], v0
    buffer_store_dwordx4 v[40:43], v6, s[8:11], s36 offen offset:0
    v_cvt_pk_bf16_f32 v120, v80, v81
    v_smfmac_f32_16x16x64_bf16 v[92:95], v[68:71], a[216:223], v0
    v_cvt_pk_bf16_f32 v121, v82, v83
    v_cvt_pk_bf16_f32 v122, v84, v85
    v_cvt_pk_bf16_f32 v123, v86, v87
    v_mfma_f32_16x16x16_bf16 v[104:107], v[120:121], v[4:5], 0
    v_cvt_pk_bf16_f32 v124, v88, v89
    v_cvt_pk_bf16_f32 v125, v90, v91
    v_mfma_f32_16x16x16_bf16 v[108:111], v[122:123], v[4:5], 0
    s_nop 0
    v_cvt_pk_bf16_f32 v126, v92, v93
    v_cvt_pk_bf16_f32 v127, v94, v95
    v_mfma_f32_16x16x16_bf16 v[112:115], v[124:125], v[4:5], 0
    s_mov_b32 m0, 18432
    v_mfma_f32_16x16x16_bf16 v[116:119], v[126:127], v[4:5], 0
    v_cvt_pk_bf16_f32 v120, v104, v105
    v_cvt_pk_bf16_f32 v121, v106, v107
    v_cvt_pk_bf16_f32 v122, v108, v109
    v_cvt_pk_bf16_f32 v123, v110, v111
    s_waitcnt vmcnt(1)
    s_nop 0
    v_mfma_f32_16x16x32_bf16 v[104:107], v[24:27], v[120:123], 0
    v_mfma_f32_16x16x32_bf16 v[108:111], v[28:31], v[120:123], 0
    v_cvt_pk_bf16_f32 v40, v112, v113
    v_cvt_pk_bf16_f32 v41, v114, v115
    v_cvt_pk_bf16_f32 v42, v116, v117
    v_cvt_pk_bf16_f32 v43, v118, v119
    s_nop 1
    v_mfma_f32_16x16x32_bf16 v[112:115], v[40:43], v[120:123], 0
    s_nop 0
    v_cndmask_b32 v104, v104, v108, s[38:39]
    v_cndmask_b32 v105, v105, v109, s[38:39]
    v_cndmask_b32 v106, v106, v110, s[38:39]
    v_cndmask_b32 v107, v107, v111, s[38:39]
    ds_write_b128 v1, v[104:107] offset:12288
    v_mov_b64 v[40:41], -1
    v_mov_b64 v[42:43], -1
    ds_write_b64 v1, v[112:113] offset:14336
    v_smfmac_f32_16x16x64_bf16 v[96:99], v[48:51], v[128:135], v0
    buffer_store_dwordx4 v[40:43], v6, s[8:11], s36 offen offset:1024
    s_lshl_b32 s29, s22, 13
    s_add_u32 s29, s29, 131072
    buffer_store_dword v23, v7, s[8:11], s29 offen sc1
    s_cmp_ge_i32 s22, s30
    v_smfmac_f32_16x16x64_bf16 v[100:103], v[48:51], v[136:143], v0
    s_cbranch_scc1 SL_120
SB_121:
    s_mov_b32 exec_hi, 0
    buffer_load_dword v21, s[8:11], s33 offen sc1 lds
    s_mov_b32 exec_hi, -1
    v_smfmac_f32_16x16x64_bf16 v[96:99], v[52:55], v[144:151], v0
    v_smfmac_f32_16x16x64_bf16 v[100:103], v[52:55], v[152:159], v0
    s_waitcnt lgkmcnt(0)
    s_barrier
    ds_read_b128 v[80:83], v1 offset:0
    ds_read_b128 v[84:87], v1 offset:4096
    ds_read_b128 v[108:111], v1 offset:8192
    v_smfmac_f32_16x16x64_bf16 v[96:99], v[56:59], v[160:167], v0
    ds_read_b64 v[114:115], v1 offset:2048
    ds_read_b64 v[116:117], v1 offset:6144
    ds_read_b64 v[118:119], v1 offset:10240
    v_smfmac_f32_16x16x64_bf16 v[100:103], v[56:59], v[168:175], v0
    ds_read_b128 v[88:91], v18 offset:0
    v_smfmac_f32_16x16x64_bf16 v[96:99], v[60:63], v[176:183], v0
    ds_read_b128 v[92:95], v18 offset:1024
    v_smfmac_f32_16x16x64_bf16 v[100:103], v[60:63], v[184:191], v0
    ds_read_b128 v[24:27], v18 offset:8192
    s_add_u32 s33, s33, 524288
    s_waitcnt lgkmcnt(7)
    v_pk_add_f32 v[80:81], v[80:81], v[84:85]
    v_pk_add_f32 v[82:83], v[82:83], v[86:87]
    s_waitcnt lgkmcnt(6)
    v_pk_add_f32 v[104:105], v[104:105], v[108:109]
    v_pk_add_f32 v[106:107], v[106:107], v[110:111]
    v_pk_add_f32 v[80:81], v[80:81], v[104:105]
    v_pk_add_f32 v[82:83], v[82:83], v[106:107]
    s_waitcnt lgkmcnt(3)
    v_pk_add_f32 v[112:113], v[112:113], v[114:115]
    v_pk_add_f32 v[116:117], v[116:117], v[118:119]
    v_max3_f32 v22, v80, v81, v82
    v_pk_add_f32 v[112:113], v[112:113], v[116:117]
    v_max3_f32 v22, v22, v83, v112
    v_max_f32 v22, v22, v113
    v_smfmac_f32_16x16x64_bf16 v[96:99], v[64:67], v[192:199], v0
    ds_read_b128 v[28:31], v18 offset:9216
    v_max_f32_dpp v22, v22, v22 quad_perm:[2,3,0,1] row_mask:0xf bank_mask:0xf
    v_mov_b32 v20, v22
    v_smfmac_f32_16x16x64_bf16 v[100:103], v[64:67], v[200:207], v0
    ds_read_b128 v[120:123], v2 offset:16384
    v_permlane16_swap_b32 v22, v20
    v_max_f32 v22, v22, v20
    v_mov_b32 v20, v22
    v_smfmac_f32_16x16x64_bf16 v[96:99], v[68:71], v[208:215], v0
    ds_read_b128 v[124:127], v2 offset:17408
    v_permlane32_swap_b32 v22, v20
    v_max_f32 v22, v22, v20
    v_mul_f32 v23, s24, v22
    v_smfmac_f32_16x16x64_bf16 v[100:103], v[68:71], v[216:223], v0
    v_fma_f32 v80, v80, s24, -v23
    v_smfmac_f32_16x16x64_bf16 v[96:99], v[72:75], v[224:231], v0
    v_fma_f32 v81, v81, s24, -v23
    v_smfmac_f32_16x16x64_bf16 v[100:103], v[72:75], v[232:239], v0
    v_fma_f32 v82, v82, s24, -v23
    v_smfmac_f32_16x16x64_bf16 v[96:99], v[76:79], v[240:247], v0
    v_fma_f32 v83, v83, s24, -v23
    v_smfmac_f32_16x16x64_bf16 v[100:103], v[76:79], v[248:255], v0
    v_fma_f32 v112, v112, s24, -v23
    v_fma_f32 v113, v113, s24, -v23
    v_exp_f32 v80, v80
    v_exp_f32 v81, v81
    v_exp_f32 v82, v82
    v_exp_f32 v83, v83
    v_exp_f32 v112, v112
    v_exp_f32 v113, v113
    v_cvt_pk_bf16_f32 v84, v80, v81
    v_cvt_pk_bf16_f32 v85, v82, v83
    v_cvt_pk_bf16_f32 v114, v112, v113
    v_mov_b32_dpp v86, v84 quad_perm:[2,3,0,1] row_mask:0xf bank_mask:0xf
    v_mov_b32_dpp v87, v85 quad_perm:[2,3,0,1] row_mask:0xf bank_mask:0xf
    v_cvt_pk_bf16_f32 v115, v112, v113
    v_cvt_pk_bf16_f32 v116, v112, v113
    v_mfma_f32_16x16x32_bf16 v[40:43], v[12:15], v[84:87], 0
    v_mov_b32 v117, 0
    v_cvt_pk_bf16_f32 v44, v96, v97
    v_mfma_f32_16x16x32_bf16 v[104:107], v[32:35], v[84:87], 0
    v_cvt_pk_bf16_f32 v45, v98, v99
    v_cvt_pk_bf16_f32 v46, v100, v101
    v_mfma_f32_16x16x16_bf16 v[40:43], v[12:13], v[116:117], v[40:43]
    v_cvt_pk_bf16_f32 v47, v102, v103
    ds_read_b128 v[64:67], v2 offset:0
    v_mfma_f32_16x16x32_bf16 v[108:111], v[36:39], v[84:87], 0
    ds_read_b128 v[68:71], v2 offset:1024
    ds_read_b128 v[72:75], v2 offset:8192
    v_mfma_f32_16x16x16_bf16 v[104:107], v[44:45], v[114:115], v[104:107]
    ds_read_b128 v[76:79], v2 offset:9216
    ds_read_b128 v[96:99], v2 offset:24576
    v_mfma_f32_16x16x16_bf16 v[108:111], v[46:47], v[114:115], v[108:111]
    v_rcp_f32 v20, v40
    ds_read_b128 v[100:103], v2 offset:25600
    v_mov_b64 v[62:63], 0
    v_mov_b64 v[60:61], 0
    v_mov_b64 v[58:59], 0
    v_mov_b64 v[56:57], 0
    v_mov_b64 v[54:55], 0
    v_mov_b64 v[52:53], 0
    v_mov_b64 v[50:51], 0
    v_mov_b64 v[48:49], 0
    v_mov_b64 v[40:41], -1
    v_mov_b64 v[42:43], -1
    v_pk_mul_f32 v[104:105], v[104:105], v[20:21] op_sel_hi:[1,0]
    v_pk_mul_f32 v[106:107], v[106:107], v[20:21] op_sel_hi:[1,0]
    v_pk_mul_f32 v[108:109], v[108:109], v[20:21] op_sel_hi:[1,0]
    v_pk_mul_f32 v[110:111], v[110:111], v[20:21] op_sel_hi:[1,0]
    v_cvt_pk_bf16_f32 v116, v104, v105
    v_cvt_pk_bf16_f32 v117, v106, v107
    v_cvt_pk_bf16_f32 v118, v108, v109
    v_cvt_pk_bf16_f32 v119, v110, v111
    ds_write_b128 v19, v[116:119]
    ds_read_b128 v[80:83], v18 offset:16384
    ds_read_b128 v[84:87], v18 offset:17408
    ds_read_b128 v[32:35], v18 offset:24576
    ds_read_b128 v[36:39], v18 offset:25600
    s_add_u32 s29, s25, 24576
    s_and_b32 s29, s29, 1073152
    buffer_store_dword v40, v7, s[8:11], s29 offen
    s_min_u32 s33, s33, 83361792
    s_add_u32 s31, s31, 524288
    s_waitcnt lgkmcnt(4)
    s_barrier
    ds_read_b128 v[104:107], v1 offset:16384
    ds_read_b128 v[108:111], v1 offset:17408
    ds_read_b128 v[112:115], v2 offset:32768
    ds_read_b128 v[116:119], v2 offset:33792
    s_waitcnt lgkmcnt(3)
    v_smfmac_f32_16x16x64_bf16 v[48:51], v[104:107], v[64:71], v0
    v_smfmac_f32_16x16x64_bf16 v[52:55], v[104:107], v[72:79], v0
    v_mov_b64 v[64:65], 0
    v_mov_b64 v[66:67], 0
    s_waitcnt lgkmcnt(2)
    v_smfmac_f32_16x16x64_bf16 v[48:51], v[108:111], v[88:95], v0
    ds_read_b128 v[88:91], v2 offset:40960
    ds_read_b128 v[92:95], v2 offset:41984
    v_mov_b64 v[68:69], 0
    v_smfmac_f32_16x16x64_bf16 v[52:55], v[108:111], v[24:31], v0
    ds_read_b128 v[24:27], v18 offset:32768
    ds_read_b128 v[28:31], v18 offset:33792
    v_mov_b64 v[70:71], 0
    v_smfmac_f32_16x16x64_bf16 v[56:59], v[104:107], v[120:127], v0
    ds_read_b128 v[120:123], v18 offset:40960
    v_mov_b64 v[72:73], 0
    v_smfmac_f32_16x16x64_bf16 v[60:63], v[104:107], v[96:103], v0
    ds_read_b128 v[124:127], v18 offset:41984
    v_add_f32 v48, v48, v50
    v_add_f32 v49, v49, v51
    v_cvt_pk_bf16_f32 v48, v48, v49
    v_smfmac_f32_16x16x64_bf16 v[56:59], v[108:111], v[80:87], v0
    ds_read_b128 v[96:99], v2 offset:49152
    v_add_f32 v52, v52, v54
    v_add_f32 v53, v53, v55
    v_cvt_pk_bf16_f32 v49, v52, v53
    v_smfmac_f32_16x16x64_bf16 v[60:63], v[108:111], v[32:39], v0
    ds_read_b128 v[100:103], v2 offset:50176
    buffer_store_dwordx2 v[48:49], v3, s[8:11], s27 offen offset:0
    v_mov_b64 v[74:75], 0
    v_mov_b64 v[76:77], 0
    v_mov_b64 v[78:79], 0
    s_waitcnt lgkmcnt(8)
    v_smfmac_f32_16x16x64_bf16 v[64:67], v[104:107], v[112:119], v0
    ds_read_b128 v[80:83], v2 offset:57344
    s_waitcnt lgkmcnt(7)
    v_smfmac_f32_16x16x64_bf16 v[68:71], v[104:107], v[88:95], v0
    ds_read_b128 v[84:87], v2 offset:58368
    v_add_f32 v56, v56, v58
    v_add_f32 v57, v57, v59
    v_cvt_pk_bf16_f32 v56, v56, v57
    s_waitcnt lgkmcnt(6)
    v_smfmac_f32_16x16x64_bf16 v[64:67], v[108:111], v[24:31], v0
    ds_read_b128 v[32:35], v18 offset:49152
    v_add_f32 v60, v60, v62
    v_add_f32 v61, v61, v63
    v_cvt_pk_bf16_f32 v57, v60, v61
    s_waitcnt lgkmcnt(5)
    v_smfmac_f32_16x16x64_bf16 v[68:71], v[108:111], v[120:127], v0
    ds_read_b128 v[36:39], v18 offset:50176
    buffer_store_dwordx2 v[56:57], v3, s[8:11], s27 offen offset:2176
    s_waitcnt lgkmcnt(4)
    v_smfmac_f32_16x16x64_bf16 v[72:75], v[104:107], v[96:103], v0
    ds_read_b128 v[112:115], v18 offset:57344
    s_waitcnt lgkmcnt(3)
    v_smfmac_f32_16x16x64_bf16 v[76:79], v[104:107], v[80:87], v0
    ds_read_b128 v[116:119], v18 offset:58368
    v_add_f32 v64, v64, v66
    v_add_f32 v65, v65, v67
    v_cvt_pk_bf16_f32 v64, v64, v65
    s_waitcnt lgkmcnt(2)
    v_smfmac_f32_16x16x64_bf16 v[72:75], v[108:111], v[32:39], v0
    v_add_f32 v68, v68, v70
    v_add_f32 v69, v69, v71
    v_cvt_pk_bf16_f32 v65, v68, v69
    s_waitcnt lgkmcnt(0)
    v_smfmac_f32_16x16x64_bf16 v[76:79], v[108:111], v[112:119], v0
    buffer_store_dwordx2 v[64:65], v3, s[8:11], s28 offen offset:0
    s_nop 1
    v_add_f32 v72, v72, v74
    v_add_f32 v73, v73, v75
    v_cvt_pk_bf16_f32 v72, v72, v73
    s_nop 1
    v_add_f32 v76, v76, v78
    v_add_f32 v77, v77, v79
    v_cvt_pk_bf16_f32 v73, v76, v77
    buffer_store_dwordx2 v[72:73], v3, s[8:11], s28 offen offset:2176
    s_mov_b32 s23, 0
    v_mov_b64 v[80:81], 0
    v_mov_b64 v[82:83], 0
    v_mov_b64 v[84:85], 0
    v_mov_b64 v[86:87], 0
    v_mov_b64 v[88:89], 0
    v_mov_b64 v[90:91], 0
    v_mov_b64 v[92:93], 0
    v_mov_b64 v[94:95], 0
    v_mov_b64 v[96:97], 0
    v_mov_b64 v[98:99], 0
    v_mov_b64 v[100:101], 0
    v_mov_b64 v[102:103], 0
    s_nop 7
    s_nop 7
    s_nop 7
    s_nop 7
    s_nop 7
    s_nop 7
    buffer_load_dwordx4 v[104:107], v6, s[8:11], s27 offen sc1
    buffer_load_dwordx4 v[108:111], v6, s[8:11], s27 offen offset:1024 sc1
    s_nop 7
    s_nop 7
    s_nop 7
    s_nop 7
    buffer_load_dwordx4 v[104:107], v6, s[8:11], s27 offen sc1
    buffer_load_dwordx4 v[108:111], v6, s[8:11], s27 offen offset:1024 sc1
    s_add_u32 s25, s25, 8192
    s_and_b32 s25, s25, 1073152
    s_add_u32 s26, s25, 6144
    s_xor_b32 s29, s27, 524288
    s_add_u32 s28, s29, 4352
    s_add_u32 s22, s22, 1
PA_124:
    s_waitcnt vmcnt(2)
    v_max3_u32 v20, v104, v105, v106
    v_max3_u32 v21, v107, v108, v109
    v_max3_u32 v20, v110, v111, v20
    v_max_u32 v20, v20, v21
    v_cmp_eq_u32 vcc, -1, v20
    v_mfma_f32_16x16x32_bf16 v[120:123], v[104:107], v[8:11], 0
    v_mfma_f32_16x16x32_bf16 v[120:123], v[108:111], v[8:11], v[120:123]
    s_cbranch_vccz PAd_125
    s_mov_b64 exec, vcc
    buffer_load_dwordx4 v[104:107], v6, s[8:11], s27 offen sc1
    buffer_load_dwordx4 v[108:111], v6, s[8:11], s27 offen offset:1024 sc1
    s_mov_b64 exec, -1
    s_waitcnt vmcnt(2)
    v_max3_u32 v20, v104, v105, v106
    v_max3_u32 v21, v107, v108, v109
    v_max3_u32 v20, v110, v111, v20
    v_max_u32 v20, v20, v21
    v_cmp_eq_u32 vcc, -1, v20
    v_mfma_f32_16x16x32_bf16 v[120:123], v[104:107], v[8:11], 0
    v_mfma_f32_16x16x32_bf16 v[120:123], v[108:111], v[8:11], v[120:123]
    s_cbranch_vccz PAd_125
    s_mov_b64 exec, vcc
    buffer_load_dwordx4 v[104:107], v6, s[8:11], s27 offen sc1
    buffer_load_dwordx4 v[108:111], v6, s[8:11], s27 offen offset:1024 sc1
    s_mov_b64 exec, -1
    s_add_u32 s23, s23, 1
    s_cmp_lt_u32 s23, 400000
    s_cbranch_scc1 PA_124
    s_branch m_exit
PAd_125:
    s_cmp_eq_u32 s22, 63
    s_nop 5
    v_permlane32_swap_b32 v120, v121
    v_permlane32_swap_b32 v122, v123
    v_add_f32 v120, v120, v121
    v_add_f32 v122, v122, v123
    s_cbranch_scc1 FN_126
    s_nop 0
    v_permlane16_swap_b32 v120, v122
    v_add_f32 v120, v120, v122
    s_nop 1
    v_mov_b32_dpp v121, v120 row_shl:4 row_mask:0xf bank_mask:0xf
    v_cvt_pk_bf16_f32 v120, v120, v121
    buffer_store_dword v120, v7, s[8:11], s25 offen
    s_mov_b32 s36, s27
    s_mov_b32 s27, s29
    s_nop 7
    s_nop 7
    s_nop 7
    s_nop 7
    s_nop 7
    buffer_load_dwordx4 v[72:75], v1, s[8:11], s26 offen offset:0 sc1
    buffer_load_dwordx4 v[76:79], v1, s[8:11], s26 offen offset:1024 sc1
    s_nop 7
    s_nop 7
    s_nop 7
    s_nop 7
    buffer_load_dwordx4 v[72:75], v1, s[8:11], s26 offen offset:0 sc1
    buffer_load_dwordx4 v[76:79], v1, s[8:11], s26 offen offset:1024 sc1
m_t_ent3b:
    s_barrier
    ds_read_b128 v[48:51], v1 offset:19456
    ds_read_b128 v[52:55], v1 offset:20480
    ds_read_b128 v[56:59], v1 offset:21504
    ds_read_b128 v[60:63], v1 offset:22528
    s_waitcnt lgkmcnt(3)
    v_smfmac_f32_16x16x64_bf16 v[80:83], v[48:51], a[0:7], v0
    v_smfmac_f32_16x16x64_bf16 v[84:87], v[48:51], a[8:15], v0
    v_smfmac_f32_16x16x64_bf16 v[88:91], v[48:51], a[128:135], v0
    v_smfmac_f32_16x16x64_bf16 v[92:95], v[48:51], a[136:143], v0
    s_waitcnt lgkmcnt(2)
    s_waitcnt lgkmcnt(0)
    s_waitcnt vmcnt(2)
    v_max3_u32 v20, v72, v73, v74
    v_smfmac_f32_16x16x64_bf16 v[80:83], v[52:55], a[16:23], v0
    v_max3_u32 v21, v75, v76, v77
    v_smfmac_f32_16x16x64_bf16 v[84:87], v[52:55], a[24:31], v0
    v_max3_u32 v20, v78, v79, v20
    v_smfmac_f32_16x16x64_bf16 v[88:91], v[52:55], a[144:151], v0
    v_max_u32 v20, v20, v21
    v_smfmac_f32_16x16x64_bf16 v[92:95], v[52:55], a[152:159], v0
    v_cmp_eq_u32 vcc, -1, v20
    v_smfmac_f32_16x16x64_bf16 v[80:83], v[56:59], a[32:39], v0
    ds_write_b128 v1, v[72:75] offset:25600
    v_smfmac_f32_16x16x64_bf16 v[84:87], v[56:59], a[40:47], v0
    ds_write_b128 v1, v[76:79] offset:26624
    s_cbranch_vccnz RT_130
RB_131:
    v_smfmac_f32_16x16x64_bf16 v[88:91], v[56:59], a[160:167], v0
    v_smfmac_f32_16x16x64_bf16 v[92:95], v[56:59], a[168:175], v0
    v_smfmac_f32_16x16x64_bf16 v[80:83], v[60:63], a[48:55], v0
    v_smfmac_f32_16x16x64_bf16 v[84:87], v[60:63], a[56:63], v0
    v_smfmac_f32_16x16x64_bf16 v[88:91], v[60:63], a[176:183], v0
    v_smfmac_f32_16x16x64_bf16 v[92:95], v[60:63], a[184:191], v0
    s_waitcnt lgkmcnt(0)
JY_129:
    s_barrier
    ds_read_b128 v[64:67], v1 offset:23552
    ds_read_b128 v[68:71], v1 offset:24576
    v_smfmac_f32_16x16x64_bf16 v[80:83], v[72:75], a[96:103], v0
    buffer_load_dwordx4 v[24:27], v16, s[8:11], s31 offen offset:0 sc1
    v_smfmac_f32_16x16x64_bf16 v[84:87], v[72:75], a[104:111], v0
    v_smfmac_f32_16x16x64_bf16 v[80:83], v[76:79], a[112:119], v0
    buffer_load_dwordx4 v[28:31], v16, s[8:11], s31 offen offset:1024 sc1
    v_smfmac_f32_16x16x64_bf16 v[84:87], v[76:79], a[120:127], v0
    v_smfmac_f32_16x16x64_bf16 v[88:91], v[72:75], a[224:231], v0
    buffer_load_dwordx4 v[32:35], v16, s[8:11], s31 offen offset:2048 sc1
    v_smfmac_f32_16x16x64_bf16 v[92:95], v[72:75], a[232:239], v0
    v_smfmac_f32_16x16x64_bf16 v[88:91], v[76:79], a[240:247], v0
    buffer_load_dwordx4 v[36:39], v16, s[8:11], s31 offen offset:3072 sc1
    v_smfmac_f32_16x16x64_bf16 v[92:95], v[76:79], a[248:255], v0
    v_mov_b32 v23, v120
    s_waitcnt lgkmcnt(0)
    v_smfmac_f32_16x16x64_bf16 v[80:83], v[64:67], a[64:71], v0
    v_smfmac_f32_16x16x64_bf16 v[84:87], v[64:67], a[72:79], v0
    v_smfmac_f32_16x16x64_bf16 v[80:83], v[68:71], a[80:87], v0
    v_smfmac_f32_16x16x64_bf16 v[84:87], v[68:71], a[88:95], v0
    s_branch m_t_loop3
m_t_cend:
.p2align 8
m_tx_loop0:
    v_smfmac_f32_16x16x64_bf16 v[88:91], v[72:75], a[224:231], v0
    v_lshl_add_u32 v21, v1, 3, s34
    v_smfmac_f32_16x16x64_bf16 v[88:91], v[76:79], a[240:247], v0
    s_waitcnt vmcnt(4)
    v_smfmac_f32_16x16x64_bf16 v[92:95], v[72:75], a[232:239], v0
    buffer_store_dwordx4 v[40:43], v6, s[8:11], s36 offen offset:0 sc1
    v_cvt_pk_bf16_f32 v120, v80, v81
    v_smfmac_f32_16x16x64_bf16 v[92:95], v[76:79], a[248:255], v0
    v_cvt_pk_bf16_f32 v121, v82, v83
    v_cvt_pk_bf16_f32 v122, v84, v85
    v_cvt_pk_bf16_f32 v123, v86, v87
    v_mfma_f32_16x16x16_bf16 v[104:107], v[120:121], v[4:5], 0
    v_cvt_pk_bf16_f32 v124, v88, v89
    v_cvt_pk_bf16_f32 v125, v90, v91
    v_mfma_f32_16x16x16_bf16 v[108:111], v[122:123], v[4:5], 0
    s_nop 0
    v_cvt_pk_bf16_f32 v126, v92, v93
    v_cvt_pk_bf16_f32 v127, v94, v95
    v_mfma_f32_16x16x16_bf16 v[112:115], v[124:125], v[4:5], 0
    s_mov_b32 m0, 18432
    v_mfma_f32_16x16x16_bf16 v[116:119], v[126:127], v[4:5], 0
    v_cvt_pk_bf16_f32 v120, v104, v105
    v_cvt_pk_bf16_f32 v121, v106, v107
    v_cvt_pk_bf16_f32 v122, v108, v109
    v_cvt_pk_bf16_f32 v123, v110, v111
    s_waitcnt vmcnt(1)
    s_nop 0
    v_mfma_f32_16x16x32_bf16 v[104:107], v[24:27], v[120:123], 0
    v_mfma_f32_16x16x32_bf16 v[108:111], v[28:31], v[120:123], 0
    v_cvt_pk_bf16_f32 v40, v112, v113
    v_cvt_pk_bf16_f32 v41, v114, v115
    v_cvt_pk_bf16_f32 v42, v116, v117
    v_cvt_pk_bf16_f32 v43, v118, v119
    s_nop 1
    v_mfma_f32_16x16x32_bf16 v[112:115], v[40:43], v[120:123], 0
    s_nop 0
    v_cndmask_b32 v104, v104, v108, s[38:39]
    v_cndmask_b32 v105, v105, v109, s[38:39]
    v_cndmask_b32 v106, v106, v110, s[38:39]
    v_cndmask_b32 v107, v107, v111, s[38:39]
    ds_write_b128 v1, v[104:107] offset:0
    v_mov_b64 v[40:41], -1
    v_mov_b64 v[42:43], -1
    ds_write_b64 v1, v[112:113] offset:2048
    v_smfmac_f32_16x16x64_bf16 v[100:103], v[52:55], v[152:159], v0
    buffer_store_dwordx4 v[40:43], v6, s[8:11], s36 offen offset:1024 sc1
    s_lshl_b32 s29, s22, 13
    s_add_u32 s29, s29, 131072
    buffer_store_dword v23, v7, s[8:11], s29 offen sc1
    s_cmp_ge_i32 s22, s30
    v_smfmac_f32_16x16x64_bf16 v[96:99], v[56:59], v[160:167], v0
    s_cbranch_scc1 SL_134
SB_135:
    s_mov_b32 exec_hi, 0
    buffer_load_dword v21, s[8:11], s33 offen sc1 lds
    s_mov_b32 exec_hi, -1
    v_smfmac_f32_16x16x64_bf16 v[100:103], v[56:59], v[168:175], v0
    v_smfmac_f32_16x16x64_bf16 v[96:99], v[60:63], v[176:183], v0
    s_waitcnt lgkmcnt(0)
    s_barrier
    ds_read_b128 v[80:83], v1 offset:4096
    ds_read_b128 v[84:87], v1 offset:8192
    ds_read_b128 v[108:111], v1 offset:12288
    v_smfmac_f32_16x16x64_bf16 v[100:103], v[60:63], v[184:191], v0
    ds_read_b64 v[114:115], v1 offset:6144
    ds_read_b64 v[116:117], v1 offset:10240
    ds_read_b64 v[118:119], v1 offset:14336
    v_smfmac_f32_16x16x64_bf16 v[96:99], v[64:67], v[192:199], v0
    ds_read_b128 v[88:91], v18 offset:0
    v_smfmac_f32_16x16x64_bf16 v[100:103], v[64:67], v[200:207], v0
    ds_read_b128 v[92:95], v18 offset:1024
    v_smfmac_f32_16x16x64_bf16 v[96:99], v[68:71], v[208:215], v0
    ds_read_b128 v[24:27], v18 offset:8192
    s_add_u32 s33, s33, 524288
    s_waitcnt lgkmcnt(7)
    v_pk_add_f32 v[80:81], v[80:81], v[84:85]
    v_pk_add_f32 v[82:83], v[82:83], v[86:87]
    s_waitcnt lgkmcnt(6)
    v_pk_add_f32 v[104:105], v[104:105], v[108:109]
    v_pk_add_f32 v[106:107], v[106:107], v[110:111]
    v_pk_add_f32 v[80:81], v[80:81], v[104:105]
    v_pk_add_f32 v[82:83], v[82:83], v[106:107]
    s_waitcnt lgkmcnt(3)
    v_pk_add_f32 v[112:113], v[112:113], v[114:115]
    v_pk_add_f32 v[116:117], v[116:117], v[118:119]
    v_max3_f32 v22, v80, v81, v82
    v_pk_add_f32 v[112:113], v[112:113], v[116:117]
    v_max3_f32 v22, v22, v83, v112
    v_max_f32 v22, v22, v113
    v_smfmac_f32_16x16x64_bf16 v[100:103], v[68:71], v[216:223], v0
    ds_read_b128 v[28:31], v18 offset:9216
    v_max_f32_dpp v22, v22, v22 quad_perm:[2,3,0,1] row_mask:0xf bank_mask:0xf
    v_mov_b32 v20, v22
    v_smfmac_f32_16x16x64_bf16 v[96:99], v[72:75], v[224:231], v0
    ds_read_b128 v[120:123], v2 offset:16384
    v_permlane16_swap_b32 v22, v20
    v_max_f32 v22, v22, v20
    v_mov_b32 v20, v22
    v_smfmac_f32_16x16x64_bf16 v[100:103], v[72:75], v[232:239], v0
    ds_read_b128 v[124:127], v2 offset:17408
    v_permlane32_swap_b32 v22, v20
    v_max_f32 v22, v22, v20
    v_mul_f32 v23, s24, v22
    v_smfmac_f32_16x16x64_bf16 v[96:99], v[76:79], v[240:247], v0
    v_fma_f32 v80, v80, s24, -v23
    v_smfmac_f32_16x16x64_bf16 v[100:103], v[76:79], v[248:255], v0
    v_fma_f32 v81, v81, s24, -v23
    v_fma_f32 v82, v82, s24, -v23
    v_fma_f32 v83, v83, s24, -v23
    v_fma_f32 v112, v112, s24, -v23
    v_fma_f32 v113, v113, s24, -v23
    v_exp_f32 v80, v80
    v_exp_f32 v81, v81
    v_exp_f32 v82, v82
    v_exp_f32 v83, v83
    v_exp_f32 v112, v112
    v_exp_f32 v113, v113
    v_cvt_pk_bf16_f32 v84, v80, v81
    v_cvt_pk_bf16_f32 v85, v82, v83
    v_cvt_pk_bf16_f32 v114, v112, v113
    v_mov_b32_dpp v86, v84 quad_perm:[2,3,0,1] row_mask:0xf bank_mask:0xf
    v_mov_b32_dpp v87, v85 quad_perm:[2,3,0,1] row_mask:0xf bank_mask:0xf
    v_cvt_pk_bf16_f32 v115, v112, v113
    v_cvt_pk_bf16_f32 v116, v112, v113
    v_mfma_f32_16x16x32_bf16 v[40:43], v[12:15], v[84:87], 0
    v_mov_b32 v117, 0
    v_cvt_pk_bf16_f32 v44, v96, v97
    v_mfma_f32_16x16x32_bf16 v[104:107], v[32:35], v[84:87], 0
    v_cvt_pk_bf16_f32 v45, v98, v99
    v_cvt_pk_bf16_f32 v46, v100, v101
    v_mfma_f32_16x16x16_bf16 v[40:43], v[12:13], v[116:117], v[40:43]
    v_cvt_pk_bf16_f32 v47, v102, v103
    ds_read_b128 v[64:67], v2 offset:0
    v_mfma_f32_16x16x32_bf16 v[108:111], v[36:39], v[84:87], 0
    ds_read_b128 v[68:71], v2 offset:1024
    ds_read_b128 v[72:75], v2 offset:8192
    v_mfma_f32_16x16x16_bf16 v[104:107], v[44:45], v[114:115], v[104:107]
    ds_read_b128 v[76:79], v2 offset:9216
    ds_read_b128 v[96:99], v2 offset:24576
    v_mfma_f32_16x16x16_bf16 v[108:111], v[46:47], v[114:115], v[108:111]
    v_rcp_f32 v20, v40
    ds_read_b128 v[100:103], v2 offset:25600
    v_mov_b64 v[62:63], 0
    v_mov_b64 v[60:61], 0
    v_mov_b64 v[58:59], 0
    v_mov_b64 v[56:57], 0
    v_mov_b64 v[54:55], 0
    v_mov_b64 v[52:53], 0
    v_mov_b64 v[50:51], 0
    v_mov_b64 v[48:49], 0
    v_mov_b64 v[40:41], -1
    v_mov_b64 v[42:43], -1
    v_pk_mul_f32 v[104:105], v[104:105], v[20:21] op_sel_hi:[1,0]
    v_pk_mul_f32 v[106:107], v[106:107], v[20:21] op_sel_hi:[1,0]
    v_pk_mul_f32 v[108:109], v[108:109], v[20:21] op_sel_hi:[1,0]
    v_pk_mul_f32 v[110:111], v[110:111], v[20:21] op_sel_hi:[1,0]
    v_cvt_pk_bf16_f32 v116, v104, v105
    v_cvt_pk_bf16_f32 v117, v106, v107
    v_cvt_pk_bf16_f32 v118, v108, v109
    v_cvt_pk_bf16_f32 v119, v110, v111
    ds_write_b128 v19, v[116:119]
    ds_read_b128 v[80:83], v18 offset:16384
    ds_read_b128 v[84:87], v18 offset:17408
    ds_read_b128 v[32:35], v18 offset:24576
    ds_read_b128 v[36:39], v18 offset:25600
    s_add_u32 s29, s25, 24576
    s_and_b32 s29, s29, 1073152
    buffer_store_dword v40, v7, s[8:11], s29 offen sc1
    s_min_u32 s33, s33, 83361792
    s_add_u32 s31, s31, 524288
    s_waitcnt lgkmcnt(4)
    s_barrier
    ds_read_b128 v[104:107], v1 offset:16384
    ds_read_b128 v[108:111], v1 offset:17408
    ds_read_b128 v[112:115], v2 offset:32768
    ds_read_b128 v[116:119], v2 offset:33792
    s_waitcnt lgkmcnt(3)
    v_smfmac_f32_16x16x64_bf16 v[48:51], v[104:107], v[64:71], v0
    v_smfmac_f32_16x16x64_bf16 v[52:55], v[104:107], v[72:79], v0
    v_mov_b64 v[64:65], 0
    v_mov_b64 v[66:67], 0
    s_waitcnt lgkmcnt(2)
    v_smfmac_f32_16x16x64_bf16 v[48:51], v[108:111], v[88:95], v0
    ds_read_b128 v[88:91], v2 offset:40960
    ds_read_b128 v[92:95], v2 offset:41984
    v_mov_b64 v[68:69], 0
    v_smfmac_f32_16x16x64_bf16 v[52:55], v[108:111], v[24:31], v0
    ds_read_b128 v[24:27], v18 offset:32768
    ds_read_b128 v[28:31], v18 offset:33792
    v_mov_b64 v[70:71], 0
    v_smfmac_f32_16x16x64_bf16 v[56:59], v[104:107], v[120:127], v0
    ds_read_b128 v[120:123], v18 offset:40960
    v_mov_b64 v[72:73], 0
    v_smfmac_f32_16x16x64_bf16 v[60:63], v[104:107], v[96:103], v0
    ds_read_b128 v[124:127], v18 offset:41984
    v_add_f32 v48, v48, v50
    v_add_f32 v49, v49, v51
    v_cvt_pk_bf16_f32 v48, v48, v49
    v_smfmac_f32_16x16x64_bf16 v[56:59], v[108:111], v[80:87], v0
    ds_read_b128 v[96:99], v2 offset:49152
    v_add_f32 v52, v52, v54
    v_add_f32 v53, v53, v55
    v_cvt_pk_bf16_f32 v49, v52, v53
    v_smfmac_f32_16x16x64_bf16 v[60:63], v[108:111], v[32:39], v0
    ds_read_b128 v[100:103], v2 offset:50176
    buffer_store_dwordx2 v[48:49], v3, s[8:11], s27 offen offset:0 sc1
    v_mov_b64 v[74:75], 0
    v_mov_b64 v[76:77], 0
    v_mov_b64 v[78:79], 0
    s_waitcnt lgkmcnt(8)
    v_smfmac_f32_16x16x64_bf16 v[64:67], v[104:107], v[112:119], v0
    ds_read_b128 v[80:83], v2 offset:57344
    s_waitcnt lgkmcnt(7)
    v_smfmac_f32_16x16x64_bf16 v[68:71], v[104:107], v[88:95], v0
    ds_read_b128 v[84:87], v2 offset:58368
    v_add_f32 v56, v56, v58
    v_add_f32 v57, v57, v59
    v_cvt_pk_bf16_f32 v56, v56, v57
    s_waitcnt lgkmcnt(6)
    v_smfmac_f32_16x16x64_bf16 v[64:67], v[108:111], v[24:31], v0
    ds_read_b128 v[32:35], v18 offset:49152
    v_add_f32 v60, v60, v62
    v_add_f32 v61, v61, v63
    v_cvt_pk_bf16_f32 v57, v60, v61
    s_waitcnt lgkmcnt(5)
    v_smfmac_f32_16x16x64_bf16 v[68:71], v[108:111], v[120:127], v0
    ds_read_b128 v[36:39], v18 offset:50176
    buffer_store_dwordx2 v[56:57], v3, s[8:11], s27 offen offset:2176 sc1
    s_waitcnt lgkmcnt(4)
    v_smfmac_f32_16x16x64_bf16 v[72:75], v[104:107], v[96:103], v0
    ds_read_b128 v[112:115], v18 offset:57344
    s_waitcnt lgkmcnt(3)
    v_smfmac_f32_16x16x64_bf16 v[76:79], v[104:107], v[80:87], v0
    ds_read_b128 v[116:119], v18 offset:58368
    v_add_f32 v64, v64, v66
    v_add_f32 v65, v65, v67
    v_cvt_pk_bf16_f32 v64, v64, v65
    s_waitcnt lgkmcnt(2)
    v_smfmac_f32_16x16x64_bf16 v[72:75], v[108:111], v[32:39], v0
    v_add_f32 v68, v68, v70
    v_add_f32 v69, v69, v71
    v_cvt_pk_bf16_f32 v65, v68, v69
    s_waitcnt lgkmcnt(0)
    v_smfmac_f32_16x16x64_bf16 v[76:79], v[108:111], v[112:119], v0
    buffer_store_dwordx2 v[64:65], v3, s[8:11], s28 offen offset:0 sc1
    s_nop 1
    v_add_f32 v72, v72, v74
    v_add_f32 v73, v73, v75
    v_cvt_pk_bf16_f32 v72, v72, v73
    s_nop 1
    v_add_f32 v76, v76, v78
    v_add_f32 v77, v77, v79
    v_cvt_pk_bf16_f32 v73, v76, v77
    buffer_store_dwordx2 v[72:73], v3, s[8:11], s28 offen offset:2176 sc1
    s_mov_b32 s23, 0
    v_mov_b64 v[80:81], 0
    v_mov_b64 v[82:83], 0
    v_mov_b64 v[84:85], 0
    v_mov_b64 v[86:87], 0
    v_mov_b64 v[88:89], 0
    v_mov_b64 v[90:91], 0
    v_mov_b64 v[92:93], 0
    v_mov_b64 v[94:95], 0
    v_mov_b64 v[96:97], 0
    v_mov_b64 v[98:99], 0
    v_mov_b64 v[100:101], 0
    v_mov_b64 v[102:103], 0
    s_nop 7
    s_nop 7
    buffer_load_dwordx4 v[104:107], v6, s[8:11], s27 offen sc1
    buffer_load_dwordx4 v[108:111], v6, s[8:11], s27 offen offset:1024 sc1
    s_nop 7
    s_nop 7
    s_nop 7
    s_nop 7
    buffer_load_dwordx4 v[104:107], v6, s[8:11], s27 offen sc1
    buffer_load_dwordx4 v[108:111], v6, s[8:11], s27 offen offset:1024 sc1
    s_add_u32 s25, s25, 8192
    s_and_b32 s25, s25, 1073152
    s_add_u32 s26, s25, 0
    s_xor_b32 s29, s27, 524288
    s_add_u32 s28, s29, 4352
    s_add_u32 s22, s22, 1
PA_138:
    s_waitcnt vmcnt(2)
    v_max3_u32 v20, v104, v105, v106
    v_max3_u32 v21, v107, v108, v109
    v_max3_u32 v20, v110, v111, v20
    v_max_u32 v20, v20, v21
    v_cmp_eq_u32 vcc, -1, v20
    v_mfma_f32_16x16x32_bf16 v[120:123], v[104:107], v[8:11], 0
    v_mfma_f32_16x16x32_bf16 v[120:123], v[108:111], v[8:11], v[120:123]
    s_cbranch_vccz PAd_139
    s_mov_b64 exec, vcc
    buffer_load_dwordx4 v[104:107], v6, s[8:11], s27 offen sc1
    buffer_load_dwordx4 v[108:111], v6, s[8:11], s27 offen offset:1024 sc1
    s_mov_b64 exec, -1
    s_waitcnt vmcnt(2)
    v_max3_u32 v20, v104, v105, v106
    v_max3_u32 v21, v107, v108, v109
    v_max3_u32 v20, v110, v111, v20
    v_max_u32 v20, v20, v21
    v_cmp_eq_u32 vcc, -1, v20
    v_mfma_f32_16x16x32_bf16 v[120:123], v[104:107], v[8:11], 0
    v_mfma_f32_16x16x32_bf16 v[120:123], v[108:111], v[8:11], v[120:123]
    s_cbranch_vccz PAd_139
    s_mov_b64 exec, vcc
    buffer_load_dwordx4 v[104:107], v6, s[8:11], s27 offen sc1
    buffer_load_dwordx4 v[108:111], v6, s[8:11], s27 offen offset:1024 sc1
    s_mov_b64 exec, -1
    s_add_u32 s23, s23, 1
    s_cmp_lt_u32 s23, 400000
    s_cbranch_scc1 PA_138
    s_branch m_exit
PAd_139:
    s_cmp_eq_u32 s22, 63
    s_nop 5
    v_permlane32_swap_b32 v120, v121
    v_permlane32_swap_b32 v122, v123
    v_add_f32 v120, v120, v121
    v_add_f32 v122, v122, v123
    s_cbranch_scc1 FN_140
    s_nop 0
    v_permlane16_swap_b32 v120, v122
    v_add_f32 v120, v120, v122
    s_nop 1
    v_mov_b32_dpp v121, v120 row_shl:4 row_mask:0xf bank_mask:0xf
    v_cvt_pk_bf16_f32 v120, v120, v121
    buffer_store_dword v120, v7, s[8:11], s25 offen sc1
    s_mov_b32 s36, s27
    s_mov_b32 s27, s29
    s_nop 7
    s_nop 7
    s_nop 7
    s_nop 7
    s_nop 7
    s_nop 7
    buffer_load_dwordx4 v[48:51], v1, s[8:11], s26 offen offset:0 sc1
    buffer_load_dwordx4 v[52:55], v1, s[8:11], s26 offen offset:1024 sc1
    s_nop 7
    s_nop 7
    s_nop 7
    s_nop 7
    buffer_load_dwordx4 v[48:51], v1, s[8:11], s26 offen offset:0 sc1
    buffer_load_dwordx4 v[52:55], v1, s[8:11], s26 offen offset:1024 sc1
m_tx_ent0b:
    s_mov_b32 s23, 0
RL_145:
    s_waitcnt vmcnt(2)
    v_max3_u32 v20, v48, v49, v50
    v_max3_u32 v21, v51, v52, v53
    v_max3_u32 v20, v54, v55, v20
    v_max_u32 v20, v20, v21
    v_cmp_eq_u32 vcc, -1, v20
    ds_write_b128 v1, v[48:51] offset:19456
    ds_write_b128 v1, v[52:55] offset:20480
    s_cbranch_vccz RB_143
    s_mov_b64 exec, vcc
    buffer_load_dwordx4 v[48:51], v1, s[8:11], s26 offen offset:0 sc1
    buffer_load_dwordx4 v[52:55], v1, s[8:11], s26 offen offset:1024 sc1
    s_mov_b64 exec, -1
    s_waitcnt vmcnt(2)
    v_max3_u32 v20, v48, v49, v50
    v_max3_u32 v21, v51, v52, v53
    v_max3_u32 v20, v54, v55, v20
    v_max_u32 v20, v20, v21
    v_cmp_eq_u32 vcc, -1, v20
    ds_write_b128 v1, v[48:51] offset:19456
    ds_write_b128 v1, v[52:55] offset:20480
    s_cbranch_vccz RB_143
    s_mov_b64 exec, vcc
    buffer_load_dwordx4 v[48:51], v1, s[8:11], s26 offen offset:0 sc1
    buffer_load_dwordx4 v[52:55], v1, s[8:11], s26 offen offset:1024 sc1
    s_mov_b64 exec, -1
    s_add_u32 s23, s23, 1
    s_cmp_lt_u32 s23, 400000
    s_cbranch_scc1 RL_145
    s_branch m_exit
RB_143:
    s_waitcnt lgkmcnt(0)
    s_barrier
    ds_read_b128 v[56:59], v1 offset:21504
    ds_read_b128 v[60:63], v1 offset:22528
    v_smfmac_f32_16x16x64_bf16 v[80:83], v[48:51], a[0:7], v0
    v_smfmac_f32_16x16x64_bf16 v[84:87], v[48:51], a[8:15], v0
    v_smfmac_f32_16x16x64_bf16 v[88:91], v[48:51], a[128:135], v0
    v_smfmac_f32_16x16x64_bf16 v[92:95], v[48:51], a[136:143], v0
    v_smfmac_f32_16x16x64_bf16 v[80:83], v[52:55], a[16:23], v0
    v_smfmac_f32_16x16x64_bf16 v[84:87], v[52:55], a[24:31], v0
    v_smfmac_f32_16x16x64_bf16 v[88:91], v[52:55], a[144:151], v0
    v_smfmac_f32_16x16x64_bf16 v[92:95], v[52:55], a[152:159], v0
    s_waitcnt lgkmcnt(0)
    v_smfmac_f32_16x16x64_bf16 v[80:83], v[56:59], a[32:39], v0
    v_smfmac_f32_16x16x64_bf16 v[84:87], v[56:59], a[40:47], v0
    buffer_load_dwordx4 v[24:27], v16, s[8:11], s31 offen offset:0 sc1
    v_smfmac_f32_16x16x64_bf16 v[88:91], v[56:59], a[160:167], v0
    v_smfmac_f32_16x16x64_bf16 v[92:95], v[56:59], a[168:175], v0
    buffer_load_dwordx4 v[28:31], v16, s[8:11], s31 offen offset:1024 sc1
    v_smfmac_f32_16x16x64_bf16 v[80:83], v[60:63], a[48:55], v0
    v_smfmac_f32_16x16x64_bf16 v[84:87], v[60:63], a[56:63], v0
    buffer_load_dwordx4 v[32:35], v16, s[8:11], s31 offen offset:2048 sc1
    v_smfmac_f32_16x16x64_bf16 v[88:91], v[60:63], a[176:183], v0
    v_smfmac_f32_16x16x64_bf16 v[92:95], v[60:63], a[184:191], v0
    buffer_load_dwordx4 v[36:39], v16, s[8:11], s31 offen offset:3072 sc1
JY_147:
    s_barrier
    ds_read_b128 v[64:67], v1 offset:23552
    ds_read_b128 v[68:71], v1 offset:24576
    ds_read_b128 v[72:75], v1 offset:25600
    ds_read_b128 v[76:79], v1 offset:26624
    v_smfmac_f32_16x16x64_bf16 v[96:99], v[48:51], v[128:135], v0
    v_smfmac_f32_16x16x64_bf16 v[100:103], v[48:51], v[136:143], v0
    v_smfmac_f32_16x16x64_bf16 v[96:99], v[52:55], v[144:151], v0
    s_waitcnt lgkmcnt(2)
    v_smfmac_f32_16x16x64_bf16 v[80:83], v[64:67], a[64:71], v0
    v_smfmac_f32_16x16x64_bf16 v[84:87], v[64:67], a[72:79], v0
    v_smfmac_f32_16x16x64_bf16 v[80:83], v[68:71], a[80:87], v0
    v_smfmac_f32_16x16x64_bf16 v[84:87], v[68:71], a[88:95], v0
    v_smfmac_f32_16x16x64_bf16 v[88:91], v[64:67], a[192:199], v0
    v_smfmac_f32_16x16x64_bf16 v[92:95], v[64:67], a[200:207], v0
    v_smfmac_f32_16x16x64_bf16 v[88:91], v[68:71], a[208:215], v0
    v_smfmac_f32_16x16x64_bf16 v[92:95], v[68:71], a[216:223], v0
    v_mov_b32 v23, v120
    s_waitcnt lgkmcnt(0)
    v_smfmac_f32_16x16x64_bf16 v[80:83], v[72:75], a[96:103], v0
    v_smfmac_f32_16x16x64_bf16 v[84:87], v[72:75], a[104:111], v0
    v_smfmac_f32_16x16x64_bf16 v[80:83], v[76:79], a[112:119], v0
    v_smfmac_f32_16x16x64_bf16 v[84:87], v[76:79], a[120:127], v0
    s_branch m_tx_loop0
.p2align 8
m_tx_loop1:
    v_smfmac_f32_16x16x64_bf16 v[88:91], v[72:75], a[224:231], v0
    v_lshl_add_u32 v21, v1, 3, s34
    v_smfmac_f32_16x16x64_bf16 v[88:91], v[76:79], a[240:247], v0
    s_waitcnt vmcnt(4)
    v_smfmac_f32_16x16x64_bf16 v[92:95], v[72:75], a[232:239], v0
    buffer_store_dwordx4 v[40:43], v6, s[8:11], s36 offen offset:0 sc1
    v_cvt_pk_bf16_f32 v120, v80, v81
    v_smfmac_f32_16x16x64_bf16 v[92:95], v[76:79], a[248:255], v0
    v_cvt_pk_bf16_f32 v121, v82, v83
    v_cvt_pk_bf16_f32 v122, v84, v85
    v_cvt_pk_bf16_f32 v123, v86, v87
    v_mfma_f32_16x16x16_bf16 v[104:107], v[120:121], v[4:5], 0
    v_cvt_pk_bf16_f32 v124, v88, v89
    v_cvt_pk_bf16_f32 v125, v90, v91
    v_mfma_f32_16x16x16_bf16 v[108:111], v[122:123], v[4:5], 0
    s_nop 0
    v_cvt_pk_bf16_f32 v126, v92, v93
    v_cvt_pk_bf16_f32 v127, v94, v95
    v_mfma_f32_16x16x16_bf16 v[112:115], v[124:125], v[4:5], 0
    s_mov_b32 m0, 18432
    v_mfma_f32_16x16x16_bf16 v[116:119], v[126:127], v[4:5], 0
    v_cvt_pk_bf16_f32 v120, v104, v105
    v_cvt_pk_bf16_f32 v121, v106, v107
    v_cvt_pk_bf16_f32 v122, v108, v109
    v_cvt_pk_bf16_f32 v123, v110, v111
    s_waitcnt vmcnt(1)
    s_nop 0
    v_mfma_f32_16x16x32_bf16 v[104:107], v[24:27], v[120:123], 0
    v_mfma_f32_16x16x32_bf16 v[108:111], v[28:31], v[120:123], 0
    v_cvt_pk_bf16_f32 v40, v112, v113
    v_cvt_pk_bf16_f32 v41, v114, v115
    v_cvt_pk_bf16_f32 v42, v116, v117
    v_cvt_pk_bf16_f32 v43, v118, v119
    s_nop 1
    v_mfma_f32_16x16x32_bf16 v[112:115], v[40:43], v[120:123], 0
    s_nop 0
    v_cndmask_b32 v104, v104, v108, s[38:39]
    v_cndmask_b32 v105, v105, v109, s[38:39]
    v_cndmask_b32 v106, v106, v110, s[38:39]
    v_cndmask_b32 v107, v107, v111, s[38:39]
    ds_write_b128 v1, v[104:107] offset:4096
    v_mov_b64 v[40:41], -1
    v_mov_b64 v[42:43], -1
    ds_write_b64 v1, v[112:113] offset:6144
    v_smfmac_f32_16x16x64_bf16 v[100:103], v[52:55], v[152:159], v0
    buffer_store_dwordx4 v[40:43], v6, s[8:11], s36 offen offset:1024 sc1
    s_lshl_b32 s29, s22, 13
    s_add_u32 s29, s29, 131072
    buffer_store_dword v23, v7, s[8:11], s29 offen sc1
    s_cmp_ge_i32 s22, s30
    v_smfmac_f32_16x16x64_bf16 v[96:99], v[56:59], v[160:167], v0
    s_cbranch_scc1 SL_148
SB_149:
    s_mov_b32 exec_hi, 0
    buffer_load_dword v21, s[8:11], s33 offen sc1 lds
    s_mov_b32 exec_hi, -1
    v_smfmac_f32_16x16x64_bf16 v[100:103], v[56:59], v[168:175], v0
    v_smfmac_f32_16x16x64_bf16 v[96:99], v[60:63], v[176:183], v0
    s_waitcnt lgkmcnt(0)
    s_barrier
    ds_read_b128 v[80:83], v1 offset:0
    ds_read_b128 v[84:87], v1 offset:8192
    ds_read_b128 v[108:111], v1 offset:12288
    v_smfmac_f32_16x16x64_bf16 v[100:103], v[60:63], v[184:191], v0
    ds_read_b64 v[114:115], v1 offset:2048
    ds_read_b64 v[116:117], v1 offset:10240
    ds_read_b64 v[118:119], v1 offset:14336
    v_smfmac_f32_16x16x64_bf16 v[96:99], v[64:67], v[192:199], v0
    ds_read_b128 v[88:91], v18 offset:0
    v_smfmac_f32_16x16x64_bf16 v[100:103], v[64:67], v[200:207], v0
    ds_read_b128 v[92:95], v18 offset:1024
    v_smfmac_f32_16x16x64_bf16 v[96:99], v[68:71], v[208:215], v0
    ds_read_b128 v[24:27], v18 offset:8192
    s_add_u32 s33, s33, 524288
    s_waitcnt lgkmcnt(7)
    v_pk_add_f32 v[80:81], v[80:81], v[84:85]
    v_pk_add_f32 v[82:83], v[82:83], v[86:87]
    s_waitcnt lgkmcnt(6)
    v_pk_add_f32 v[104:105], v[104:105], v[108:109]
    v_pk_add_f32 v[106:107], v[106:107], v[110:111]
    v_pk_add_f32 v[80:81], v[80:81], v[104:105]
    v_pk_add_f32 v[82:83], v[82:83], v[106:107]
    s_waitcnt lgkmcnt(3)
    v_pk_add_f32 v[112:113], v[112:113], v[114:115]
    v_pk_add_f32 v[116:117], v[116:117], v[118:119]
    v_max3_f32 v22, v80, v81, v82
    v_pk_add_f32 v[112:113], v[112:113], v[116:117]
    v_max3_f32 v22, v22, v83, v112
    v_max_f32 v22, v22, v113
    v_smfmac_f32_16x16x64_bf16 v[100:103], v[68:71], v[216:223], v0
    ds_read_b128 v[28:31], v18 offset:9216
    v_max_f32_dpp v22, v22, v22 quad_perm:[2,3,0,1] row_mask:0xf bank_mask:0xf
    v_mov_b32 v20, v22
    v_smfmac_f32_16x16x64_bf16 v[96:99], v[72:75], v[224:231], v0
    ds_read_b128 v[120:123], v2 offset:16384
    v_permlane16_swap_b32 v22, v20
    v_max_f32 v22, v22, v20
    v_mov_b32 v20, v22
    v_smfmac_f32_16x16x64_bf16 v[100:103], v[72:75], v[232:239], v0
    ds_read_b128 v[124:127], v2 offset:17408
    v_permlane32_swap_b32 v22, v20
    v_max_f32 v22, v22, v20
    v_mul_f32 v23, s24, v22
    v_smfmac_f32_16x16x64_bf16 v[96:99], v[76:79], v[240:247], v0
    v_fma_f32 v80, v80, s24, -v23
    v_smfmac_f32_16x16x64_bf16 v[100:103], v[76:79], v[248:255], v0
    v_fma_f32 v81, v81, s24, -v23
    v_fma_f32 v82, v82, s24, -v23
    v_fma_f32 v83, v83, s24, -v23
    v_fma_f32 v112, v112, s24, -v23
    v_fma_f32 v113, v113, s24, -v23
    v_exp_f32 v80, v80
    v_exp_f32 v81, v81
    v_exp_f32 v82, v82
    v_exp_f32 v83, v83
    v_exp_f32 v112, v112
    v_exp_f32 v113, v113
    v_cvt_pk_bf16_f32 v84, v80, v81
    v_cvt_pk_bf16_f32 v85, v82, v83
    v_cvt_pk_bf16_f32 v114, v112, v113
    v_mov_b32_dpp v86, v84 quad_perm:[2,3,0,1] row_mask:0xf bank_mask:0xf
    v_mov_b32_dpp v87, v85 quad_perm:[2,3,0,1] row_mask:0xf bank_mask:0xf
    v_cvt_pk_bf16_f32 v115, v112, v113
    v_cvt_pk_bf16_f32 v116, v112, v113
    v_mfma_f32_16x16x32_bf16 v[40:43], v[12:15], v[84:87], 0
    v_mov_b32 v117, 0
    v_cvt_pk_bf16_f32 v44, v96, v97
    v_mfma_f32_16x16x32_bf16 v[104:107], v[32:35], v[84:87], 0
    v_cvt_pk_bf16_f32 v45, v98, v99
    v_cvt_pk_bf16_f32 v46, v100, v101
    v_mfma_f32_16x16x16_bf16 v[40:43], v[12:13], v[116:117], v[40:43]
    v_cvt_pk_bf16_f32 v47, v102, v103
    ds_read_b128 v[64:67], v2 offset:0
    v_mfma_f32_16x16x32_bf16 v[108:111], v[36:39], v[84:87], 0
    ds_read_b128 v[68:71], v2 offset:1024
    ds_read_b128 v[72:75], v2 offset:8192
    v_mfma_f32_16x16x16_bf16 v[104:107], v[44:45], v[114:115], v[104:107]
    ds_read_b128 v[76:79], v2 offset:9216
    ds_read_b128 v[96:99], v2 offset:24576
    v_mfma_f32_16x16x16_bf16 v[108:111], v[46:47], v[114:115], v[108:111]
    v_rcp_f32 v20, v40
    ds_read_b128 v[100:103], v2 offset:25600
    v_mov_b64 v[62:63], 0
    v_mov_b64 v[60:61], 0
    v_mov_b64 v[58:59], 0
    v_mov_b64 v[56:57], 0
    v_mov_b64 v[54:55], 0
    v_mov_b64 v[52:53], 0
    v_mov_b64 v[50:51], 0
    v_mov_b64 v[48:49], 0
    v_mov_b64 v[40:41], -1
    v_mov_b64 v[42:43], -1
    v_pk_mul_f32 v[104:105], v[104:105], v[20:21] op_sel_hi:[1,0]
    v_pk_mul_f32 v[106:107], v[106:107], v[20:21] op_sel_hi:[1,0]
    v_pk_mul_f32 v[108:109], v[108:109], v[20:21] op_sel_hi:[1,0]
    v_pk_mul_f32 v[110:111], v[110:111], v[20:21] op_sel_hi:[1,0]
    v_cvt_pk_bf16_f32 v116, v104, v105
    v_cvt_pk_bf16_f32 v117, v106, v107
    v_cvt_pk_bf16_f32 v118, v108, v109
    v_cvt_pk_bf16_f32 v119, v110, v111
    ds_write_b128 v19, v[116:119]
    ds_read_b128 v[80:83], v18 offset:16384
    ds_read_b128 v[84:87], v18 offset:17408
    ds_read_b128 v[32:35], v18 offset:24576
    ds_read_b128 v[36:39], v18 offset:25600
    s_add_u32 s29, s25, 24576
    s_and_b32 s29, s29, 1073152
    buffer_store_dword v40, v7, s[8:11], s29 offen sc1
    s_min_u32 s33, s33, 83361792
    s_add_u32 s31, s31, 524288
    s_waitcnt lgkmcnt(4)
    s_barrier
    ds_read_b128 v[104:107], v1 offset:16384
    ds_read_b128 v[108:111], v1 offset:17408
    ds_read_b128 v[112:115], v2 offset:32768
    ds_read_b128 v[116:119], v2 offset:33792
    s_waitcnt lgkmcnt(3)
    v_smfmac_f32_16x16x64_bf16 v[48:51], v[104:107], v[64:71], v0
    v_smfmac_f32_16x16x64_bf16 v[52:55], v[104:107], v[72:79], v0
    v_mov_b64 v[64:65], 0
    v_mov_b64 v[66:67], 0
    s_waitcnt lgkmcnt(2)
    v_smfmac_f32_16x16x64_bf16 v[48:51], v[108:111], v[88:95], v0
    ds_read_b128 v[88:91], v2 offset:40960
    ds_read_b128 v[92:95], v2 offset:41984
    v_mov_b64 v[68:69], 0
    v_smfmac_f32_16x16x64_bf16 v[52:55], v[108:111], v[24:31], v0
    ds_read_b128 v[24:27], v18 offset:32768
    ds_read_b128 v[28:31], v18 offset:33792
    v_mov_b64 v[70:71], 0
    v_smfmac_f32_16x16x64_bf16 v[56:59], v[104:107], v[120:127], v0
    ds_read_b128 v[120:123], v18 offset:40960
    v_mov_b64 v[72:73], 0
    v_smfmac_f32_16x16x64_bf16 v[60:63], v[104:107], v[96:103], v0
    ds_read_b128 v[124:127], v18 offset:41984
    v_add_f32 v48, v48, v50
    v_add_f32 v49, v49, v51
    v_cvt_pk_bf16_f32 v48, v48, v49
    v_smfmac_f32_16x16x64_bf16 v[56:59], v[108:111], v[80:87], v0
    ds_read_b128 v[96:99], v2 offset:49152
    v_add_f32 v52, v52, v54
    v_add_f32 v53, v53, v55
    v_cvt_pk_bf16_f32 v49, v52, v53
    v_smfmac_f32_16x16x64_bf16 v[60:63], v[108:111], v[32:39], v0
    ds_read_b128 v[100:103], v2 offset:50176
    buffer_store_dwordx2 v[48:49], v3, s[8:11], s27 offen offset:0 sc1
    v_mov_b64 v[74:75], 0
    v_mov_b64 v[76:77], 0
    v_mov_b64 v[78:79], 0
    s_waitcnt lgkmcnt(8)
    v_smfmac_f32_16x16x64_bf16 v[64:67], v[104:107], v[112:119], v0
    ds_read_b128 v[80:83], v2 offset:57344
    s_waitcnt lgkmcnt(7)
    v_smfmac_f32_16x16x64_bf16 v[68:71], v[104:107], v[88:95], v0
    ds_read_b128 v[84:87], v2 offset:58368
    v_add_f32 v56, v56, v58
    v_add_f32 v57, v57, v59
    v_cvt_pk_bf16_f32 v56, v56, v57
    s_waitcnt lgkmcnt(6)
    v_smfmac_f32_16x16x64_bf16 v[64:67], v[108:111], v[24:31], v0
    ds_read_b128 v[32:35], v18 offset:49152
    v_add_f32 v60, v60, v62
    v_add_f32 v61, v61, v63
    v_cvt_pk_bf16_f32 v57, v60, v61
    s_waitcnt lgkmcnt(5)
    v_smfmac_f32_16x16x64_bf16 v[68:71], v[108:111], v[120:127], v0
    ds_read_b128 v[36:39], v18 offset:50176
    buffer_store_dwordx2 v[56:57], v3, s[8:11], s27 offen offset:2176 sc1
    s_waitcnt lgkmcnt(4)
    v_smfmac_f32_16x16x64_bf16 v[72:75], v[104:107], v[96:103], v0
    ds_read_b128 v[112:115], v18 offset:57344
    s_waitcnt lgkmcnt(3)
    v_smfmac_f32_16x16x64_bf16 v[76:79], v[104:107], v[80:87], v0
    ds_read_b128 v[116:119], v18 offset:58368
    v_add_f32 v64, v64, v66
    v_add_f32 v65, v65, v67
    v_cvt_pk_bf16_f32 v64, v64, v65
    s_waitcnt lgkmcnt(2)
    v_smfmac_f32_16x16x64_bf16 v[72:75], v[108:111], v[32:39], v0
    v_add_f32 v68, v68, v70
    v_add_f32 v69, v69, v71
    v_cvt_pk_bf16_f32 v65, v68, v69
    s_waitcnt lgkmcnt(0)
    v_smfmac_f32_16x16x64_bf16 v[76:79], v[108:111], v[112:119], v0
    buffer_store_dwordx2 v[64:65], v3, s[8:11], s28 offen offset:0 sc1
    s_nop 1
    v_add_f32 v72, v72, v74
    v_add_f32 v73, v73, v75
    v_cvt_pk_bf16_f32 v72, v72, v73
    s_nop 1
    v_add_f32 v76, v76, v78
    v_add_f32 v77, v77, v79
    v_cvt_pk_bf16_f32 v73, v76, v77
    buffer_store_dwordx2 v[72:73], v3, s[8:11], s28 offen offset:2176 sc1
    s_mov_b32 s23, 0
    v_mov_b64 v[80:81], 0
    v_mov_b64 v[82:83], 0
    v_mov_b64 v[84:85], 0
    v_mov_b64 v[86:87], 0
    v_mov_b64 v[88:89], 0
    v_mov_b64 v[90:91], 0
    v_mov_b64 v[92:93], 0
    v_mov_b64 v[94:95], 0
    v_mov_b64 v[96:97], 0
    v_mov_b64 v[98:99], 0
    v_mov_b64 v[100:101], 0
    v_mov_b64 v[102:103], 0
    s_nop 7
    s_nop 7
    s_nop 7
    buffer_load_dwordx4 v[104:107], v6, s[8:11], s27 offen sc1
    buffer_load_dwordx4 v[108:111], v6, s[8:11], s27 offen offset:1024 sc1
    s_nop 7
    s_nop 7
    s_nop 7
    s_nop 7
    buffer_load_dwordx4 v[104:107], v6, s[8:11], s27 offen sc1
    buffer_load_dwordx4 v[108:111], v6, s[8:11], s27 offen offset:1024 sc1
    s_add_u32 s25, s25, 8192
    s_and_b32 s25, s25, 1073152
    s_add_u32 s26, s25, 2048
    s_xor_b32 s29, s27, 524288
    s_add_u32 s28, s29, 4352
    s_add_u32 s22, s22, 1
PA_152:
    s_waitcnt vmcnt(2)
    v_max3_u32 v20, v104, v105, v106
    v_max3_u32 v21, v107, v108, v109
    v_max3_u32 v20, v110, v111, v20
    v_max_u32 v20, v20, v21
    v_cmp_eq_u32 vcc, -1, v20
    v_mfma_f32_16x16x32_bf16 v[120:123], v[104:107], v[8:11], 0
    v_mfma_f32_16x16x32_bf16 v[120:123], v[108:111], v[8:11], v[120:123]
    s_cbranch_vccz PAd_153
    s_mov_b64 exec, vcc
    buffer_load_dwordx4 v[104:107], v6, s[8:11], s27 offen sc1
    buffer_load_dwordx4 v[108:111], v6, s[8:11], s27 offen offset:1024 sc1
    s_mov_b64 exec, -1
    s_waitcnt vmcnt(2)
    v_max3_u32 v20, v104, v105, v106
    v_max3_u32 v21, v107, v108, v109
    v_max3_u32 v20, v110, v111, v20
    v_max_u32 v20, v20, v21
    v_cmp_eq_u32 vcc, -1, v20
    v_mfma_f32_16x16x32_bf16 v[120:123], v[104:107], v[8:11], 0
    v_mfma_f32_16x16x32_bf16 v[120:123], v[108:111], v[8:11], v[120:123]
    s_cbranch_vccz PAd_153
    s_mov_b64 exec, vcc
    buffer_load_dwordx4 v[104:107], v6, s[8:11], s27 offen sc1
    buffer_load_dwordx4 v[108:111], v6, s[8:11], s27 offen offset:1024 sc1
    s_mov_b64 exec, -1
    s_add_u32 s23, s23, 1
    s_cmp_lt_u32 s23, 400000
    s_cbranch_scc1 PA_152
    s_branch m_exit
PAd_153:
    s_cmp_eq_u32 s22, 63
    s_nop 5
    v_permlane32_swap_b32 v120, v121
    v_permlane32_swap_b32 v122, v123
    v_add_f32 v120, v120, v121
    v_add_f32 v122, v122, v123
    s_cbranch_scc1 FN_154
    s_nop 0
    v_permlane16_swap_b32 v120, v122
    v_add_f32 v120, v120, v122
    s_nop 1
    v_mov_b32_dpp v121, v120 row_shl:4 row_mask:0xf bank_mask:0xf
    v_cvt_pk_bf16_f32 v120, v120, v121
    buffer_store_dword v120, v7, s[8:11], s25 offen sc1
    s_mov_b32 s36, s27
    s_mov_b32 s27, s29
    s_nop 7
    s_nop 7
    s_nop 7
    s_nop 7
    s_nop 7
    s_nop 7
    buffer_load_dwordx4 v[56:59], v1, s[8:11], s26 offen offset:0 sc1
    buffer_load_dwordx4 v[60:63], v1, s[8:11], s26 offen offset:1024 sc1
    s_nop 7
    s_nop 7
    s_nop 7
    s_nop 7
    buffer_load_dwordx4 v[56:59], v1, s[8:11], s26 offen offset:0 sc1
    buffer_load_dwordx4 v[60:63], v1, s[8:11], s26 offen offset:1024 sc1
m_tx_ent1b:
    s_mov_b32 s23, 0
RL_159:
    s_waitcnt vmcnt(2)
    v_max3_u32 v20, v56, v57, v58
    v_max3_u32 v21, v59, v60, v61
    v_max3_u32 v20, v62, v63, v20
    v_max_u32 v20, v20, v21
    v_cmp_eq_u32 vcc, -1, v20
    ds_write_b128 v1, v[56:59] offset:21504
    ds_write_b128 v1, v[60:63] offset:22528
    s_cbranch_vccz RB_157
    s_mov_b64 exec, vcc
    buffer_load_dwordx4 v[56:59], v1, s[8:11], s26 offen offset:0 sc1
    buffer_load_dwordx4 v[60:63], v1, s[8:11], s26 offen offset:1024 sc1
    s_mov_b64 exec, -1
    s_waitcnt vmcnt(2)
    v_max3_u32 v20, v56, v57, v58
    v_max3_u32 v21, v59, v60, v61
    v_max3_u32 v20, v62, v63, v20
    v_max_u32 v20, v20, v21
    v_cmp_eq_u32 vcc, -1, v20
    ds_write_b128 v1, v[56:59] offset:21504
    ds_write_b128 v1, v[60:63] offset:22528
    s_cbranch_vccz RB_157
    s_mov_b64 exec, vcc
    buffer_load_dwordx4 v[56:59], v1, s[8:11], s26 offen offset:0 sc1
    buffer_load_dwordx4 v[60:63], v1, s[8:11], s26 offen offset:1024 sc1
    s_mov_b64 exec, -1
    s_add_u32 s23, s23, 1
    s_cmp_lt_u32 s23, 400000
    s_cbranch_scc1 RL_159
    s_branch m_exit
RB_157:
    s_waitcnt lgkmcnt(0)
    s_barrier
    ds_read_b128 v[48:51], v1 offset:19456
    ds_read_b128 v[52:55], v1 offset:20480
    v_smfmac_f32_16x16x64_bf16 v[80:83], v[56:59], a[32:39], v0
    v_smfmac_f32_16x16x64_bf16 v[84:87], v[56:59], a[40:47], v0
    v_smfmac_f32_16x16x64_bf16 v[88:91], v[56:59], a[160:167], v0
    v_smfmac_f32_16x16x64_bf16 v[92:95], v[56:59], a[168:175], v0
    v_smfmac_f32_16x16x64_bf16 v[80:83], v[60:63], a[48:55], v0
    v_smfmac_f32_16x16x64_bf16 v[84:87], v[60:63], a[56:63], v0
    v_smfmac_f32_16x16x64_bf16 v[88:91], v[60:63], a[176:183], v0
    v_smfmac_f32_16x16x64_bf16 v[92:95], v[60:63], a[184:191], v0
    s_waitcnt lgkmcnt(0)
    v_smfmac_f32_16x16x64_bf16 v[80:83], v[48:51], a[0:7], v0
    v_smfmac_f32_16x16x64_bf16 v[84:87], v[48:51], a[8:15], v0
    buffer_load_dwordx4 v[24:27], v16, s[8:11], s31 offen offset:0 sc1
    v_smfmac_f32_16x16x64_bf16 v[88:91], v[48:51], a[128:135], v0
    v_smfmac_f32_16x16x64_bf16 v[92:95], v[48:51], a[136:143], v0
    buffer_load_dwordx4 v[28:31], v16, s[8:11], s31 offen offset:1024 sc1
    v_smfmac_f32_16x16x64_bf16 v[80:83], v[52:55], a[16:23], v0
    v_smfmac_f32_16x16x64_bf16 v[84:87], v[52:55], a[24:31], v0
    buffer_load_dwordx4 v[32:35], v16, s[8:11], s31 offen offset:2048 sc1
    v_smfmac_f32_16x16x64_bf16 v[88:91], v[52:55], a[144:151], v0
    v_smfmac_f32_16x16x64_bf16 v[92:95], v[52:55], a[152:159], v0
    buffer_load_dwordx4 v[36:39], v16, s[8:11], s31 offen offset:3072 sc1
JY_161:
    s_barrier
    ds_read_b128 v[64:67], v1 offset:23552
    ds_read_b128 v[68:71], v1 offset:24576
    ds_read_b128 v[72:75], v1 offset:25600
    ds_read_b128 v[76:79], v1 offset:26624
    v_smfmac_f32_16x16x64_bf16 v[96:99], v[48:51], v[128:135], v0
    v_smfmac_f32_16x16x64_bf16 v[100:103], v[48:51], v[136:143], v0
    v_smfmac_f32_16x16x64_bf16 v[96:99], v[52:55], v[144:151], v0
    s_waitcnt lgkmcnt(2)
    v_smfmac_f32_16x16x64_bf16 v[80:83], v[64:67], a[64:71], v0
    v_smfmac_f32_16x16x64_bf16 v[84:87], v[64:67], a[72:79], v0
    v_smfmac_f32_16x16x64_bf16 v[80:83], v[68:71], a[80:87], v0
    v_smfmac_f32_16x16x64_bf16 v[84:87], v[68:71], a[88:95], v0
    v_smfmac_f32_16x16x64_bf16 v[88:91], v[64:67], a[192:199], v0
    v_smfmac_f32_16x16x64_bf16 v[92:95], v[64:67], a[200:207], v0
    v_smfmac_f32_16x16x64_bf16 v[88:91], v[68:71], a[208:215], v0
    v_smfmac_f32_16x16x64_bf16 v[92:95], v[68:71], a[216:223], v0
    v_mov_b32 v23, v120
    s_waitcnt lgkmcnt(0)
    v_smfmac_f32_16x16x64_bf16 v[80:83], v[72:75], a[96:103], v0
    v_smfmac_f32_16x16x64_bf16 v[84:87], v[72:75], a[104:111], v0
    v_smfmac_f32_16x16x64_bf16 v[80:83], v[76:79], a[112:119], v0
    v_smfmac_f32_16x16x64_bf16 v[84:87], v[76:79], a[120:127], v0
    s_branch m_tx_loop1
.p2align 8
m_tx_loop2:
    v_smfmac_f32_16x16x64_bf16 v[88:91], v[72:75], a[224:231], v0
    v_lshl_add_u32 v21, v1, 3, s34
    v_smfmac_f32_16x16x64_bf16 v[88:91], v[76:79], a[240:247], v0
    s_waitcnt vmcnt(4)
    v_smfmac_f32_16x16x64_bf16 v[92:95], v[72:75], a[232:239], v0
    buffer_store_dwordx4 v[40:43], v6, s[8:11], s36 offen offset:0 sc1
    v_cvt_pk_bf16_f32 v120, v80, v81
    v_smfmac_f32_16x16x64_bf16 v[92:95], v[76:79], a[248:255], v0
    v_cvt_pk_bf16_f32 v121, v82, v83
    v_cvt_pk_bf16_f32 v122, v84, v85
    v_cvt_pk_bf16_f32 v123, v86, v87
    v_mfma_f32_16x16x16_bf16 v[104:107], v[120:121], v[4:5], 0
    v_cvt_pk_bf16_f32 v124, v88, v89
    v_cvt_pk_bf16_f32 v125, v90, v91
    v_mfma_f32_16x16x16_bf16 v[108:111], v[122:123], v[4:5], 0
    s_nop 0
    v_cvt_pk_bf16_f32 v126, v92, v93
    v_cvt_pk_bf16_f32 v127, v94, v95
    v_mfma_f32_16x16x16_bf16 v[112:115], v[124:125], v[4:5], 0
    s_mov_b32 m0, 18432
    v_mfma_f32_16x16x16_bf16 v[116:119], v[126:127], v[4:5], 0
    v_cvt_pk_bf16_f32 v120, v104, v105
    v_cvt_pk_bf16_f32 v121, v106, v107
    v_cvt_pk_bf16_f32 v122, v108, v109
    v_cvt_pk_bf16_f32 v123, v110, v111
    s_waitcnt vmcnt(1)
    s_nop 0
    v_mfma_f32_16x16x32_bf16 v[104:107], v[24:27], v[120:123], 0
    v_mfma_f32_16x16x32_bf16 v[108:111], v[28:31], v[120:123], 0
    v_cvt_pk_bf16_f32 v40, v112, v113
    v_cvt_pk_bf16_f32 v41, v114, v115
    v_cvt_pk_bf16_f32 v42, v116, v117
    v_cvt_pk_bf16_f32 v43, v118, v119
    s_nop 1
    v_mfma_f32_16x16x32_bf16 v[112:115], v[40:43], v[120:123], 0
    s_nop 0
    v_cndmask_b32 v104, v104, v108, s[38:39]
    v_cndmask_b32 v105, v105, v109, s[38:39]
    v_cndmask_b32 v106, v106, v110, s[38:39]
    v_cndmask_b32 v107, v107, v111, s[38:39]
    ds_write_b128 v1, v[104:107] offset:8192
    v_mov_b64 v[40:41], -1
    v_mov_b64 v[42:43], -1
    ds_write_b64 v1, v[112:113] offset:10240
    v_smfmac_f32_16x16x64_bf16 v[96:99], v[48:51], v[128:135], v0
    buffer_store_dwordx4 v[40:43], v6, s[8:11], s36 offen offset:1024 sc1
    s_lshl_b32 s29, s22, 13
    s_add_u32 s29, s29, 131072
    buffer_store_dword v23, v7, s[8:11], s29 offen sc1
    s_cmp_ge_i32 s22, s30
    v_smfmac_f32_16x16x64_bf16 v[100:103], v[48:51], v[136:143], v0
    s_cbranch_scc1 SL_162
SB_163:
    s_mov_b32 exec_hi, 0
    buffer_load_dword v21, s[8:11], s33 offen sc1 lds
    s_mov_b32 exec_hi, -1
    v_smfmac_f32_16x16x64_bf16 v[96:99], v[52:55], v[144:151], v0
    v_smfmac_f32_16x16x64_bf16 v[100:103], v[52:55], v[152:159], v0
    s_waitcnt lgkmcnt(0)
    s_barrier
    ds_read_b128 v[80:83], v1 offset:0
    ds_read_b128 v[84:87], v1 offset:4096
    ds_read_b128 v[108:111], v1 offset:12288
    v_smfmac_f32_16x16x64_bf16 v[96:99], v[56:59], v[160:167], v0
    ds_read_b64 v[114:115], v1 offset:2048
    ds_read_b64 v[116:117], v1 offset:6144
    ds_read_b64 v[118:119], v1 offset:14336
    v_smfmac_f32_16x16x64_bf16 v[100:103], v[56:59], v[168:175], v0
    ds_read_b128 v[88:91], v18 offset:0
    v_smfmac_f32_16x16x64_bf16 v[96:99], v[60:63], v[176:183], v0
    ds_read_b128 v[92:95], v18 offset:1024
    v_smfmac_f32_16x16x64_bf16 v[100:103], v[60:63], v[184:191], v0
    ds_read_b128 v[24:27], v18 offset:8192
    s_add_u32 s33, s33, 524288
    s_waitcnt lgkmcnt(7)
    v_pk_add_f32 v[80:81], v[80:81], v[84:85]
    v_pk_add_f32 v[82:83], v[82:83], v[86:87]
    s_waitcnt lgkmcnt(6)
    v_pk_add_f32 v[104:105], v[104:105], v[108:109]
    v_pk_add_f32 v[106:107], v[106:107], v[110:111]
    v_pk_add_f32 v[80:81], v[80:81], v[104:105]
    v_pk_add_f32 v[82:83], v[82:83], v[106:107]
    s_waitcnt lgkmcnt(3)
    v_pk_add_f32 v[112:113], v[112:113], v[114:115]
    v_pk_add_f32 v[116:117], v[116:117], v[118:119]
    v_max3_f32 v22, v80, v81, v82
    v_pk_add_f32 v[112:113], v[112:113], v[116:117]
    v_max3_f32 v22, v22, v83, v112
    v_max_f32 v22, v22, v113
    v_smfmac_f32_16x16x64_bf16 v[96:99], v[64:67], v[192:199], v0
    ds_read_b128 v[28:31], v18 offset:9216
    v_max_f32_dpp v22, v22, v22 quad_perm:[2,3,0,1] row_mask:0xf bank_mask:0xf
    v_mov_b32 v20, v22
    v_smfmac_f32_16x16x64_bf16 v[100:103], v[64:67], v[200:207], v0
    ds_read_b128 v[120:123], v2 offset:16384
    v_permlane16_swap_b32 v22, v20
    v_max_f32 v22, v22, v20
    v_mov_b32 v20, v22
    v_smfmac_f32_16x16x64_bf16 v[96:99], v[68:71], v[208:215], v0
    ds_read_b128 v[124:127], v2 offset:17408
    v_permlane32_swap_b32 v22, v20
    v_max_f32 v22, v22, v20
    v_mul_f32 v23, s24, v22
    v_smfmac_f32_16x16x64_bf16 v[100:103], v[68:71], v[216:223], v0
    v_fma_f32 v80, v80, s24, -v23
    v_smfmac_f32_16x16x64_bf16 v[96:99], v[72:75], v[224:231], v0
    v_fma_f32 v81, v81, s24, -v23
    v_smfmac_f32_16x16x64_bf16 v[100:103], v[72:75], v[232:239], v0
    v_fma_f32 v82, v82, s24, -v23
    v_smfmac_f32_16x16x64_bf16 v[96:99], v[76:79], v[240:247], v0
    v_fma_f32 v83, v83, s24, -v23
    v_smfmac_f32_16x16x64_bf16 v[100:103], v[76:79], v[248:255], v0
    v_fma_f32 v112, v112, s24, -v23
    v_fma_f32 v113, v113, s24, -v23
    v_exp_f32 v80, v80
    v_exp_f32 v81, v81
    v_exp_f32 v82, v82
    v_exp_f32 v83, v83
    v_exp_f32 v112, v112
    v_exp_f32 v113, v113
    v_cvt_pk_bf16_f32 v84, v80, v81
    v_cvt_pk_bf16_f32 v85, v82, v83
    v_cvt_pk_bf16_f32 v114, v112, v113
    v_mov_b32_dpp v86, v84 quad_perm:[2,3,0,1] row_mask:0xf bank_mask:0xf
    v_mov_b32_dpp v87, v85 quad_perm:[2,3,0,1] row_mask:0xf bank_mask:0xf
    v_cvt_pk_bf16_f32 v115, v112, v113
    v_cvt_pk_bf16_f32 v116, v112, v113
    v_mfma_f32_16x16x32_bf16 v[40:43], v[12:15], v[84:87], 0
    v_mov_b32 v117, 0
    v_cvt_pk_bf16_f32 v44, v96, v97
    v_mfma_f32_16x16x32_bf16 v[104:107], v[32:35], v[84:87], 0
    v_cvt_pk_bf16_f32 v45, v98, v99
    v_cvt_pk_bf16_f32 v46, v100, v101
    v_mfma_f32_16x16x16_bf16 v[40:43], v[12:13], v[116:117], v[40:43]
    v_cvt_pk_bf16_f32 v47, v102, v103
    ds_read_b128 v[64:67], v2 offset:0
    v_mfma_f32_16x16x32_bf16 v[108:111], v[36:39], v[84:87], 0
    ds_read_b128 v[68:71], v2 offset:1024
    ds_read_b128 v[72:75], v2 offset:8192
    v_mfma_f32_16x16x16_bf16 v[104:107], v[44:45], v[114:115], v[104:107]
    ds_read_b128 v[76:79], v2 offset:9216
    ds_read_b128 v[96:99], v2 offset:24576
    v_mfma_f32_16x16x16_bf16 v[108:111], v[46:47], v[114:115], v[108:111]
    v_rcp_f32 v20, v40
    ds_read_b128 v[100:103], v2 offset:25600
    v_mov_b64 v[62:63], 0
    v_mov_b64 v[60:61], 0
    v_mov_b64 v[58:59], 0
    v_mov_b64 v[56:57], 0
    v_mov_b64 v[54:55], 0
    v_mov_b64 v[52:53], 0
    v_mov_b64 v[50:51], 0
    v_mov_b64 v[48:49], 0
    v_mov_b64 v[40:41], -1
    v_mov_b64 v[42:43], -1
    v_pk_mul_f32 v[104:105], v[104:105], v[20:21] op_sel_hi:[1,0]
    v_pk_mul_f32 v[106:107], v[106:107], v[20:21] op_sel_hi:[1,0]
    v_pk_mul_f32 v[108:109], v[108:109], v[20:21] op_sel_hi:[1,0]
    v_pk_mul_f32 v[110:111], v[110:111], v[20:21] op_sel_hi:[1,0]
    v_cvt_pk_bf16_f32 v116, v104, v105
    v_cvt_pk_bf16_f32 v117, v106, v107
    v_cvt_pk_bf16_f32 v118, v108, v109
    v_cvt_pk_bf16_f32 v119, v110, v111
    ds_write_b128 v19, v[116:119]
    ds_read_b128 v[80:83], v18 offset:16384
    ds_read_b128 v[84:87], v18 offset:17408
    ds_read_b128 v[32:35], v18 offset:24576
    ds_read_b128 v[36:39], v18 offset:25600
    s_add_u32 s29, s25, 24576
    s_and_b32 s29, s29, 1073152
    buffer_store_dword v40, v7, s[8:11], s29 offen sc1
    s_min_u32 s33, s33, 83361792
    s_add_u32 s31, s31, 524288
    s_waitcnt lgkmcnt(4)
    s_barrier
    ds_read_b128 v[104:107], v1 offset:16384
    ds_read_b128 v[108:111], v1 offset:17408
    ds_read_b128 v[112:115], v2 offset:32768
    ds_read_b128 v[116:119], v2 offset:33792
    s_waitcnt lgkmcnt(3)
    v_smfmac_f32_16x16x64_bf16 v[48:51], v[104:107], v[64:71], v0
    v_smfmac_f32_16x16x64_bf16 v[52:55], v[104:107], v[72:79], v0
    v_mov_b64 v[64:65], 0
    v_mov_b64 v[66:67], 0
    s_waitcnt lgkmcnt(2)
    v_smfmac_f32_16x16x64_bf16 v[48:51], v[108:111], v[88:95], v0
    ds_read_b128 v[88:91], v2 offset:40960
    ds_read_b128 v[92:95], v2 offset:41984
    v_mov_b64 v[68:69], 0
    v_smfmac_f32_16x16x64_bf16 v[52:55], v[108:111], v[24:31], v0
    ds_read_b128 v[24:27], v18 offset:32768
    ds_read_b128 v[28:31], v18 offset:33792
    v_mov_b64 v[70:71], 0
    v_smfmac_f32_16x16x64_bf16 v[56:59], v[104:107], v[120:127], v0
    ds_read_b128 v[120:123], v18 offset:40960
    v_mov_b64 v[72:73], 0
    v_smfmac_f32_16x16x64_bf16 v[60:63], v[104:107], v[96:103], v0
    ds_read_b128 v[124:127], v18 offset:41984
    v_add_f32 v48, v48, v50
    v_add_f32 v49, v49, v51
    v_cvt_pk_bf16_f32 v48, v48, v49
    v_smfmac_f32_16x16x64_bf16 v[56:59], v[108:111], v[80:87], v0
    ds_read_b128 v[96:99], v2 offset:49152
    v_add_f32 v52, v52, v54
    v_add_f32 v53, v53, v55
    v_cvt_pk_bf16_f32 v49, v52, v53
    v_smfmac_f32_16x16x64_bf16 v[60:63], v[108:111], v[32:39], v0
    ds_read_b128 v[100:103], v2 offset:50176
    buffer_store_dwordx2 v[48:49], v3, s[8:11], s27 offen offset:0 sc1
    v_mov_b64 v[74:75], 0
    v_mov_b64 v[76:77], 0
    v_mov_b64 v[78:79], 0
    s_waitcnt lgkmcnt(8)
    v_smfmac_f32_16x16x64_bf16 v[64:67], v[104:107], v[112:119], v0
    ds_read_b128 v[80:83], v2 offset:57344
    s_waitcnt lgkmcnt(7)
    v_smfmac_f32_16x16x64_bf16 v[68:71], v[104:107], v[88:95], v0
    ds_read_b128 v[84:87], v2 offset:58368
    v_add_f32 v56, v56, v58
    v_add_f32 v57, v57, v59
    v_cvt_pk_bf16_f32 v56, v56, v57
    s_waitcnt lgkmcnt(6)
    v_smfmac_f32_16x16x64_bf16 v[64:67], v[108:111], v[24:31], v0
    ds_read_b128 v[32:35], v18 offset:49152
    v_add_f32 v60, v60, v62
    v_add_f32 v61, v61, v63
    v_cvt_pk_bf16_f32 v57, v60, v61
    s_waitcnt lgkmcnt(5)
    v_smfmac_f32_16x16x64_bf16 v[68:71], v[108:111], v[120:127], v0
    ds_read_b128 v[36:39], v18 offset:50176
    buffer_store_dwordx2 v[56:57], v3, s[8:11], s27 offen offset:2176 sc1
    s_waitcnt lgkmcnt(4)
    v_smfmac_f32_16x16x64_bf16 v[72:75], v[104:107], v[96:103], v0
    ds_read_b128 v[112:115], v18 offset:57344
    s_waitcnt lgkmcnt(3)
    v_smfmac_f32_16x16x64_bf16 v[76:79], v[104:107], v[80:87], v0
    ds_read_b128 v[116:119], v18 offset:58368
    v_add_f32 v64, v64, v66
    v_add_f32 v65, v65, v67
    v_cvt_pk_bf16_f32 v64, v64, v65
    s_waitcnt lgkmcnt(2)
    v_smfmac_f32_16x16x64_bf16 v[72:75], v[108:111], v[32:39], v0
    v_add_f32 v68, v68, v70
    v_add_f32 v69, v69, v71
    v_cvt_pk_bf16_f32 v65, v68, v69
    s_waitcnt lgkmcnt(0)
    v_smfmac_f32_16x16x64_bf16 v[76:79], v[108:111], v[112:119], v0
    buffer_store_dwordx2 v[64:65], v3, s[8:11], s28 offen offset:0 sc1
    s_nop 1
    v_add_f32 v72, v72, v74
    v_add_f32 v73, v73, v75
    v_cvt_pk_bf16_f32 v72, v72, v73
    s_nop 1
    v_add_f32 v76, v76, v78
    v_add_f32 v77, v77, v79
    v_cvt_pk_bf16_f32 v73, v76, v77
    buffer_store_dwordx2 v[72:73], v3, s[8:11], s28 offen offset:2176 sc1
    s_mov_b32 s23, 0
    v_mov_b64 v[80:81], 0
    v_mov_b64 v[82:83], 0
    v_mov_b64 v[84:85], 0
    v_mov_b64 v[86:87], 0
    v_mov_b64 v[88:89], 0
    v_mov_b64 v[90:91], 0
    v_mov_b64 v[92:93], 0
    v_mov_b64 v[94:95], 0
    v_mov_b64 v[96:97], 0
    v_mov_b64 v[98:99], 0
    v_mov_b64 v[100:101], 0
    v_mov_b64 v[102:103], 0
    s_nop 7
    s_nop 7
    s_nop 7
    s_nop 7
    s_nop 7
    buffer_load_dwordx4 v[104:107], v6, s[8:11], s27 offen sc1
    buffer_load_dwordx4 v[108:111], v6, s[8:11], s27 offen offset:1024 sc1
    s_nop 7
    s_nop 7
    s_nop 7
    s_nop 7
    buffer_load_dwordx4 v[104:107], v6, s[8:11], s27 offen sc1
    buffer_load_dwordx4 v[108:111], v6, s[8:11], s27 offen offset:1024 sc1
    s_add_u32 s25, s25, 8192
    s_and_b32 s25, s25, 1073152
    s_add_u32 s26, s25, 4096
    s_xor_b32 s29, s27, 524288
    s_add_u32 s28, s29, 4352
    s_add_u32 s22, s22, 1
PA_166:
    s_waitcnt vmcnt(2)
    v_max3_u32 v20, v104, v105, v106
    v_max3_u32 v21, v107, v108, v109
    v_max3_u32 v20, v110, v111, v20
    v_max_u32 v20, v20, v21
    v_cmp_eq_u32 vcc, -1, v20
    v_mfma_f32_16x16x32_bf16 v[120:123], v[104:107], v[8:11], 0
    v_mfma_f32_16x16x32_bf16 v[120:123], v[108:111], v[8:11], v[120:123]
    s_cbranch_vccz PAd_167
    s_mov_b64 exec, vcc
    buffer_load_dwordx4 v[104:107], v6, s[8:11], s27 offen sc1
    buffer_load_dwordx4 v[108:111], v6, s[8:11], s27 offen offset:1024 sc1
    s_mov_b64 exec, -1
    s_waitcnt vmcnt(2)
    v_max3_u32 v20, v104, v105, v106
    v_max3_u32 v21, v107, v108, v109
    v_max3_u32 v20, v110, v111, v20
    v_max_u32 v20, v20, v21
    v_cmp_eq_u32 vcc, -1, v20
    v_mfma_f32_16x16x32_bf16 v[120:123], v[104:107], v[8:11], 0
    v_mfma_f32_16x16x32_bf16 v[120:123], v[108:111], v[8:11], v[120:123]
    s_cbranch_vccz PAd_167
    s_mov_b64 exec, vcc
    buffer_load_dwordx4 v[104:107], v6, s[8:11], s27 offen sc1
    buffer_load_dwordx4 v[108:111], v6, s[8:11], s27 offen offset:1024 sc1
    s_mov_b64 exec, -1
    s_add_u32 s23, s23, 1
    s_cmp_lt_u32 s23, 400000
    s_cbranch_scc1 PA_166
    s_branch m_exit
PAd_167:
    s_cmp_eq_u32 s22, 63
    s_nop 5
    v_permlane32_swap_b32 v120, v121
    v_permlane32_swap_b32 v122, v123
    v_add_f32 v120, v120, v121
    v_add_f32 v122, v122, v123
    s_cbranch_scc1 FN_168
    s_nop 0
    v_permlane16_swap_b32 v120, v122
    v_add_f32 v120, v120, v122
    s_nop 1
    v_mov_b32_dpp v121, v120 row_shl:4 row_mask:0xf bank_mask:0xf
    v_cvt_pk_bf16_f32 v120, v120, v121
    buffer_store_dword v120, v7, s[8:11], s25 offen sc1
    s_mov_b32 s36, s27
    s_mov_b32 s27, s29
    s_nop 7
    s_nop 7
    s_nop 7
    s_nop 7
    s_nop 7
    s_nop 7
    buffer_load_dwordx4 v[64:67], v1, s[8:11], s26 offen offset:0 sc1
    buffer_load_dwordx4 v[68:71], v1, s[8:11], s26 offen offset:1024 sc1
    s_nop 7
    s_nop 7
    s_nop 7
    s_nop 7
    buffer_load_dwordx4 v[64:67], v1, s[8:11], s26 offen offset:0 sc1
    buffer_load_dwordx4 v[68:71], v1, s[8:11], s26 offen offset:1024 sc1
m_tx_ent2b:
    s_barrier
    ds_read_b128 v[48:51], v1 offset:19456
    ds_read_b128 v[52:55], v1 offset:20480
    ds_read_b128 v[56:59], v1 offset:21504
    ds_read_b128 v[60:63], v1 offset:22528
    s_waitcnt lgkmcnt(3)
    v_smfmac_f32_16x16x64_bf16 v[80:83], v[48:51], a[0:7], v0
    v_smfmac_f32_16x16x64_bf16 v[84:87], v[48:51], a[8:15], v0
    v_smfmac_f32_16x16x64_bf16 v[88:91], v[48:51], a[128:135], v0
    v_smfmac_f32_16x16x64_bf16 v[92:95], v[48:51], a[136:143], v0
    s_waitcnt lgkmcnt(2)
    s_waitcnt lgkmcnt(0)
    s_waitcnt vmcnt(0)
    v_max3_u32 v20, v64, v65, v66
    v_smfmac_f32_16x16x64_bf16 v[80:83], v[52:55], a[16:23], v0
    v_max3_u32 v21, v67, v68, v69
    v_smfmac_f32_16x16x64_bf16 v[84:87], v[52:55], a[24:31], v0
    v_max3_u32 v20, v70, v71, v20
    v_smfmac_f32_16x16x64_bf16 v[88:91], v[52:55], a[144:151], v0
    v_max_u32 v20, v20, v21
    v_smfmac_f32_16x16x64_bf16 v[92:95], v[52:55], a[152:159], v0
    v_cmp_eq_u32 vcc, -1, v20
    v_smfmac_f32_16x16x64_bf16 v[80:83], v[56:59], a[32:39], v0
    ds_write_b128 v1, v[64:67] offset:23552
    v_smfmac_f32_16x16x64_bf16 v[84:87], v[56:59], a[40:47], v0
    ds_write_b128 v1, v[68:71] offset:24576
    s_cbranch_vccnz RT_172
RB_173:
    v_smfmac_f32_16x16x64_bf16 v[88:91], v[56:59], a[160:167], v0
    v_smfmac_f32_16x16x64_bf16 v[92:95], v[56:59], a[168:175], v0
    v_smfmac_f32_16x16x64_bf16 v[80:83], v[60:63], a[48:55], v0
    v_smfmac_f32_16x16x64_bf16 v[84:87], v[60:63], a[56:63], v0
    v_smfmac_f32_16x16x64_bf16 v[88:91], v[60:63], a[176:183], v0
    v_smfmac_f32_16x16x64_bf16 v[92:95], v[60:63], a[184:191], v0
    s_waitcnt lgkmcnt(0)
JY_171:
    s_barrier
    ds_read_b128 v[72:75], v1 offset:25600
    ds_read_b128 v[76:79], v1 offset:26624
    v_smfmac_f32_16x16x64_bf16 v[80:83], v[64:67], a[64:71], v0
    buffer_load_dwordx4 v[24:27], v16, s[8:11], s31 offen offset:0 sc1
    v_smfmac_f32_16x16x64_bf16 v[84:87], v[64:67], a[72:79], v0
    v_smfmac_f32_16x16x64_bf16 v[80:83], v[68:71], a[80:87], v0
    buffer_load_dwordx4 v[28:31], v16, s[8:11], s31 offen offset:1024 sc1
    v_smfmac_f32_16x16x64_bf16 v[84:87], v[68:71], a[88:95], v0
    v_smfmac_f32_16x16x64_bf16 v[88:91], v[64:67], a[192:199], v0
    buffer_load_dwordx4 v[32:35], v16, s[8:11], s31 offen offset:2048 sc1
    v_smfmac_f32_16x16x64_bf16 v[92:95], v[64:67], a[200:207], v0
    v_smfmac_f32_16x16x64_bf16 v[88:91], v[68:71], a[208:215], v0
    buffer_load_dwordx4 v[36:39], v16, s[8:11], s31 offen offset:3072 sc1
    v_smfmac_f32_16x16x64_bf16 v[92:95], v[68:71], a[216:223], v0
    v_mov_b32 v23, v120
    s_waitcnt lgkmcnt(0)
    v_smfmac_f32_16x16x64_bf16 v[80:83], v[72:75], a[96:103], v0
    v_smfmac_f32_16x16x64_bf16 v[84:87], v[72:75], a[104:111], v0
    v_smfmac_f32_16x16x64_bf16 v[80:83], v[76:79], a[112:119], v0
    v_smfmac_f32_16x16x64_bf16 v[84:87], v[76:79], a[120:127], v0
    s_branch m_tx_loop2
.p2align 8
m_tx_loop3:
    v_smfmac_f32_16x16x64_bf16 v[88:91], v[64:67], a[192:199], v0
    v_lshl_add_u32 v21, v1, 3, s34
    v_smfmac_f32_16x16x64_bf16 v[88:91], v[68:71], a[208:215], v0
    s_waitcnt vmcnt(4)
    v_smfmac_f32_16x16x64_bf16 v[92:95], v[64:67], a[200:207], v0
    buffer_store_dwordx4 v[40:43], v6, s[8:11], s36 offen offset:0 sc1
    v_cvt_pk_bf16_f32 v120, v80, v81
    v_smfmac_f32_16x16x64_bf16 v[92:95], v[68:71], a[216:223], v0
    v_cvt_pk_bf16_f32 v121, v82, v83
    v_cvt_pk_bf16_f32 v122, v84, v85
    v_cvt_pk_bf16_f32 v123, v86, v87
    v_mfma_f32_16x16x16_bf16 v[104:107], v[120:121], v[4:5], 0
    v_cvt_pk_bf16_f32 v124, v88, v89
    v_cvt_pk_bf16_f32 v125, v90, v91
    v_mfma_f32_16x16x16_bf16 v[108:111], v[122:123], v[4:5], 0
    s_nop 0
    v_cvt_pk_bf16_f32 v126, v92, v93
    v_cvt_pk_bf16_f32 v127, v94, v95
    v_mfma_f32_16x16x16_bf16 v[112:115], v[124:125], v[4:5], 0
    s_mov_b32 m0, 18432
    v_mfma_f32_16x16x16_bf16 v[116:119], v[126:127], v[4:5], 0
    v_cvt_pk_bf16_f32 v120, v104, v105
    v_cvt_pk_bf16_f32 v121, v106, v107
    v_cvt_pk_bf16_f32 v122, v108, v109
    v_cvt_pk_bf16_f32 v123, v110, v111
    s_waitcnt vmcnt(1)
    s_nop 0
    v_mfma_f32_16x16x32_bf16 v[104:107], v[24:27], v[120:123], 0
    v_mfma_f32_16x16x32_bf16 v[108:111], v[28:31], v[120:123], 0
    v_cvt_pk_bf16_f32 v40, v112, v113
    v_cvt_pk_bf16_f32 v41, v114, v115
    v_cvt_pk_bf16_f32 v42, v116, v117
    v_cvt_pk_bf16_f32 v43, v118, v119
    s_nop 1
    v_mfma_f32_16x16x32_bf16 v[112:115], v[40:43], v[120:123], 0
    s_nop 0
    v_cndmask_b32 v104, v104, v108, s[38:39]
    v_cndmask_b32 v105, v105, v109, s[38:39]
    v_cndmask_b32 v106, v106, v110, s[38:39]
    v_cndmask_b32 v107, v107, v111, s[38:39]
    ds_write_b128 v1, v[104:107] offset:12288
    v_mov_b64 v[40:41], -1
    v_mov_b64 v[42:43], -1
    ds_write_b64 v1, v[112:113] offset:14336
    v_smfmac_f32_16x16x64_bf16 v[96:99], v[48:51], v[128:135], v0
    buffer_store_dwordx4 v[40:43], v6, s[8:11], s36 offen offset:1024 sc1
    s_lshl_b32 s29, s22, 13
    s_add_u32 s29, s29, 131072
    buffer_store_dword v23, v7, s[8:11], s29 offen sc1
    s_cmp_ge_i32 s22, s30
    v_smfmac_f32_16x16x64_bf16 v[100:103], v[48:51], v[136:143], v0
    s_cbranch_scc1 SL_176
SB_177:
    s_mov_b32 exec_hi, 0
    buffer_load_dword v21, s[8:11], s33 offen sc1 lds
    s_mov_b32 exec_hi, -1
    v_smfmac_f32_16x16x64_bf16 v[96:99], v[52:55], v[144:151], v0
    v_smfmac_f32_16x16x64_bf16 v[100:103], v[52:55], v[152:159], v0
    s_waitcnt lgkmcnt(0)
    s_barrier
    ds_read_b128 v[80:83], v1 offset:0
    ds_read_b128 v[84:87], v1 offset:4096
    ds_read_b128 v[108:111], v1 offset:8192
    v_smfmac_f32_16x16x64_bf16 v[96:99], v[56:59], v[160:167], v0
    ds_read_b64 v[114:115], v1 offset:2048
    ds_read_b64 v[116:117], v1 offset:6144
    ds_read_b64 v[118:119], v1 offset:10240
    v_smfmac_f32_16x16x64_bf16 v[100:103], v[56:59], v[168:175], v0
    ds_read_b128 v[88:91], v18 offset:0
    v_smfmac_f32_16x16x64_bf16 v[96:99], v[60:63], v[176:183], v0
    ds_read_b128 v[92:95], v18 offset:1024
    v_smfmac_f32_16x16x64_bf16 v[100:103], v[60:63], v[184:191], v0
    ds_read_b128 v[24:27], v18 offset:8192
    s_add_u32 s33, s33, 524288
    s_waitcnt lgkmcnt(7)
    v_pk_add_f32 v[80:81], v[80:81], v[84:85]
    v_pk_add_f32 v[82:83], v[82:83], v[86:87]
    s_waitcnt lgkmcnt(6)
    v_pk_add_f32 v[104:105], v[104:105], v[108:109]
    v_pk_add_f32 v[106:107], v[106:107], v[110:111]
    v_pk_add_f32 v[80:81], v[80:81], v[104:105]
    v_pk_add_f32 v[82:83], v[82:83], v[106:107]
    s_waitcnt lgkmcnt(3)
    v_pk_add_f32 v[112:113], v[112:113], v[114:115]
    v_pk_add_f32 v[116:117], v[116:117], v[118:119]
    v_max3_f32 v22, v80, v81, v82
    v_pk_add_f32 v[112:113], v[112:113], v[116:117]
    v_max3_f32 v22, v22, v83, v112
    v_max_f32 v22, v22, v113
    v_smfmac_f32_16x16x64_bf16 v[96:99], v[64:67], v[192:199], v0
    ds_read_b128 v[28:31], v18 offset:9216
    v_max_f32_dpp v22, v22, v22 quad_perm:[2,3,0,1] row_mask:0xf bank_mask:0xf
    v_mov_b32 v20, v22
    v_smfmac_f32_16x16x64_bf16 v[100:103], v[64:67], v[200:207], v0
    ds_read_b128 v[120:123], v2 offset:16384
    v_permlane16_swap_b32 v22, v20
    v_max_f32 v22, v22, v20
    v_mov_b32 v20, v22
    v_smfmac_f32_16x16x64_bf16 v[96:99], v[68:71], v[208:215], v0
    ds_read_b128 v[124:127], v2 offset:17408
    v_permlane32_swap_b32 v22, v20
    v_max_f32 v22, v22, v20
    v_mul_f32 v23, s24, v22
    v_smfmac_f32_16x16x64_bf16 v[100:103], v[68:71], v[216:223], v0
    v_fma_f32 v80, v80, s24, -v23
    v_smfmac_f32_16x16x64_bf16 v[96:99], v[72:75], v[224:231], v0
    v_fma_f32 v81, v81, s24, -v23
    v_smfmac_f32_16x16x64_bf16 v[100:103], v[72:75], v[232:239], v0
    v_fma_f32 v82, v82, s24, -v23
    v_smfmac_f32_16x16x64_bf16 v[96:99], v[76:79], v[240:247], v0
    v_fma_f32 v83, v83, s24, -v23
    v_smfmac_f32_16x16x64_bf16 v[100:103], v[76:79], v[248:255], v0
    v_fma_f32 v112, v112, s24, -v23
    v_fma_f32 v113, v113, s24, -v23
    v_exp_f32 v80, v80
    v_exp_f32 v81, v81
    v_exp_f32 v82, v82
    v_exp_f32 v83, v83
    v_exp_f32 v112, v112
    v_exp_f32 v113, v113
    v_cvt_pk_bf16_f32 v84, v80, v81
    v_cvt_pk_bf16_f32 v85, v82, v83
    v_cvt_pk_bf16_f32 v114, v112, v113
    v_mov_b32_dpp v86, v84 quad_perm:[2,3,0,1] row_mask:0xf bank_mask:0xf
    v_mov_b32_dpp v87, v85 quad_perm:[2,3,0,1] row_mask:0xf bank_mask:0xf
    v_cvt_pk_bf16_f32 v115, v112, v113
    v_cvt_pk_bf16_f32 v116, v112, v113
    v_mfma_f32_16x16x32_bf16 v[40:43], v[12:15], v[84:87], 0
    v_mov_b32 v117, 0
    v_cvt_pk_bf16_f32 v44, v96, v97
    v_mfma_f32_16x16x32_bf16 v[104:107], v[32:35], v[84:87], 0
    v_cvt_pk_bf16_f32 v45, v98, v99
    v_cvt_pk_bf16_f32 v46, v100, v101
    v_mfma_f32_16x16x16_bf16 v[40:43], v[12:13], v[116:117], v[40:43]
    v_cvt_pk_bf16_f32 v47, v102, v103
    ds_read_b128 v[64:67], v2 offset:0
    v_mfma_f32_16x16x32_bf16 v[108:111], v[36:39], v[84:87], 0
    ds_read_b128 v[68:71], v2 offset:1024
    ds_read_b128 v[72:75], v2 offset:8192
    v_mfma_f32_16x16x16_bf16 v[104:107], v[44:45], v[114:115], v[104:107]
    ds_read_b128 v[76:79], v2 offset:9216
    ds_read_b128 v[96:99], v2 offset:24576
    v_mfma_f32_16x16x16_bf16 v[108:111], v[46:47], v[114:115], v[108:111]
    v_rcp_f32 v20, v40
    ds_read_b128 v[100:103], v2 offset:25600
    v_mov_b64 v[62:63], 0
    v_mov_b64 v[60:61], 0
    v_mov_b64 v[58:59], 0
    v_mov_b64 v[56:57], 0
    v_mov_b64 v[54:55], 0
    v_mov_b64 v[52:53], 0
    v_mov_b64 v[50:51], 0
    v_mov_b64 v[48:49], 0
    v_mov_b64 v[40:41], -1
    v_mov_b64 v[42:43], -1
    v_pk_mul_f32 v[104:105], v[104:105], v[20:21] op_sel_hi:[1,0]
    v_pk_mul_f32 v[106:107], v[106:107], v[20:21] op_sel_hi:[1,0]
    v_pk_mul_f32 v[108:109], v[108:109], v[20:21] op_sel_hi:[1,0]
    v_pk_mul_f32 v[110:111], v[110:111], v[20:21] op_sel_hi:[1,0]
    v_cvt_pk_bf16_f32 v116, v104, v105
    v_cvt_pk_bf16_f32 v117, v106, v107
    v_cvt_pk_bf16_f32 v118, v108, v109
    v_cvt_pk_bf16_f32 v119, v110, v111
    ds_write_b128 v19, v[116:119]
    ds_read_b128 v[80:83], v18 offset:16384
    ds_read_b128 v[84:87], v18 offset:17408
    ds_read_b128 v[32:35], v18 offset:24576
    ds_read_b128 v[36:39], v18 offset:25600
    s_add_u32 s29, s25, 24576
    s_and_b32 s29, s29, 1073152
    buffer_store_dword v40, v7, s[8:11], s29 offen sc1
    s_min_u32 s33, s33, 83361792
    s_add_u32 s31, s31, 524288
    s_waitcnt lgkmcnt(4)
    s_barrier
    ds_read_b128 v[104:107], v1 offset:16384
    ds_read_b128 v[108:111], v1 offset:17408
    ds_read_b128 v[112:115], v2 offset:32768
    ds_read_b128 v[116:119], v2 offset:33792
    s_waitcnt lgkmcnt(3)
    v_smfmac_f32_16x16x64_bf16 v[48:51], v[104:107], v[64:71], v0
    v_smfmac_f32_16x16x64_bf16 v[52:55], v[104:107], v[72:79], v0
    v_mov_b64 v[64:65], 0
    v_mov_b64 v[66:67], 0
    s_waitcnt lgkmcnt(2)
    v_smfmac_f32_16x16x64_bf16 v[48:51], v[108:111], v[88:95], v0
    ds_read_b128 v[88:91], v2 offset:40960
    ds_read_b128 v[92:95], v2 offset:41984
    v_mov_b64 v[68:69], 0
    v_smfmac_f32_16x16x64_bf16 v[52:55], v[108:111], v[24:31], v0
    ds_read_b128 v[24:27], v18 offset:32768
    ds_read_b128 v[28:31], v18 offset:33792
    v_mov_b64 v[70:71], 0
    v_smfmac_f32_16x16x64_bf16 v[56:59], v[104:107], v[120:127], v0
    ds_read_b128 v[120:123], v18 offset:40960
    v_mov_b64 v[72:73], 0
    v_smfmac_f32_16x16x64_bf16 v[60:63], v[104:107], v[96:103], v0
    ds_read_b128 v[124:127], v18 offset:41984
    v_add_f32 v48, v48, v50
    v_add_f32 v49, v49, v51
    v_cvt_pk_bf16_f32 v48, v48, v49
    v_smfmac_f32_16x16x64_bf16 v[56:59], v[108:111], v[80:87], v0
    ds_read_b128 v[96:99], v2 offset:49152
    v_add_f32 v52, v52, v54
    v_add_f32 v53, v53, v55
    v_cvt_pk_bf16_f32 v49, v52, v53
    v_smfmac_f32_16x16x64_bf16 v[60:63], v[108:111], v[32:39], v0
    ds_read_b128 v[100:103], v2 offset:50176
    buffer_store_dwordx2 v[48:49], v3, s[8:11], s27 offen offset:0 sc1
    v_mov_b64 v[74:75], 0
    v_mov_b64 v[76:77], 0
    v_mov_b64 v[78:79], 0
    s_waitcnt lgkmcnt(8)
    v_smfmac_f32_16x16x64_bf16 v[64:67], v[104:107], v[112:119], v0
    ds_read_b128 v[80:83], v2 offset:57344
    s_waitcnt lgkmcnt(7)
    v_smfmac_f32_16x16x64_bf16 v[68:71], v[104:107], v[88:95], v0
    ds_read_b128 v[84:87], v2 offset:58368
    v_add_f32 v56, v56, v58
    v_add_f32 v57, v57, v59
    v_cvt_pk_bf16_f32 v56, v56, v57
    s_waitcnt lgkmcnt(6)
    v_smfmac_f32_16x16x64_bf16 v[64:67], v[108:111], v[24:31], v0
    ds_read_b128 v[32:35], v18 offset:49152
    v_add_f32 v60, v60, v62
    v_add_f32 v61, v61, v63
    v_cvt_pk_bf16_f32 v57, v60, v61
    s_waitcnt lgkmcnt(5)
    v_smfmac_f32_16x16x64_bf16 v[68:71], v[108:111], v[120:127], v0
    ds_read_b128 v[36:39], v18 offset:50176
    buffer_store_dwordx2 v[56:57], v3, s[8:11], s27 offen offset:2176 sc1
    s_waitcnt lgkmcnt(4)
    v_smfmac_f32_16x16x64_bf16 v[72:75], v[104:107], v[96:103], v0
    ds_read_b128 v[112:115], v18 offset:57344
    s_waitcnt lgkmcnt(3)
    v_smfmac_f32_16x16x64_bf16 v[76:79], v[104:107], v[80:87], v0
    ds_read_b128 v[116:119], v18 offset:58368
    v_add_f32 v64, v64, v66
    v_add_f32 v65, v65, v67
    v_cvt_pk_bf16_f32 v64, v64, v65
    s_waitcnt lgkmcnt(2)
    v_smfmac_f32_16x16x64_bf16 v[72:75], v[108:111], v[32:39], v0
    v_add_f32 v68, v68, v70
    v_add_f32 v69, v69, v71
    v_cvt_pk_bf16_f32 v65, v68, v69
    s_waitcnt lgkmcnt(0)
    v_smfmac_f32_16x16x64_bf16 v[76:79], v[108:111], v[112:119], v0
    buffer_store_dwordx2 v[64:65], v3, s[8:11], s28 offen offset:0 sc1
    s_nop 1
    v_add_f32 v72, v72, v74
    v_add_f32 v73, v73, v75
    v_cvt_pk_bf16_f32 v72, v72, v73
    s_nop 1
    v_add_f32 v76, v76, v78
    v_add_f32 v77, v77, v79
    v_cvt_pk_bf16_f32 v73, v76, v77
    buffer_store_dwordx2 v[72:73], v3, s[8:11], s28 offen offset:2176 sc1
    s_mov_b32 s23, 0
    v_mov_b64 v[80:81], 0
    v_mov_b64 v[82:83], 0
    v_mov_b64 v[84:85], 0
    v_mov_b64 v[86:87], 0
    v_mov_b64 v[88:89], 0
    v_mov_b64 v[90:91], 0
    v_mov_b64 v[92:93], 0
    v_mov_b64 v[94:95], 0
    v_mov_b64 v[96:97], 0
    v_mov_b64 v[98:99], 0
    v_mov_b64 v[100:101], 0
    v_mov_b64 v[102:103], 0
    s_nop 7
    s_nop 7
    s_nop 7
    s_nop 7
    s_nop 7
    s_nop 7
    buffer_load_dwordx4 v[104:107], v6, s[8:11], s27 offen sc1
    buffer_load_dwordx4 v[108:111], v6, s[8:11], s27 offen offset:1024 sc1
    s_nop 7
    s_nop 7
    s_nop 7
    s_nop 7
    buffer_load_dwordx4 v[104:107], v6, s[8:11], s27 offen sc1
    buffer_load_dwordx4 v[108:111], v6, s[8:11], s27 offen offset:1024 sc1
    s_add_u32 s25, s25, 8192
    s_and_b32 s25, s25, 1073152
    s_add_u32 s26, s25, 6144
    s_xor_b32 s29, s27, 524288
    s_add_u32 s28, s29, 4352
    s_add_u32 s22, s22, 1
PA_180:
    s_waitcnt vmcnt(2)
    v_max3_u32 v20, v104, v105, v106
    v_max3_u32 v21, v107, v108, v109
    v_max3_u32 v20, v110, v111, v20
    v_max_u32 v20, v20, v21
    v_cmp_eq_u32 vcc, -1, v20
    v_mfma_f32_16x16x32_bf16 v[120:123], v[104:107], v[8:11], 0
    v_mfma_f32_16x16x32_bf16 v[120:123], v[108:111], v[8:11], v[120:123]
    s_cbranch_vccz PAd_181
    s_mov_b64 exec, vcc
    buffer_load_dwordx4 v[104:107], v6, s[8:11], s27 offen sc1
    buffer_load_dwordx4 v[108:111], v6, s[8:11], s27 offen offset:1024 sc1
    s_mov_b64 exec, -1
    s_waitcnt vmcnt(2)
    v_max3_u32 v20, v104, v105, v106
    v_max3_u32 v21, v107, v108, v109
    v_max3_u32 v20, v110, v111, v20
    v_max_u32 v20, v20, v21
    v_cmp_eq_u32 vcc, -1, v20
    v_mfma_f32_16x16x32_bf16 v[120:123], v[104:107], v[8:11], 0
    v_mfma_f32_16x16x32_bf16 v[120:123], v[108:111], v[8:11], v[120:123]
    s_cbranch_vccz PAd_181
    s_mov_b64 exec, vcc
    buffer_load_dwordx4 v[104:107], v6, s[8:11], s27 offen sc1
    buffer_load_dwordx4 v[108:111], v6, s[8:11], s27 offen offset:1024 sc1
    s_mov_b64 exec, -1
    s_add_u32 s23, s23, 1
    s_cmp_lt_u32 s23, 400000
    s_cbranch_scc1 PA_180
    s_branch m_exit
PAd_181:
    s_cmp_eq_u32 s22, 63
    s_nop 5
    v_permlane32_swap_b32 v120, v121
    v_permlane32_swap_b32 v122, v123
    v_add_f32 v120, v120, v121
    v_add_f32 v122, v122, v123
    s_cbranch_scc1 FN_182
    s_nop 0
    v_permlane16_swap_b32 v120, v122
    v_add_f32 v120, v120, v122
    s_nop 1
    v_mov_b32_dpp v121, v120 row_shl:4 row_mask:0xf bank_mask:0xf
    v_cvt_pk_bf16_f32 v120, v120, v121
    buffer_store_dword v120, v7, s[8:11], s25 offen sc1
    s_mov_b32 s36, s27
    s_mov_b32 s27, s29
    s_nop 7
    s_nop 7
    s_nop 7
    s_nop 7
    s_nop 7
    buffer_load_dwordx4 v[72:75], v1, s[8:11], s26 offen offset:0 sc1
    buffer_load_dwordx4 v[76:79], v1, s[8:11], s26 offen offset:1024 sc1
    s_nop 7
    s_nop 7
    s_nop 7
    s_nop 7
    buffer_load_dwordx4 v[72:75], v1, s[8:11], s26 offen offset:0 sc1
    buffer_load_dwordx4 v[76:79], v1, s[8:11], s26 offen offset:1024 sc1
m_tx_ent3b:
    s_barrier
    ds_read_b128 v[48:51], v1 offset:19456
    ds_read_b128 v[52:55], v1 offset:20480
    ds_read_b128 v[56:59], v1 offset:21504
    ds_read_b128 v[60:63], v1 offset:22528
    s_waitcnt lgkmcnt(3)
    v_smfmac_f32_16x16x64_bf16 v[80:83], v[48:51], a[0:7], v0
    v_smfmac_f32_16x16x64_bf16 v[84:87], v[48:51], a[8:15], v0
    v_smfmac_f32_16x16x64_bf16 v[88:91], v[48:51], a[128:135], v0
    v_smfmac_f32_16x16x64_bf16 v[92:95], v[48:51], a[136:143], v0
    s_waitcnt lgkmcnt(2)
    s_waitcnt lgkmcnt(0)
    s_waitcnt vmcnt(2)
    v_max3_u32 v20, v72, v73, v74
    v_smfmac_f32_16x16x64_bf16 v[80:83], v[52:55], a[16:23], v0
    v_max3_u32 v21, v75, v76, v77
    v_smfmac_f32_16x16x64_bf16 v[84:87], v[52:55], a[24:31], v0
    v_max3_u32 v20, v78, v79, v20
    v_smfmac_f32_16x16x64_bf16 v[88:91], v[52:55], a[144:151], v0
    v_max_u32 v20, v20, v21
    v_smfmac_f32_16x16x64_bf16 v[92:95], v[52:55], a[152:159], v0
    v_cmp_eq_u32 vcc, -1, v20
    v_smfmac_f32_16x16x64_bf16 v[80:83], v[56:59], a[32:39], v0
    ds_write_b128 v1, v[72:75] offset:25600
    v_smfmac_f32_16x16x64_bf16 v[84:87], v[56:59], a[40:47], v0
    ds_write_b128 v1, v[76:79] offset:26624
    s_cbranch_vccnz RT_186
RB_187:
    v_smfmac_f32_16x16x64_bf16 v[88:91], v[56:59], a[160:167], v0
    v_smfmac_f32_16x16x64_bf16 v[92:95], v[56:59], a[168:175], v0
    v_smfmac_f32_16x16x64_bf16 v[80:83], v[60:63], a[48:55], v0
    v_smfmac_f32_16x16x64_bf16 v[84:87], v[60:63], a[56:63], v0
    v_smfmac_f32_16x16x64_bf16 v[88:91], v[60:63], a[176:183], v0
    v_smfmac_f32_16x16x64_bf16 v[92:95], v[60:63], a[184:191], v0
    s_waitcnt lgkmcnt(0)
JY_185:
    s_barrier
    ds_read_b128 v[64:67], v1 offset:23552
    ds_read_b128 v[68:71], v1 offset:24576
    v_smfmac_f32_16x16x64_bf16 v[80:83], v[72:75], a[96:103], v0
    buffer_load_dwordx4 v[24:27], v16, s[8:11], s31 offen offset:0 sc1
    v_smfmac_f32_16x16x64_bf16 v[84:87], v[72:75], a[104:111], v0
    v_smfmac_f32_16x16x64_bf16 v[80:83], v[76:79], a[112:119], v0
    buffer_load_dwordx4 v[28:31], v16, s[8:11], s31 offen offset:1024 sc1
    v_smfmac_f32_16x16x64_bf16 v[84:87], v[76:79], a[120:127], v0
    v_smfmac_f32_16x16x64_bf16 v[88:91], v[72:75], a[224:231], v0
    buffer_load_dwordx4 v[32:35], v16, s[8:11], s31 offen offset:2048 sc1
    v_smfmac_f32_16x16x64_bf16 v[92:95], v[72:75], a[232:239], v0
    v_smfmac_f32_16x16x64_bf16 v[88:91], v[76:79], a[240:247], v0
    buffer_load_dwordx4 v[36:39], v16, s[8:11], s31 offen offset:3072 sc1
    v_smfmac_f32_16x16x64_bf16 v[92:95], v[76:79], a[248:255], v0
    v_mov_b32 v23, v120
    s_waitcnt lgkmcnt(0)
    v_smfmac_f32_16x16x64_bf16 v[80:83], v[64:67], a[64:71], v0
    v_smfmac_f32_16x16x64_bf16 v[84:87], v[64:67], a[72:79], v0
    v_smfmac_f32_16x16x64_bf16 v[80:83], v[68:71], a[80:87], v0
    v_smfmac_f32_16x16x64_bf16 v[84:87], v[68:71], a[88:95], v0
    s_branch m_tx_loop3
m_t_done:
m_tt:
    v_lshrrev_b32 v60, 4, v1
    s_load_dwordx2 s[84:85], s[0:1], 80
    s_load_dwordx2 s[86:87], s[0:1], 104
    s_waitcnt lgkmcnt(0)
    s_barrier
    s_mov_b32 s44, s84
    s_and_b32 s45, s85, 0xffff
    s_mov_b32 s46, 0x158000
    s_mov_b32 s47, 0x20000
    s_mov_b32 s48, s86
    s_and_b32 s49, s87, 0xffff
    s_mov_b32 s50, 0x200000
    s_mov_b32 s51, 0x20000
    v_and_b32 v61, 15, v60
    v_lshrrev_b32 v62, 4, v60
    v_bfe_u32 v63, v60, 2, 2
    v_and_b32 v64, 3, v60
    s_lshl_b32 s42, s21, 15
    s_add_u32 s42, s42, 32768
    s_and_b32 s37, s20, 15
    s_lshr_b32 s36, s20, 4
    v_lshrrev_b32 v65, 2, v60
    v_lshlrev_b32 v65, 10, v65
    v_lshlrev_b32 v66, 4, v64
    s_mul_i32 s40, s21, 360448
    s_lshl_b32 s41, s37, 6
    s_add_u32 s40, s40, s41
    v_add3_u32 v65, v65, v66, s40
    s_add_u32 m0, s42, 0
    s_mov_b32 s43, 0
    buffer_load_dwordx4 v65, s[44:47], s43 offen lds
    s_add_u32 m0, s42, 1024
    s_mov_b32 s43, 16384
    buffer_load_dwordx4 v65, s[44:47], s43 offen lds
    s_add_u32 m0, s42, 2048
    s_mov_b32 s43, 32768
    buffer_load_dwordx4 v65, s[44:47], s43 offen lds
    s_add_u32 m0, s42, 3072
    s_mov_b32 s43, 49152
    buffer_load_dwordx4 v65, s[44:47], s43 offen lds
    s_add_u32 m0, s42, 4096
    s_mov_b32 s43, 65536
    buffer_load_dwordx4 v65, s[44:47], s43 offen lds
    s_add_u32 m0, s42, 5120
    s_mov_b32 s43, 81920
    buffer_load_dwordx4 v65, s[44:47], s43 offen lds
    s_add_u32 m0, s42, 6144
    s_mov_b32 s43, 98304
    buffer_load_dwordx4 v65, s[44:47], s43 offen lds
    s_add_u32 m0, s42, 7168
    s_mov_b32 s43, 114688
    buffer_load_dwordx4 v65, s[44:47], s43 offen lds
    s_add_u32 m0, s42, 8192
    s_mov_b32 s43, 131072
    buffer_load_dwordx4 v65, s[44:47], s43 offen lds
    s_add_u32 m0, s42, 9216
    s_mov_b32 s43, 147456
    buffer_load_dwordx4 v65, s[44:47], s43 offen lds
    s_add_u32 m0, s42, 10240
    s_mov_b32 s43, 163840
    buffer_load_dwordx4 v65, s[44:47], s43 offen lds
    s_add_u32 m0, s42, 11264
    s_mov_b32 s43, 180224
    buffer_load_dwordx4 v65, s[44:47], s43 offen lds
    s_add_u32 m0, s42, 12288
    s_mov_b32 s43, 196608
    buffer_load_dwordx4 v65, s[44:47], s43 offen lds
    s_add_u32 m0, s42, 13312
    s_mov_b32 s43, 212992
    buffer_load_dwordx4 v65, s[44:47], s43 offen lds
    s_add_u32 m0, s42, 14336
    s_mov_b32 s43, 229376
    buffer_load_dwordx4 v65, s[44:47], s43 offen lds
    s_add_u32 m0, s42, 15360
    s_mov_b32 s43, 245760
    buffer_load_dwordx4 v65, s[44:47], s43 offen lds
    s_add_u32 m0, s42, 16384
    s_mov_b32 s43, 262144
    buffer_load_dwordx4 v65, s[44:47], s43 offen lds
    s_add_u32 m0, s42, 17408
    s_mov_b32 s43, 278528
    buffer_load_dwordx4 v65, s[44:47], s43 offen lds
    s_add_u32 m0, s42, 18432
    s_mov_b32 s43, 294912
    buffer_load_dwordx4 v65, s[44:47], s43 offen lds
    s_add_u32 m0, s42, 19456
    s_mov_b32 s43, 311296
    buffer_load_dwordx4 v65, s[44:47], s43 offen lds
    s_add_u32 m0, s42, 20480
    s_mov_b32 s43, 327680
    buffer_load_dwordx4 v65, s[44:47], s43 offen lds
    s_add_u32 m0, s42, 21504
    s_mov_b32 s43, 344064
    buffer_load_dwordx4 v65, s[44:47], s43 offen lds
    v_lshlrev_b32 v66, 2, v62
    v_add_u32 v66, v66, v63
    v_lshlrev_b32 v66, 6, v66
    v_lshlrev_b32 v67, 3, v64
    v_add3_u32 v66, v66, v67, s42
    s_waitcnt vmcnt(20)
    ds_read_b64_tr_b16 a[0:1], v66 offset:0
    ds_read_b64_tr_b16 a[2:3], v66 offset:1024
    ds_read_b64_tr_b16 a[4:5], v66 offset:32
    ds_read_b64_tr_b16 a[6:7], v66 offset:1056
    s_waitcnt vmcnt(18)
    ds_read_b64_tr_b16 a[8:9], v66 offset:2048
    ds_read_b64_tr_b16 a[10:11], v66 offset:3072
    ds_read_b64_tr_b16 a[12:13], v66 offset:2080
    ds_read_b64_tr_b16 a[14:15], v66 offset:3104
    s_waitcnt vmcnt(16)
    ds_read_b64_tr_b16 a[16:17], v66 offset:4096
    ds_read_b64_tr_b16 a[18:19], v66 offset:5120
    ds_read_b64_tr_b16 a[20:21], v66 offset:4128
    ds_read_b64_tr_b16 a[22:23], v66 offset:5152
    s_waitcnt vmcnt(14)
    ds_read_b64_tr_b16 a[24:25], v66 offset:6144
    ds_read_b64_tr_b16 a[26:27], v66 offset:7168
    ds_read_b64_tr_b16 a[28:29], v66 offset:6176
    ds_read_b64_tr_b16 a[30:31], v66 offset:7200
    s_waitcnt vmcnt(12)
    ds_read_b64_tr_b16 a[32:33], v66 offset:8192
    ds_read_b64_tr_b16 a[34:35], v66 offset:9216
    ds_read_b64_tr_b16 a[36:37], v66 offset:8224
    ds_read_b64_tr_b16 a[38:39], v66 offset:9248
    s_waitcnt vmcnt(10)
    ds_read_b64_tr_b16 a[40:41], v66 offset:10240
    ds_read_b64_tr_b16 a[42:43], v66 offset:11264
    ds_read_b64_tr_b16 a[44:45], v66 offset:10272
    ds_read_b64_tr_b16 a[46:47], v66 offset:11296
    s_waitcnt vmcnt(8)
    ds_read_b64_tr_b16 a[48:49], v66 offset:12288
    ds_read_b64_tr_b16 a[50:51], v66 offset:13312
    ds_read_b64_tr_b16 a[52:53], v66 offset:12320
    ds_read_b64_tr_b16 a[54:55], v66 offset:13344
    s_waitcnt vmcnt(6)
    ds_read_b64_tr_b16 a[56:57], v66 offset:14336
    ds_read_b64_tr_b16 a[58:59], v66 offset:15360
    ds_read_b64_tr_b16 a[60:61], v66 offset:14368
    ds_read_b64_tr_b16 a[62:63], v66 offset:15392
    s_waitcnt vmcnt(4)
    ds_read_b64_tr_b16 a[64:65], v66 offset:16384
    ds_read_b64_tr_b16 a[66:67], v66 offset:17408
    ds_read_b64_tr_b16 a[68:69], v66 offset:16416
    ds_read_b64_tr_b16 a[70:71], v66 offset:17440
    s_waitcnt vmcnt(2)
    ds_read_b64_tr_b16 a[72:73], v66 offset:18432
    ds_read_b64_tr_b16 a[74:75], v66 offset:19456
    ds_read_b64_tr_b16 a[76:77], v66 offset:18464
    ds_read_b64_tr_b16 a[78:79], v66 offset:19488
    s_waitcnt vmcnt(0)
    ds_read_b64_tr_b16 a[80:81], v66 offset:20480
    ds_read_b64_tr_b16 a[82:83], v66 offset:21504
    ds_read_b64_tr_b16 a[84:85], v66 offset:20512
    ds_read_b64_tr_b16 a[86:87], v66 offset:21536
    s_waitcnt lgkmcnt(0)
    s_cmp_lg_u32 s21, 0
    s_cbranch_scc1 PD_191
    s_mov_b32 s23, 0
PL_190:
    buffer_load_dword v61, off, s[16:19], 0 offset:196 sc1
    s_waitcnt vmcnt(0)
    v_readfirstlane_b32 s40, v61
    s_nop 0
    s_cmp_ge_u32 s40, 1
    s_cbranch_scc1 PD_191
    s_sleep 2
    s_add_u32 s23, s23, 1
    s_cmp_lt_u32 s23, 400000
    s_cbranch_scc1 PL_190
    s_branch m_exit
PD_191:
    s_barrier
    s_add_u32 s5, s20, 2016
    s_mov_b32 s7, 2048
    s_branch m_r1b
m_dl:
    s_load_dwordx2 s[86:87], s[0:1], 104
    s_waitcnt lgkmcnt(0)
    s_mov_b32 s48, s86
    s_and_b32 s49, s87, 0xffff
    s_mov_b32 s50, 0x200000
    s_mov_b32 s51, 0x20000
    v_and_b32 v61, 15, v60
    v_lshrrev_b32 v62, 4, v60
    v_bfe_u32 v63, v60, 2, 2
    v_and_b32 v64, 3, v60
    s_lshl_b32 s42, s21, 15
    s_add_u32 s42, s42, 32768
    s_and_b32 s37, s20, 15
    s_lshr_b32 s36, s20, 4
    v_lshlrev_b32 v1, 4, v60
    s_mul_i32 s40, s21, 11264
    s_mul_i32 s41, s36, 44032
    s_add_u32 s40, s40, s41
    v_add_u32 v2, s40, v1
    s_lshl_b32 s40, s21, 11
    v_add_u32 v3, s40, v1
    s_and_b32 s40, s21, 1
    s_lshl_b32 s41, s40, 10
    v_add_u32 v4, s41, v1
    s_lshl_b32 s40, s40, 4
    s_lshl_b32 s41, s37, 5
    s_add_u32 s40, s40, s41
    v_lshlrev_b32 v65, 2, v62
    v_add_u32 v65, s40, v65
    v_lshlrev_b32 v66, 2, v65
    s_mov_b32 s43, 75776
    buffer_load_dwordx4 v[8:11], v66, s[8:11], s43 offen sc1
    v_lshlrev_b32 v65, 1, v65
    v_lshlrev_b32 v66, 10, v61
    s_lshl_b32 s40, s36, 14
    v_add3_u32 v5, v65, v66, s40
    s_mov_b32 s36, 63
    s_mov_b32 s55, 0
    s_waitcnt lgkmcnt(0)
DL_192:
    s_lshl_b32 s52, s36, 7
    s_add_u32 s52, s52, 24576
    s_mov_b32 s52, 24448
    s_cmp_lg_u32 s21, 0
    s_cbranch_scc1 PD_198
    s_mov_b32 s23, 0
PL_197:
    buffer_load_dword v6, off, s[8:11], s52 offset:0 sc1
    s_waitcnt vmcnt(0)
    v_readfirstlane_b32 s40, v6
    s_nop 0
    s_cmp_ge_u32 s40, 32
    s_cbranch_scc1 PD_198
    s_sleep 4
    s_add_u32 s23, s23, 1
    s_cmp_lt_u32 s23, 400000
    s_cbranch_scc1 PL_197
    s_branch m_exit
PD_198:
    s_barrier
    s_mul_i32 s56, s36, 88064
    s_add_u32 s56, s56, 10485760
    s_lshl_b32 s53, s36, 15
    s_add_u32 s54, s53, 6291456
    buffer_load_dwordx2 v[6:7], v5, s[8:11], s54 offen sc1
    v_lshrrev_b32 v25, 1, v60
    s_cmp_eq_u32 s21, 3
    s_cselect_b32 s40, 9, 10
    v_min_u32 v25, s40, v25
    v_lshlrev_b32 v25, 10, v25
    v_and_b32 v26, 1, v60
    v_lshlrev_b32 v26, 3, v26
    v_sub_u32 v27, v2, v1
    v_add3_u32 v25, v25, v26, v27
    s_mov_b32 s57, s56
    v_mov_b64 v[72:73], 0
    v_mov_b64 v[74:75], 0
    s_mov_b32 s23, 0
CY_199:
    buffer_load_dword v24, v25, s[8:11], s57 offen sc1
    s_add_u32 s23, s23, 1
    s_cmp_ge_u32 s23, 400000
    s_cbranch_scc1 m_exit
    s_waitcnt vmcnt(0)
    v_cmp_eq_u32 vcc, -1, v24
    s_cbranch_vccz CZ_200
    s_sleep 1
    s_branch CY_199
CZ_200:
    s_mov_b32 s56, s57
    buffer_load_dwordx4 v[32:35], v2, s[8:11], s56 offen offset:0 sc1
    buffer_load_dwordx4 v[36:39], v2, s[8:11], s56 offen offset:1024 sc1
    buffer_load_dwordx4 v[40:43], v2, s[8:11], s56 offen offset:2048 sc1
    buffer_load_dwordx4 v[44:47], v2, s[8:11], s56 offen offset:3072 sc1
    s_add_u32 s56, s56, 4096
    buffer_load_dwordx4 v[48:51], v2, s[8:11], s56 offen offset:0 sc1
    buffer_load_dwordx4 v[52:55], v2, s[8:11], s56 offen offset:1024 sc1
    buffer_load_dwordx4 v[56:59], v2, s[8:11], s56 offen offset:2048 sc1
    buffer_load_dwordx4 v[60:63], v2, s[8:11], s56 offen offset:3072 sc1
    s_add_u32 s56, s56, 4096
    buffer_load_dwordx4 v[64:67], v2, s[8:11], s56 offen offset:0 sc1
    buffer_load_dwordx4 v[68:71], v2, s[8:11], s56 offen offset:1024 sc1
    s_cmp_eq_u32 s21, 3
    s_cbranch_scc1 DS_193
    buffer_load_dwordx4 v[72:75], v2, s[8:11], s56 offen offset:2048 sc1
DS_193:
    s_waitcnt vmcnt(0)
    v_max3_u32 v24, v32, v33, v34
    v_max3_u32 v24, v24, v35, v36
    v_max3_u32 v24, v24, v37, v38
    v_max3_u32 v24, v24, v39, v40
    v_max3_u32 v24, v24, v41, v42
    v_max3_u32 v24, v24, v43, v44
    v_max3_u32 v24, v24, v45, v46
    v_max3_u32 v24, v24, v47, v48
    v_max3_u32 v24, v24, v49, v50
    v_max3_u32 v24, v24, v51, v52
    v_max3_u32 v24, v24, v53, v54
    v_max3_u32 v24, v24, v55, v56
    v_max3_u32 v24, v24, v57, v58
    v_max3_u32 v24, v24, v59, v60
    v_max3_u32 v24, v24, v61, v62
    v_max3_u32 v24, v24, v63, v64
    v_max3_u32 v24, v24, v65, v66
    v_max3_u32 v24, v24, v67, v68
    v_max3_u32 v24, v24, v69, v70
    v_max3_u32 v24, v24, v71, v72
    v_max3_u32 v24, v24, v73, v74
    v_max_u32 v24, v24, v75
    v_cmp_eq_u32 vcc, -1, v24
    s_cbranch_vccnz CY_199
    s_waitcnt vmcnt(9)
    v_mfma_f32_16x16x32_bf16 v[12:15], a[0:3], v[32:35], 0
    v_mfma_f32_16x16x32_bf16 v[16:19], a[4:7], v[32:35], 0
    s_waitcnt vmcnt(8)
    v_mfma_f32_16x16x32_bf16 v[12:15], a[8:11], v[36:39], v[12:15]
    v_mfma_f32_16x16x32_bf16 v[16:19], a[12:15], v[36:39], v[16:19]
    s_waitcnt vmcnt(7)
    v_mfma_f32_16x16x32_bf16 v[12:15], a[16:19], v[40:43], v[12:15]
    v_mfma_f32_16x16x32_bf16 v[16:19], a[20:23], v[40:43], v[16:19]
    s_waitcnt vmcnt(6)
    v_mfma_f32_16x16x32_bf16 v[12:15], a[24:27], v[44:47], v[12:15]
    v_mfma_f32_16x16x32_bf16 v[16:19], a[28:31], v[44:47], v[16:19]
    s_waitcnt vmcnt(5)
    v_mfma_f32_16x16x32_bf16 v[12:15], a[32:35], v[48:51], v[12:15]
    v_mfma_f32_16x16x32_bf16 v[16:19], a[36:39], v[48:51], v[16:19]
    s_waitcnt vmcnt(4)
    v_mfma_f32_16x16x32_bf16 v[12:15], a[40:43], v[52:55], v[12:15]
    v_mfma_f32_16x16x32_bf16 v[16:19], a[44:47], v[52:55], v[16:19]
    s_waitcnt vmcnt(3)
    v_mfma_f32_16x16x32_bf16 v[12:15], a[48:51], v[56:59], v[12:15]
    v_mfma_f32_16x16x32_bf16 v[16:19], a[52:55], v[56:59], v[16:19]
    s_waitcnt vmcnt(2)
    v_mfma_f32_16x16x32_bf16 v[12:15], a[56:59], v[60:63], v[12:15]
    v_mfma_f32_16x16x32_bf16 v[16:19], a[60:63], v[60:63], v[16:19]
    s_waitcnt vmcnt(1)
    v_mfma_f32_16x16x32_bf16 v[12:15], a[64:67], v[64:67], v[12:15]
    v_mfma_f32_16x16x32_bf16 v[16:19], a[68:71], v[64:67], v[16:19]
    s_waitcnt vmcnt(0)
    v_mfma_f32_16x16x32_bf16 v[12:15], a[72:75], v[68:71], v[12:15]
    v_mfma_f32_16x16x32_bf16 v[16:19], a[76:79], v[68:71], v[16:19]
    s_waitcnt vmcnt(0)
    s_cmp_eq_u32 s21, 3
    s_cbranch_scc1 DT_194
    v_mfma_f32_16x16x32_bf16 v[12:15], a[80:83], v[72:75], v[12:15]
    v_mfma_f32_16x16x32_bf16 v[16:19], a[84:87], v[72:75], v[16:19]
DT_194:
    v_and_b32 v29, 0xffff0000, v6
    v_lshlrev_b32 v28, 16, v6
    v_and_b32 v31, 0xffff0000, v7
    v_lshlrev_b32 v30, 16, v7
    s_nop 2
    ds_write_b128 v3, v[12:15] offset:0
    ds_write_b128 v3, v[16:19] offset:1024
    s_waitcnt lgkmcnt(0)
    s_barrier
    s_cmp_ge_u32 s21, 2
    s_cbranch_scc1 DN_196
    ds_read_b128 v[32:35], v4 offset:0
    ds_read_b128 v[36:39], v4 offset:2048
    ds_read_b128 v[40:43], v4 offset:4096
    ds_read_b128 v[44:47], v4 offset:6144
    s_waitcnt lgkmcnt(0)
    v_add_f32 v32, v32, v36
    v_add_f32 v40, v40, v44
    v_add_f32 v33, v33, v37
    v_add_f32 v41, v41, v45
    v_add_f32 v34, v34, v38
    v_add_f32 v42, v42, v46
    v_add_f32 v35, v35, v39
    v_add_f32 v43, v43, v47
    v_add_f32 v32, v32, v40
    v_add_f32 v33, v33, v41
    v_add_f32 v34, v34, v42
    v_add_f32 v35, v35, v43
    v_fma_f32 v32, v32, v8, v28
    v_fma_f32 v33, v33, v9, v29
    v_fma_f32 v34, v34, v10, v30
    v_fma_f32 v35, v35, v11, v31
    v_cvt_pk_bf16_f32 v26, v32, v33
    v_cvt_pk_bf16_f32 v27, v34, v35
    buffer_store_dwordx2 v[26:27], v5, s[48:51], s53 offen
DN_196:
    s_branch m_fin
    s_waitcnt vmcnt(0)
m_exit:
    s_endpgm
SL_78:
    v_lshrrev_b32 v20, 2, v1
    ds_read_b32 v22, v20 offset:27648
    s_add_u32 s40, s22, 1
    s_min_u32 s40, s40, 62
    s_lshl_b64 s[42:43], 3, s40
    s_mov_b32 s41, 0
    s_waitcnt lgkmcnt(0)
FS_80:
    v_cmp_ne_u32 vcc, 0, v22
    s_nop 3
    s_andn2_b64 s[44:45], s[42:43], vcc
    s_cbranch_scc0 FO_81
    buffer_load_dword v22, v20, s[8:11], s32 offen sc1
    s_add_u32 s41, s41, 1
    s_cmp_ge_u32 s41, 400000
    s_cbranch_scc1 m_exit
    s_waitcnt vmcnt(0)
    s_branch FS_80
FO_81:
    s_ff0_i32_b64 s30, vcc
    s_cmp_lt_i32 s30, 0
    s_cselect_b32 s30, 1000, s30
    s_sub_u32 s30, s30, 3
    s_mov_b32 m0, 27648
    s_nop 0
    buffer_load_dword v20, s[8:11], s32 offen sc1 lds
    s_mov_b32 m0, 18432
    s_branch SB_79
FN_84:
    s_mov_b32 s29, 647168
    v_permlane16_swap_b32 v120, v122
    v_add_f32 v120, v120, v122
    s_nop 1
    v_mov_b32_dpp v121, v120 row_shl:4 row_mask:0xf bank_mask:0xf
    v_cvt_pk_bf16_f32 v120, v120, v121
    buffer_store_dword v120, v7, s[8:11], s29 offen sc1
    s_branch m_t_done
m_t_ent0:
    v_mov_b32 v48, v40
    v_mov_b32 v49, v41
    v_mov_b32 v50, v42
    v_mov_b32 v51, v43
    v_mov_b32 v52, v78
    v_mov_b32 v53, v79
    v_mov_b32 v54, v54
    v_mov_b32 v55, v55
    v_mov_b64 v[40:41], -1
    v_mov_b64 v[42:43], -1
    s_branch m_t_ent0b
SL_92:
    v_lshrrev_b32 v20, 2, v1
    ds_read_b32 v22, v20 offset:27904
    s_add_u32 s40, s22, 1
    s_min_u32 s40, s40, 62
    s_lshl_b64 s[42:43], 3, s40
    s_mov_b32 s41, 0
    s_waitcnt lgkmcnt(0)
FS_94:
    v_cmp_ne_u32 vcc, 0, v22
    s_nop 3
    s_andn2_b64 s[44:45], s[42:43], vcc
    s_cbranch_scc0 FO_95
    buffer_load_dword v22, v20, s[8:11], s32 offen sc1
    s_add_u32 s41, s41, 1
    s_cmp_ge_u32 s41, 400000
    s_cbranch_scc1 m_exit
    s_waitcnt vmcnt(0)
    s_branch FS_94
FO_95:
    s_ff0_i32_b64 s30, vcc
    s_cmp_lt_i32 s30, 0
    s_cselect_b32 s30, 1000, s30
    s_sub_u32 s30, s30, 3
    s_mov_b32 m0, 27904
    s_nop 0
    buffer_load_dword v20, s[8:11], s32 offen sc1 lds
    s_mov_b32 m0, 18432
    s_branch SB_93
FN_98:
    s_mov_b32 s29, 647168
    v_permlane16_swap_b32 v120, v122
    v_add_f32 v120, v120, v122
    s_nop 1
    v_mov_b32_dpp v121, v120 row_shl:4 row_mask:0xf bank_mask:0xf
    v_cvt_pk_bf16_f32 v120, v120, v121
    buffer_store_dword v120, v7, s[8:11], s29 offen sc1
    s_branch m_t_done
m_t_ent1:
    v_mov_b32 v56, v40
    v_mov_b32 v57, v41
    v_mov_b32 v58, v42
    v_mov_b32 v59, v43
    v_mov_b32 v60, v78
    v_mov_b32 v61, v79
    v_mov_b32 v62, v54
    v_mov_b32 v63, v55
    v_mov_b64 v[40:41], -1
    v_mov_b64 v[42:43], -1
    s_branch m_t_ent1b
SL_106:
    v_lshrrev_b32 v20, 2, v1
    ds_read_b32 v22, v20 offset:28160
    s_add_u32 s40, s22, 1
    s_min_u32 s40, s40, 62
    s_lshl_b64 s[42:43], 3, s40
    s_mov_b32 s41, 0
    s_waitcnt lgkmcnt(0)
FS_108:
    v_cmp_ne_u32 vcc, 0, v22
    s_nop 3
    s_andn2_b64 s[44:45], s[42:43], vcc
    s_cbranch_scc0 FO_109
    buffer_load_dword v22, v20, s[8:11], s32 offen sc1
    s_add_u32 s41, s41, 1
    s_cmp_ge_u32 s41, 400000
    s_cbranch_scc1 m_exit
    s_waitcnt vmcnt(0)
    s_branch FS_108
FO_109:
    s_ff0_i32_b64 s30, vcc
    s_cmp_lt_i32 s30, 0
    s_cselect_b32 s30, 1000, s30
    s_sub_u32 s30, s30, 3
    s_mov_b32 m0, 28160
    s_nop 0
    buffer_load_dword v20, s[8:11], s32 offen sc1 lds
    s_mov_b32 m0, 18432
    s_branch SB_107
FN_112:
    s_mov_b32 s29, 647168
    v_permlane16_swap_b32 v120, v122
    v_add_f32 v120, v120, v122
    s_nop 1
    v_mov_b32_dpp v121, v120 row_shl:4 row_mask:0xf bank_mask:0xf
    v_cvt_pk_bf16_f32 v120, v120, v121
    buffer_store_dword v120, v7, s[8:11], s29 offen sc1
    s_branch m_t_done
m_t_ent2:
    v_mov_b32 v64, v40
    v_mov_b32 v65, v41
    v_mov_b32 v66, v42
    v_mov_b32 v67, v43
    v_mov_b32 v68, v78
    v_mov_b32 v69, v79
    v_mov_b32 v70, v54
    v_mov_b32 v71, v55
    v_mov_b64 v[40:41], -1
    v_mov_b64 v[42:43], -1
    s_branch m_t_ent2b
RT_116:
    s_mov_b64 exec, vcc
    buffer_load_dwordx4 v[64:67], v1, s[8:11], s26 offen offset:0 sc1
    buffer_load_dwordx4 v[68:71], v1, s[8:11], s26 offen offset:1024 sc1
    s_mov_b64 exec, -1
    s_mov_b32 s23, 0
RL_119:
    s_waitcnt vmcnt(2)
    v_max3_u32 v20, v64, v65, v66
    v_max3_u32 v21, v67, v68, v69
    v_max3_u32 v20, v70, v71, v20
    v_max_u32 v20, v20, v21
    v_cmp_eq_u32 vcc, -1, v20
    ds_write_b128 v1, v[64:67] offset:23552
    ds_write_b128 v1, v[68:71] offset:24576
    s_cbranch_vccz RB_117
    s_mov_b64 exec, vcc
    buffer_load_dwordx4 v[64:67], v1, s[8:11], s26 offen offset:0 sc1
    buffer_load_dwordx4 v[68:71], v1, s[8:11], s26 offen offset:1024 sc1
    s_mov_b64 exec, -1
    s_waitcnt vmcnt(2)
    v_max3_u32 v20, v64, v65, v66
    v_max3_u32 v21, v67, v68, v69
    v_max3_u32 v20, v70, v71, v20
    v_max_u32 v20, v20, v21
    v_cmp_eq_u32 vcc, -1, v20
    ds_write_b128 v1, v[64:67] offset:23552
    ds_write_b128 v1, v[68:71] offset:24576
    s_cbranch_vccz RB_117
    s_mov_b64 exec, vcc
    buffer_load_dwordx4 v[64:67], v1, s[8:11], s26 offen offset:0 sc1
    buffer_load_dwordx4 v[68:71], v1, s[8:11], s26 offen offset:1024 sc1
    s_mov_b64 exec, -1
    s_add_u32 s23, s23, 1
    s_cmp_lt_u32 s23, 400000
    s_cbranch_scc1 RL_119
    s_branch m_exit
SL_120:
    v_lshrrev_b32 v20, 2, v1
    ds_read_b32 v22, v20 offset:28416
    s_add_u32 s40, s22, 1
    s_min_u32 s40, s40, 62
    s_lshl_b64 s[42:43], 3, s40
    s_mov_b32 s41, 0
    s_waitcnt lgkmcnt(0)
FS_122:
    v_cmp_ne_u32 vcc, 0, v22
    s_nop 3
    s_andn2_b64 s[44:45], s[42:43], vcc
    s_cbranch_scc0 FO_123
    buffer_load_dword v22, v20, s[8:11], s32 offen sc1
    s_add_u32 s41, s41, 1
    s_cmp_ge_u32 s41, 400000
    s_cbranch_scc1 m_exit
    s_waitcnt vmcnt(0)
    s_branch FS_122
FO_123:
    s_ff0_i32_b64 s30, vcc
    s_cmp_lt_i32 s30, 0
    s_cselect_b32 s30, 1000, s30
    s_sub_u32 s30, s30, 3
    s_mov_b32 m0, 28416
    s_nop 0
    buffer_load_dword v20, s[8:11], s32 offen sc1 lds
    s_mov_b32 m0, 18432
    s_branch SB_121
FN_126:
    s_mov_b32 s29, 647168
    v_permlane16_swap_b32 v120, v122
    v_add_f32 v120, v120, v122
    s_nop 1
    v_mov_b32_dpp v121, v120 row_shl:4 row_mask:0xf bank_mask:0xf
    v_cvt_pk_bf16_f32 v120, v120, v121
    buffer_store_dword v120, v7, s[8:11], s29 offen sc1
    s_branch m_t_done
m_t_ent3:
    v_mov_b32 v72, v40
    v_mov_b32 v73, v41
    v_mov_b32 v74, v42
    v_mov_b32 v75, v43
    v_mov_b32 v76, v78
    v_mov_b32 v77, v79
    v_mov_b32 v78, v54
    v_mov_b32 v79, v55
    v_mov_b64 v[40:41], -1
    v_mov_b64 v[42:43], -1
    s_branch m_t_ent3b
RT_130:
    s_mov_b64 exec, vcc
    buffer_load_dwordx4 v[72:75], v1, s[8:11], s26 offen offset:0 sc1
    buffer_load_dwordx4 v[76:79], v1, s[8:11], s26 offen offset:1024 sc1
    s_mov_b64 exec, -1
    s_mov_b32 s23, 0
RL_133:
    s_waitcnt vmcnt(2)
    v_max3_u32 v20, v72, v73, v74
    v_max3_u32 v21, v75, v76, v77
    v_max3_u32 v20, v78, v79, v20
    v_max_u32 v20, v20, v21
    v_cmp_eq_u32 vcc, -1, v20
    ds_write_b128 v1, v[72:75] offset:25600
    ds_write_b128 v1, v[76:79] offset:26624
    s_cbranch_vccz RB_131
    s_mov_b64 exec, vcc
    buffer_load_dwordx4 v[72:75], v1, s[8:11], s26 offen offset:0 sc1
    buffer_load_dwordx4 v[76:79], v1, s[8:11], s26 offen offset:1024 sc1
    s_mov_b64 exec, -1
    s_waitcnt vmcnt(2)
    v_max3_u32 v20, v72, v73, v74
    v_max3_u32 v21, v75, v76, v77
    v_max3_u32 v20, v78, v79, v20
    v_max_u32 v20, v20, v21
    v_cmp_eq_u32 vcc, -1, v20
    ds_write_b128 v1, v[72:75] offset:25600
    ds_write_b128 v1, v[76:79] offset:26624
    s_cbranch_vccz RB_131
    s_mov_b64 exec, vcc
    buffer_load_dwordx4 v[72:75], v1, s[8:11], s26 offen offset:0 sc1
    buffer_load_dwordx4 v[76:79], v1, s[8:11], s26 offen offset:1024 sc1
    s_mov_b64 exec, -1
    s_add_u32 s23, s23, 1
    s_cmp_lt_u32 s23, 400000
    s_cbranch_scc1 RL_133
    s_branch m_exit
SL_134:
    v_lshrrev_b32 v20, 2, v1
    ds_read_b32 v22, v20 offset:27648
    s_add_u32 s40, s22, 1
    s_min_u32 s40, s40, 62
    s_lshl_b64 s[42:43], 3, s40
    s_mov_b32 s41, 0
    s_waitcnt lgkmcnt(0)
FS_136:
    v_cmp_ne_u32 vcc, 0, v22
    s_nop 3
    s_andn2_b64 s[44:45], s[42:43], vcc
    s_cbranch_scc0 FO_137
    buffer_load_dword v22, v20, s[8:11], s32 offen sc1
    s_add_u32 s41, s41, 1
    s_cmp_ge_u32 s41, 400000
    s_cbranch_scc1 m_exit
    s_waitcnt vmcnt(0)
    s_branch FS_136
FO_137:
    s_ff0_i32_b64 s30, vcc
    s_cmp_lt_i32 s30, 0
    s_cselect_b32 s30, 1000, s30
    s_sub_u32 s30, s30, 3
    s_mov_b32 m0, 27648
    s_nop 0
    buffer_load_dword v20, s[8:11], s32 offen sc1 lds
    s_mov_b32 m0, 18432
    s_branch SB_135
FN_140:
    s_mov_b32 s29, 647168
    v_permlane16_swap_b32 v120, v122
    v_add_f32 v120, v120, v122
    s_nop 1
    v_mov_b32_dpp v121, v120 row_shl:4 row_mask:0xf bank_mask:0xf
    v_cvt_pk_bf16_f32 v120, v120, v121
    buffer_store_dword v120, v7, s[8:11], s29 offen sc1
    s_branch m_t_done
m_tx_ent0:
    v_mov_b32 v48, v40
    v_mov_b32 v49, v41
    v_mov_b32 v50, v42
    v_mov_b32 v51, v43
    v_mov_b32 v52, v78
    v_mov_b32 v53, v79
    v_mov_b32 v54, v54
    v_mov_b32 v55, v55
    v_mov_b64 v[40:41], -1
    v_mov_b64 v[42:43], -1
    s_branch m_tx_ent0b
SL_148:
    v_lshrrev_b32 v20, 2, v1
    ds_read_b32 v22, v20 offset:27904
    s_add_u32 s40, s22, 1
    s_min_u32 s40, s40, 62
    s_lshl_b64 s[42:43], 3, s40
    s_mov_b32 s41, 0
    s_waitcnt lgkmcnt(0)
FS_150:
    v_cmp_ne_u32 vcc, 0, v22
    s_nop 3
    s_andn2_b64 s[44:45], s[42:43], vcc
    s_cbranch_scc0 FO_151
    buffer_load_dword v22, v20, s[8:11], s32 offen sc1
    s_add_u32 s41, s41, 1
    s_cmp_ge_u32 s41, 400000
    s_cbranch_scc1 m_exit
    s_waitcnt vmcnt(0)
    s_branch FS_150
FO_151:
    s_ff0_i32_b64 s30, vcc
    s_cmp_lt_i32 s30, 0
    s_cselect_b32 s30, 1000, s30
    s_sub_u32 s30, s30, 3
    s_mov_b32 m0, 27904
    s_nop 0
    buffer_load_dword v20, s[8:11], s32 offen sc1 lds
    s_mov_b32 m0, 18432
    s_branch SB_149
FN_154:
    s_mov_b32 s29, 647168
    v_permlane16_swap_b32 v120, v122
    v_add_f32 v120, v120, v122
    s_nop 1
    v_mov_b32_dpp v121, v120 row_shl:4 row_mask:0xf bank_mask:0xf
    v_cvt_pk_bf16_f32 v120, v120, v121
    buffer_store_dword v120, v7, s[8:11], s29 offen sc1
    s_branch m_t_done
m_tx_ent1:
    v_mov_b32 v56, v40
    v_mov_b32 v57, v41
    v_mov_b32 v58, v42
    v_mov_b32 v59, v43
    v_mov_b32 v60, v78
    v_mov_b32 v61, v79
    v_mov_b32 v62, v54
    v_mov_b32 v63, v55
    v_mov_b64 v[40:41], -1
    v_mov_b64 v[42:43], -1
    s_branch m_tx_ent1b
SL_162:
    v_lshrrev_b32 v20, 2, v1
    ds_read_b32 v22, v20 offset:28160
    s_add_u32 s40, s22, 1
    s_min_u32 s40, s40, 62
    s_lshl_b64 s[42:43], 3, s40
    s_mov_b32 s41, 0
    s_waitcnt lgkmcnt(0)
FS_164:
    v_cmp_ne_u32 vcc, 0, v22
    s_nop 3
    s_andn2_b64 s[44:45], s[42:43], vcc
    s_cbranch_scc0 FO_165
    buffer_load_dword v22, v20, s[8:11], s32 offen sc1
    s_add_u32 s41, s41, 1
    s_cmp_ge_u32 s41, 400000
    s_cbranch_scc1 m_exit
    s_waitcnt vmcnt(0)
    s_branch FS_164
FO_165:
    s_ff0_i32_b64 s30, vcc
    s_cmp_lt_i32 s30, 0
    s_cselect_b32 s30, 1000, s30
    s_sub_u32 s30, s30, 3
    s_mov_b32 m0, 28160
    s_nop 0
    buffer_load_dword v20, s[8:11], s32 offen sc1 lds
    s_mov_b32 m0, 18432
    s_branch SB_163
FN_168:
    s_mov_b32 s29, 647168
    v_permlane16_swap_b32 v120, v122
    v_add_f32 v120, v120, v122
    s_nop 1
    v_mov_b32_dpp v121, v120 row_shl:4 row_mask:0xf bank_mask:0xf
    v_cvt_pk_bf16_f32 v120, v120, v121
    buffer_store_dword v120, v7, s[8:11], s29 offen sc1
    s_branch m_t_done
m_tx_ent2:
    v_mov_b32 v64, v40
    v_mov_b32 v65, v41
    v_mov_b32 v66, v42
    v_mov_b32 v67, v43
    v_mov_b32 v68, v78
    v_mov_b32 v69, v79
    v_mov_b32 v70, v54
    v_mov_b32 v71, v55
    v_mov_b64 v[40:41], -1
    v_mov_b64 v[42:43], -1
    s_branch m_tx_ent2b
RT_172:
    s_mov_b64 exec, vcc
    buffer_load_dwordx4 v[64:67], v1, s[8:11], s26 offen offset:0 sc1
    buffer_load_dwordx4 v[68:71], v1, s[8:11], s26 offen offset:1024 sc1
    s_mov_b64 exec, -1
    s_mov_b32 s23, 0
RL_175:
    s_waitcnt vmcnt(2)
    v_max3_u32 v20, v64, v65, v66
    v_max3_u32 v21, v67, v68, v69
    v_max3_u32 v20, v70, v71, v20
    v_max_u32 v20, v20, v21
    v_cmp_eq_u32 vcc, -1, v20
    ds_write_b128 v1, v[64:67] offset:23552
    ds_write_b128 v1, v[68:71] offset:24576
    s_cbranch_vccz RB_173
    s_mov_b64 exec, vcc
    buffer_load_dwordx4 v[64:67], v1, s[8:11], s26 offen offset:0 sc1
    buffer_load_dwordx4 v[68:71], v1, s[8:11], s26 offen offset:1024 sc1
    s_mov_b64 exec, -1
    s_waitcnt vmcnt(2)
    v_max3_u32 v20, v64, v65, v66
    v_max3_u32 v21, v67, v68, v69
    v_max3_u32 v20, v70, v71, v20
    v_max_u32 v20, v20, v21
    v_cmp_eq_u32 vcc, -1, v20
    ds_write_b128 v1, v[64:67] offset:23552
    ds_write_b128 v1, v[68:71] offset:24576
    s_cbranch_vccz RB_173
    s_mov_b64 exec, vcc
    buffer_load_dwordx4 v[64:67], v1, s[8:11], s26 offen offset:0 sc1
    buffer_load_dwordx4 v[68:71], v1, s[8:11], s26 offen offset:1024 sc1
    s_mov_b64 exec, -1
    s_add_u32 s23, s23, 1
    s_cmp_lt_u32 s23, 400000
    s_cbranch_scc1 RL_175
    s_branch m_exit
SL_176:
    v_lshrrev_b32 v20, 2, v1
    ds_read_b32 v22, v20 offset:28416
    s_add_u32 s40, s22, 1
    s_min_u32 s40, s40, 62
    s_lshl_b64 s[42:43], 3, s40
    s_mov_b32 s41, 0
    s_waitcnt lgkmcnt(0)
FS_178:
    v_cmp_ne_u32 vcc, 0, v22
    s_nop 3
    s_andn2_b64 s[44:45], s[42:43], vcc
    s_cbranch_scc0 FO_179
    buffer_load_dword v22, v20, s[8:11], s32 offen sc1
    s_add_u32 s41, s41, 1
    s_cmp_ge_u32 s41, 400000
    s_cbranch_scc1 m_exit
    s_waitcnt vmcnt(0)
    s_branch FS_178
FO_179:
    s_ff0_i32_b64 s30, vcc
    s_cmp_lt_i32 s30, 0
    s_cselect_b32 s30, 1000, s30
    s_sub_u32 s30, s30, 3
    s_mov_b32 m0, 28416
    s_nop 0
    buffer_load_dword v20, s[8:11], s32 offen sc1 lds
    s_mov_b32 m0, 18432
    s_branch SB_177
FN_182:
    s_mov_b32 s29, 647168
    v_permlane16_swap_b32 v120, v122
    v_add_f32 v120, v120, v122
    s_nop 1
    v_mov_b32_dpp v121, v120 row_shl:4 row_mask:0xf bank_mask:0xf
    v_cvt_pk_bf16_f32 v120, v120, v121
    buffer_store_dword v120, v7, s[8:11], s29 offen sc1
    s_branch m_t_done
m_tx_ent3:
    v_mov_b32 v72, v40
    v_mov_b32 v73, v41
    v_mov_b32 v74, v42
    v_mov_b32 v75, v43
    v_mov_b32 v76, v78
    v_mov_b32 v77, v79
    v_mov_b32 v78, v54
    v_mov_b32 v79, v55
    v_mov_b64 v[40:41], -1
    v_mov_b64 v[42:43], -1
    s_branch m_tx_ent3b
RT_186:
    s_mov_b64 exec, vcc
    buffer_load_dwordx4 v[72:75], v1, s[8:11], s26 offen offset:0 sc1
    buffer_load_dwordx4 v[76:79], v1, s[8:11], s26 offen offset:1024 sc1
    s_mov_b64 exec, -1
    s_mov_b32 s23, 0
RL_189:
    s_waitcnt vmcnt(2)
    v_max3_u32 v20, v72, v73, v74
    v_max3_u32 v21, v75, v76, v77
    v_max3_u32 v20, v78, v79, v20
    v_max_u32 v20, v20, v21
    v_cmp_eq_u32 vcc, -1, v20
    ds_write_b128 v1, v[72:75] offset:25600
    ds_write_b128 v1, v[76:79] offset:26624
    s_cbranch_vccz RB_187
    s_mov_b64 exec, vcc
    buffer_load_dwordx4 v[72:75], v1, s[8:11], s26 offen offset:0 sc1
    buffer_load_dwordx4 v[76:79], v1, s[8:11], s26 offen offset:1024 sc1
    s_mov_b64 exec, -1
    s_waitcnt vmcnt(2)
    v_max3_u32 v20, v72, v73, v74
    v_max3_u32 v21, v75, v76, v77
    v_max3_u32 v20, v78, v79, v20
    v_max_u32 v20, v20, v21
    v_cmp_eq_u32 vcc, -1, v20
    ds_write_b128 v1, v[72:75] offset:25600
    ds_write_b128 v1, v[76:79] offset:26624
    s_cbranch_vccz RB_187
    s_mov_b64 exec, vcc
    buffer_load_dwordx4 v[72:75], v1, s[8:11], s26 offen offset:0 sc1
    buffer_load_dwordx4 v[76:79], v1, s[8:11], s26 offen offset:1024 sc1
    s_mov_b64 exec, -1
    s_add_u32 s23, s23, 1
    s_cmp_lt_u32 s23, 400000
    s_cbranch_scc1 RL_189
    s_branch m_exit
KEND:
.section .rodata,"a"
.p2align 6
.amdhsa_kernel adaLN_cond__memory_aug_recurrent_mem_tr__geglu_ffn__prompt_kernel
  .amdhsa_next_free_vgpr 512
  .amdhsa_next_free_sgpr 102
  .amdhsa_accum_offset 256
  .amdhsa_group_segment_fixed_size 0
  .amdhsa_kernarg_size 128
  .amdhsa_user_sgpr_count 2
  .amdhsa_user_sgpr_kernarg_segment_ptr 1
  .amdhsa_system_sgpr_workgroup_id_x 1
  .amdhsa_float_denorm_mode_32 3
.end_amdhsa_kernel
```
